```python
import torch

def _softmax(x, axis=-1):
    return torch.softmax(x, dim=axis)
def _gelu(x):
    return torch.nn.functional.gelu(x, approximate="tanh")
def _silu(x):
    return torch.nn.functional.silu(x)
def _sigmoid(x):
    return torch.sigmoid(x)
def _layernorm(x, axis=-1, eps=1e-5):
    m = x.mean(dim=axis, keepdim=True)
    v = x.var(dim=axis, keepdim=True, unbiased=False)
    return (x - m) / torch.sqrt(v + eps)
def _scatter_add(tgt, idx, src, axis=0):
    return tgt.clone().index_add_(axis, idx, src)
def _segment_sum(src, seg, n):
    out = torch.zeros((n,) + src.shape[1:], dtype=src.dtype)
    return out.index_add_(0, seg, src)
def _pad(x, pw):
    flat = tuple(v for pair in reversed(pw) for v in pair)
    return torch.nn.functional.pad(x, flat)

kernel_name = 'interleave_layers__sliding_block__glu_gated_reglu__prompt'

def setup_inputs():

    _w = (lambda a: (lambda t: t.to(torch.bfloat16) if t.is_floating_point() else t)(torch.as_tensor(a)))
    def _A_setup():
        B, S, D = 1, 2048, 640
        return {
            "x": _w((lambda *s: torch.randn(*s, dtype=torch.bfloat16) * 0.05)(B, S, D)),
            "wqkv": _w((lambda *s: torch.randn(*s, dtype=torch.bfloat16) * 0.05)(D, 3 * D)),
            "wo": _w((lambda *s: torch.randn(*s, dtype=torch.bfloat16) * 0.05)(D, D)),
        }
    _A_in = _A_setup()

    def _B_setup():
        B, S, D, F = 1, 2048, 640, 1728
        return {
            "x": _w((lambda *s: torch.randn(*s, dtype=torch.bfloat16) * 0.05)(B, S, D)),
            "W_gate": _w((lambda *s: torch.randn(*s, dtype=torch.bfloat16) * 0.8)(D, F) * (2.0 / D) ** 0.5),
            "W_up": _w((lambda *s: torch.randn(*s, dtype=torch.bfloat16) * 0.8)(D, F) * (2.0 / D) ** 0.5),
            "W_down": _w((lambda *s: torch.randn(*s, dtype=torch.bfloat16) * 0.8)(F, D) * (1.0 / F) ** 0.5),
        }
    _B_in = _B_setup()

    return {
        "A_x": _A_in["x"],
        "A_wqkv": _A_in["wqkv"],
        "A_wo": _A_in["wo"],
        "B_x": _B_in["x"],
        "B_W_gate": _B_in["W_gate"],
        "B_W_up": _B_in["W_up"],
        "B_W_down": _B_in["W_down"],
    }

def reference(A_x, A_wqkv, A_wo, B_x, B_W_gate, B_W_up, B_W_down):
    def _A_ref(x, wqkv, wo):
        B, S, D = x.shape
        H = 32; Dh = D // H; W = 256
        qkv = (lambda x, *d: x.permute(*d))((x @ wqkv).reshape(B, S, 3, H, Dh), 2, 0, 3, 1, 4)
        q, k, v = qkv[0], qkv[1], qkv[2]
        scores = torch.einsum("bhqd,bhkd->bhqk", q, k) * (Dh ** -0.5)
        idx = torch.arange(S)
        mask = (idx[:, None] - idx[None, :] >= 0) & (idx[:, None] - idx[None, :] < W)
        scores = torch.where(mask[None, None], scores, -1e9)
        p = _softmax(scores, axis=-1)
        o = torch.einsum("bhqk,bhkd->bhqd", p, v)
        return (lambda x, *d: x.permute(*d))(o, 0, 2, 1, 3).reshape(B, S, D) @ wo

    def _B_ref(x, W_gate, W_up, W_down):
        gate = torch.einsum("bsd,df->bsf", x, W_gate)
        up = torch.einsum("bsd,df->bsf", x, W_up)
        gate = gate * (lambda x, dt: x.to(dt))(gate > 0, gate.dtype)
        h = gate * up
        return torch.einsum("bsf,fd->bsd", h, W_down)

    x = A_x
    x = x + _A_ref(_layernorm(x, axis=-1), A_wqkv, A_wo)
    x = x + _B_ref(_layernorm(x, axis=-1), B_W_gate, B_W_up, B_W_down)
    x = x + _A_ref(_layernorm(x, axis=-1), A_wqkv, A_wo)
    x = x + _B_ref(_layernorm(x, axis=-1), B_W_gate, B_W_up, B_W_down)
    return x
```

```asm
; @launch grid=(256,1,1) block=(256,1,1) lds=163840
.amdgcn_target "amdgcn-amd-amdhsa--gfx950"
.text
.globl interleave_layers__sliding_block__glu_gated_reglu__prompt_kernel
.p2align 8
.type interleave_layers__sliding_block__glu_gated_reglu__prompt_kernel,@function
interleave_layers__sliding_block__glu_gated_reglu__prompt_kernel:
  s_cmp_ge_u32 s2, 256
  s_cbranch_scc1 main_end
  s_load_dwordx2 s[28:29], s[0:1], 0
  s_load_dwordx4 s[32:35], s[0:1], 56
  s_load_dwordx2 s[30:31], s[0:1], 72
  s_load_dwordx4 s[80:83], s[0:1], 8
  s_load_dwordx4 s[84:87], s[0:1], 32
  s_load_dwordx2 s[88:89], s[0:1], 48
  v_and_b32 v1, 63, v0
  v_lshrrev_b32 v2, 6, v0
  s_nop 0
  v_readfirstlane_b32 s22, v2
  v_lshlrev_b32 v2, 4, v1
  s_bfe_u32 s20, s2, 0x20001
  s_lshl_b32 s20, s20, 2
  s_lshr_b32 s3, s2, 6
  s_add_u32 s20, s20, s3
  s_and_b32 s21, s2, 1
  s_lshl_b32 s21, s21, 3
  s_bfe_u32 s3, s2, 0x30003
  s_add_u32 s21, s21, s3
  s_and_b32 s24, s21, 1
  s_lshr_b32 s25, s21, 1
  s_lshr_b32 s26, s22, 1
  s_and_b32 s27, s22, 1
  s_sub_u32 s55, s22, 1
  s_mov_b32 s23, 0
  s_mov_b32 s40, 16777216
  s_mov_b32 s41, 0
  s_mov_b32 s54, 0
  s_lshl_b32 s3, s20, 2
  s_add_u32 s3, s3, s22
  s_mul_i32 s42, s3, 40960
  s_lshl_b32 s43, s3, 11
  s_mul_i32 s53, s3, 110592
  s_nop 0
  s_mul_i32 s49, s21, 163840
  s_add_u32 s49, s49, 1048576
  s_mul_i32 s51, s21, 286720
  s_add_u32 s51, s51, 4489216
  s_mul_i32 s50, s25, 102400
  s_add_u32 s50, s50, 3670016
  s_mul_i32 s52, s25, 286720
  s_add_u32 s52, s52, 9076736
  s_mov_b32 s38, s51
  s_cmp_eq_u32 s21, 15
  s_cmov_b32 s38, 2146435072
  s_waitcnt lgkmcnt(0)
  s_mov_b32 s4, s30
  s_mov_b32 s5, s31
  s_mov_b32 s6, 60817408
  s_mov_b32 s7, 0x20000
  s_mov_b32 s8, s28
  s_mov_b32 s9, s29
  s_mov_b32 s10, 2621440
  s_mov_b32 s11, 0x20000
  s_mov_b32 s16, s34
  s_mov_b32 s17, s35
  s_mov_b32 s18, 256
  s_mov_b32 s19, 0x20000
  s_mov_b32 s68, s80
  s_mov_b32 s69, s81
  s_mov_b32 s70, 2457600
  s_mov_b32 s71, 0x20000
  s_mov_b32 s64, s82
  s_mov_b32 s65, s83
  s_mov_b32 s66, 819200
  s_mov_b32 s67, 0x20000
  s_mov_b32 s60, s88
  s_mov_b32 s61, s89
  s_mov_b32 s62, 2211840
  s_mov_b32 s63, 0x20000
  s_mov_b32 s12, s32
  s_mov_b32 s13, s33
  s_mov_b32 s14, 2621440
  s_mov_b32 s15, 0x20000
  s_cmp_lt_u32 s22, 2
  s_cselect_b32 s56, s84, s86
  s_cselect_b32 s57, s85, s87
  s_mov_b32 s58, 2211840
  s_mov_b32 s59, 0x20000
  s_lshl_b32 s98, s20, 4
  s_add_u32 s98, s98, s21
  s_cmp_lg_u32 s2, 0
  s_cbranch_scc1 nz_1
  s_cmp_lg_u32 s22, 3
  s_cbranch_scc1 nz_1
  v_lshlrev_b32 v56, 7, v1
  v_mov_b32 v57, 0
  buffer_store_dword v57, v56, s[4:7], 0 offen sc1
  s_mov_b32 s3, 40960
  s_mov_b32 exec_hi, 0
  buffer_store_dword v57, v56, s[4:7], s3 offen sc1
  s_mov_b32 exec_hi, -1
nz_1:
  v_and_b32 v51, 7, v1
  v_lshrrev_b32 v52, 3, v1
  s_and_b32 s34, s20, 1
  s_lshr_b32 s35, s20, 1
  s_cmp_eq_u32 s34, 0
  s_cselect_b32 s31, 5, 3
  s_mov_b32 s32, 1312
  s_cmov_b32 s32, 2560
  s_mov_b32 s33, -48
  s_cmov_b32 s33, 1184
  s_mov_b32 s36, -1
  s_cmov_b32 s36, 3755991007
  v_mov_b32 v53, s32
  v_mov_b32 v54, s33
  v_cmp_gt_u32 vcc, s31, v51
  s_nop 1
  v_cndmask_b32 v53, v54, v53, vcc
  v_lshl_add_u32 v53, v51, 4, v53
  v_mul_u32_u24 v54, 3840, v52
  v_add_u32 v53, v53, v54
  s_mul_i32 s31, s35, 80*3840
  s_mul_i32 s32, s21, 80
  s_add_u32 s31, s31, s32
  s_mov_b32 exec_lo, s36
  s_mov_b32 exec_hi, s36
  s_add_u32 s32, s22, 0
  s_min_u32 s32, s32, 9
  s_lshl_b32 m0, s32, 10
  s_mul_i32 s32, s32, 8*3840
  s_add_u32 s32, s32, s31
  buffer_load_dwordx4 v53, s[68:71], s32 offen  lds
  s_add_u32 s32, s22, 4
  s_min_u32 s32, s32, 9
  s_lshl_b32 m0, s32, 10
  s_mul_i32 s32, s32, 8*3840
  s_add_u32 s32, s32, s31
  buffer_load_dwordx4 v53, s[68:71], s32 offen  lds
  s_add_u32 s32, s22, 8
  s_min_u32 s32, s32, 9
  s_lshl_b32 m0, s32, 10
  s_mul_i32 s32, s32, 8*3840
  s_add_u32 s32, s32, s31
  buffer_load_dwordx4 v53, s[68:71], s32 offen  lds
  s_mov_b64 exec, -1
  s_lshr_b32 s99, s98, 3
  s_and_b32 s100, s98, 7
  s_mul_i32 s30, s99, 32*1280
  s_mul_i32 s31, s100, 160
  s_add_u32 s30, s30, s31
  s_cmp_ge_u32 s98, 160
  s_cmov_b32 s30, 2146435072
  s_add_u32 s31, s22, 0
  s_min_u32 s31, s31, 4
  s_lshl_b32 s3, s31, 6
  v_add_u32 v54, s3, v1
  v_mul_u32_u24 v55, 6554, v54
  v_lshrrev_b32 v55, 16, v55
  v_mul_u32_u24 v56, 10, v55
  v_sub_u32 v56, v54, v56
  v_mul_u32_u24 v55, 1280, v55
  v_lshl_add_u32 v55, v56, 4, v55
  s_lshl_b32 s31, s31, 10
  s_add_u32 m0, s31, 155648
  s_nop 0
  buffer_load_dwordx4 v55, s[64:67], s30 offen  lds
  s_add_u32 s31, s22, 4
  s_min_u32 s31, s31, 4
  s_lshl_b32 s3, s31, 6
  v_add_u32 v54, s3, v1
  v_mul_u32_u24 v55, 6554, v54
  v_lshrrev_b32 v55, 16, v55
  v_mul_u32_u24 v56, 10, v55
  v_sub_u32 v56, v54, v56
  v_mul_u32_u24 v55, 1280, v55
  v_lshl_add_u32 v55, v56, 4, v55
  s_lshl_b32 s31, s31, 10
  s_add_u32 m0, s31, 155648
  s_nop 0
  buffer_load_dwordx4 v55, s[64:67], s30 offen  lds
  v_lshrrev_b32 v46, 4, v1
  v_and_b32 v48, 15, v1
  v_add_u32 v49, 0, v46
  v_xor_b32 v50, v48, v49
  v_mul_u32_u24 v49, 1280, v49
  v_lshl_add_u32 v129, v50, 4, v49
  v_add_u32 v49, 4, v46
  v_xor_b32 v50, v48, v49
  v_mul_u32_u24 v49, 1280, v49
  v_lshl_add_u32 v130, v50, 4, v49
  v_add_u32 v49, 8, v46
  v_xor_b32 v50, v48, v49
  v_mul_u32_u24 v49, 1280, v49
  v_lshl_add_u32 v131, v50, 4, v49
  v_add_u32 v49, 12, v46
  v_xor_b32 v50, v48, v49
  v_mul_u32_u24 v49, 1280, v49
  v_lshl_add_u32 v132, v50, 4, v49
  s_lshl_b32 s3, s20, 2
  s_add_u32 s3, s3, s22
  s_mul_i32 s28, s3, 32*1280
  s_mul_i32 s29, s22, 24576
  s_add_u32 s29, s29, 49152
  s_getpc_b64 s[64:65]
main_pc:
  s_sub_u32 s64, s64, main_pc - interleave_layers__sliding_block__glu_gated_reglu__prompt_kernel
  s_subb_u32 s65, s65, 0
  s_mov_b32 s66, main_last - interleave_layers__sliding_block__glu_gated_reglu__prompt_kernel
  s_mov_b32 s67, 0x20000
  s_and_b32 s3, s21, 7
  s_lshl_b32 s3, s3, 13
  s_cmp_lg_u32 s22, 3
  s_cmov_b32 s3, 2146435072
  v_lshlrev_b32 v54, 7, v1
  buffer_load_dword v43, v54, s[64:67], s3 offen
  v_mov_b32 v56, 0x3f803f80
  v_mov_b32 v57, 0x3f803f80
  v_mov_b32 v58, 0x3f803f80
  v_mov_b32 v59, 0x3f803f80
  s_cmp_lg_u32 s34, 0
  s_cbranch_scc1 np_3
  v_lshlrev_b32 v48, 7, v0
  v_cmp_gt_u32 vcc, 80, v0
  s_nop 0
  s_and_saveexec_b64 s[36:37], vcc
  s_cbranch_execz np_3a
  ds_write_b128 v48, v[56:59] offset:80
np_3a:
  s_mov_b64 exec, s[36:37]
np_3:
  s_add_u32 s37, s28, 0
  s_add_u32 m0, s29, 0
  s_nop 0
  buffer_load_dwordx4 v129, s[8:11], s37 offen  lds
  s_add_u32 m0, s29, 1024
  s_cmp_ge_u32 s99, 10
  s_cselect_b32 s30, 1, 0
  s_cselect_b32 s31, 10, 0
  s_sub_u32 s31, s99, s31
  s_lshl_b32 s31, s31, 1
  s_add_u32 s31, s31, s30
  s_mul_i32 s31, s31, 5120
  s_mul_i32 s30, s100, 102400
  s_add_u32 s30, s30, s31
  buffer_load_dwordx4 v130, s[8:11], s37 offen  lds
  s_add_u32 m0, s29, 2048
  s_add_u32 s30, s30, 3670016
  s_cmp_ge_u32 s98, 160
  s_cmov_b32 s30, 2146435072
  v_bfe_u32 v44, v1, 2, 2
  v_and_b32 v45, 3, v1
  v_lshrrev_b32 v48, 1, v46
  v_lshl_add_u32 v48, v48, 2, v44
  v_lshlrev_b32 v48, 7, v48
  v_and_b32 v49, 1, v46
  buffer_load_dwordx4 v131, s[8:11], s37 offen  lds
  s_add_u32 m0, s29, 3072
  v_lshl_add_u32 v49, v49, 2, v45
  v_lshl_add_u32 v48, v49, 3, v48
  s_lshl_b32 s3, s22, 6
  v_add_u32 v134, s3, v48
  v_lshl_add_u32 v135, v46, 3, v44
  v_mul_u32_u24 v135, 160, v135
  v_lshl_add_u32 v135, v45, 3, v135
  v_add_u32 v135, 155648, v135
  v_mov_b32 v136, 0
  buffer_load_dwordx4 v132, s[8:11], s37 offen  lds
  s_add_u32 s37, s28, 20480
  s_add_u32 m0, s29, 4096
  v_and_b32 v164, 7, v1
  v_lshrrev_b32 v165, 3, v1
  v_mul_u32_u24 v160, 3456, v165
  v_lshl_add_u32 v160, v164, 4, v160
  s_and_b32 s99, s98, 7
  s_mul_i32 s99, s99, 80
  s_mul_i32 s100, s27, 40
  s_add_u32 s99, s99, s100
  s_mul_i32 s99, s99, 3456
  buffer_load_dwordx4 v129, s[8:11], s37 offen  lds
  s_add_u32 m0, s29, 5120
  s_lshr_b32 s100, s98, 3
  s_lshl_b32 s100, s100, 7
  s_add_u32 s99, s99, s100
  s_lshr_b32 s100, s98, 2
  s_mul_i32 s100, s100, 32*1280
  s_and_b32 s101, s98, 3
  s_mul_i32 s101, s101, 320
  s_add_u32 s100, s100, s101
  s_cmp_ge_u32 s98, 216
  s_cmov_b32 s99, 2146435072
  s_cmov_b32 s100, 2146435072
  buffer_load_dwordx4 v130, s[8:11], s37 offen  lds
  s_add_u32 m0, s29, 6144
  s_add_u32 s101, s22, 0
  s_min_u32 s101, s101, 9
  s_lshl_b32 s101, s101, 6
  v_add_u32 v164, s101, v1
  v_mul_u32_u24 v165, 3277, v164
  v_lshrrev_b32 v165, 16, v165
  v_mul_u32_u24 v166, 20, v165
  v_sub_u32 v166, v164, v166
  v_mul_u32_u24 v165, 1280, v165
  buffer_load_dwordx4 v131, s[8:11], s37 offen  lds
  s_add_u32 m0, s29, 7168
  v_lshl_add_u32 v161, v166, 4, v165
  s_add_u32 s101, s22, 4
  s_min_u32 s101, s101, 9
  s_lshl_b32 s101, s101, 6
  v_add_u32 v164, s101, v1
  v_mul_u32_u24 v165, 3277, v164
  v_lshrrev_b32 v165, 16, v165
  v_mul_u32_u24 v166, 20, v165
  v_sub_u32 v166, v164, v166
  buffer_load_dwordx4 v132, s[8:11], s37 offen  lds
  v_mul_u32_u24 v165, 1280, v165
  v_lshl_add_u32 v162, v166, 4, v165
  s_add_u32 s101, s22, 8
  s_min_u32 s101, s101, 9
  s_lshl_b32 s101, s101, 6
  v_add_u32 v164, s101, v1
  v_mul_u32_u24 v165, 3277, v164
  v_lshrrev_b32 v165, 16, v165
  v_mul_u32_u24 v166, 20, v165
  v_sub_u32 v166, v164, v166
  v_mul_u32_u24 v165, 1280, v165
  v_lshl_add_u32 v163, v166, 4, v165
  s_cmp_lg_u32 s2, 0
  s_cbranch_scc1 nz_2
  s_cmp_lg_u32 s22, 3
  s_cbranch_scc1 nz_2
  s_waitcnt vmcnt(14)
  s_mov_b64 exec, 1
  v_mov_b32 v60, 0
  v_mov_b32 v61, 1
  buffer_store_dword v61, v60, s[16:19], 0 offen sc1
  s_mov_b64 exec, -1
nz_2:
  s_add_u32 s37, s28, 256
  s_add_u32 m0, s29, 8192
  s_nop 0
  buffer_load_dwordx4 v129, s[8:11], s37 offen  lds
  s_add_u32 m0, s29, 9216
  v_and_b32 v48, 31, v1
  v_and_b32 v49, 15, v1
  v_lshlrev_b32 v133, 8, v48
  v_lshl_add_u32 v133, v49, 4, v133
  v_lshrrev_b32 v49, 5, v1
  v_lshl_add_u32 v133, v49, 3, v133
  v_add_u32 v133, s29, v133
  s_lshl_b32 s3, s20, 4
  s_add_u32 s3, s3, s21
  s_mul_i32 s44, s3, 23552
  s_add_u32 s44, s44, 14942208
  s_lshl_b32 s3, s20, 2
  buffer_load_dwordx4 v130, s[8:11], s37 offen  lds
  s_add_u32 m0, s29, 10240
  s_lshl_b32 s90, s24, 1
  s_add_u32 s3, s3, s90
  s_add_u32 s3, s3, s26
  s_mul_i32 s47, s3, 40960
  s_mul_i32 s90, s25, 5120
  s_add_u32 s47, s47, s90
  s_lshl_b32 s48, s3, 3
  s_add_u32 s48, s48, s25
  s_lshl_b32 s48, s48, 8
  s_lshl_b32 s3, s3, 1
  s_add_u32 s45, s3, s27
  s_xor_b32 s46, s45, 1
  buffer_load_dwordx4 v131, s[8:11], s37 offen  lds
  s_add_u32 m0, s29, 11264
  v_add_u32 v30, 0x10000, v2
  v_add_u32 v31, 0x20000, v2
  s_lshl_b32 s3, s21, 7
  s_add_u32 s3, s3, 4096
  v_mov_b32 v53, s3
  v_mov_b32 v62, s3
  s_lshl_b32 s3, s25, 7
  s_add_u32 s3, s3, 6144
  v_writelane_b32 v53, s3, 1
  v_mov_b32 v54, 16
  v_writelane_b32 v54, 20, 1
  s_and_b32 s3, s98, 7
  buffer_load_dwordx4 v132, s[8:11], s37 offen  lds
  s_add_u32 s37, s28, 20736
  s_add_u32 m0, s29, 12288
  s_lshl_b32 s3, s3, 7
  s_add_u32 s3, s3, 6144
  v_writelane_b32 v62, s3, 1
  v_mov_b32 v63, 1
  s_lshl_b32 s88, s45, 4
  s_mul_i32 s88, s88, 1280
  s_mul_i32 s3, s25, 160
  s_add_u32 s88, s88, s3
  s_mul_i32 s89, s22, 2560
  s_add_u32 s89, s89, 151552
  v_and_b32 v250, 15, v1
  v_mul_u32_u24 v250, 160, v250
  buffer_load_dwordx4 v129, s[8:11], s37 offen  lds
  s_add_u32 m0, s29, 13312
  v_lshrrev_b32 v48, 4, v1
  v_lshl_add_u32 v250, v48, 3, v250
  v_add_u32 v250, s89, v250
  v_add_u32 v48, 0, v1
  v_mul_u32_u24 v49, 6554, v48
  v_lshrrev_b32 v49, 16, v49
  v_mul_u32_u24 v50, 10, v49
  v_sub_u32 v50, v48, v50
  v_mul_u32_u24 v49, 1280, v49
  v_lshl_add_u32 v140, v50, 4, v49
  v_add_u32 v48, 64, v1
  v_mul_u32_u24 v49, 6554, v48
  buffer_load_dwordx4 v130, s[8:11], s37 offen  lds
  s_add_u32 m0, s29, 14336
  v_lshrrev_b32 v49, 16, v49
  v_mul_u32_u24 v50, 10, v49
  v_sub_u32 v50, v48, v50
  v_mul_u32_u24 v49, 1280, v49
  v_lshl_add_u32 v141, v50, 4, v49
  v_add_u32 v48, 128, v1
  v_mul_u32_u24 v49, 6554, v48
  v_lshrrev_b32 v49, 16, v49
  v_mul_u32_u24 v50, 10, v49
  v_sub_u32 v50, v48, v50
  v_mul_u32_u24 v49, 1280, v49
  v_lshl_add_u32 v142, v50, 4, v49
  buffer_load_dwordx4 v131, s[8:11], s37 offen  lds
  s_add_u32 m0, s29, 15360
  v_and_b32 v48, 127, v0
  v_lshrrev_b32 v49, 5, v48
  v_and_b32 v50, 31, v48
  v_lshlrev_b32 v50, 2, v50
  v_lshl_add_u32 v248, v49, 10, v50
  v_lshrrev_b32 v249, 5, v48
  v_lshlrev_b32 v249, 10, v249
  v_bfe_u32 v49, v48, 2, 2
  v_lshl_add_u32 v249, v49, 7, v249
  v_bfe_u32 v49, v48, 4, 1
  v_lshl_add_u32 v249, v49, 6, v249
  v_and_b32 v49, 3, v48
  buffer_load_dwordx4 v132, s[8:11], s37 offen  lds
  v_lshl_add_u32 v249, v49, 4, v249
  v_add_u32 v249, 147456, v249
  v_bfe_u32 v44, v1, 2, 2
  v_and_b32 v45, 3, v1
  v_lshrrev_b32 v46, 4, v1
  v_lshrrev_b32 v47, 1, v46
  v_lshl_add_u32 v47, v47, 2, v44
  v_lshlrev_b32 v47, 7, v47
  v_and_b32 v48, 1, v45
  v_lshl_add_u32 v47, v48, 4, v47
  v_and_b32 v48, 1, v46
  v_lshl_add_u32 v47, v48, 3, v47
  v_lshrrev_b32 v48, 1, v45
  v_mul_u32_u24 v48, 10240, v48
  v_add_u32 v47, v47, v48
  s_lshl_b32 s3, s22, 5
  s_add_u32 s3, s3, 16384
  v_add_u32 v47, s3, v47
  v_lshl_add_u32 v49, v46, 3, v44
  v_mul_u32_u24 v49, 320, v49
  v_lshl_add_u32 v49, v45, 3, v49
  s_mul_i32 s81, s27, 160
  s_mul_i32 s3, s26, 96
  s_add_u32 s81, s81, s3
  s_add_u32 s81, s81, 36864
  v_add_u32 v49, s81, v49
  s_lshl_b32 s3, s26, 5
  v_subrev_u32 v50, s3, v49
  s_lshr_b32 s81, s98, 2
  s_lshl_b32 s81, s81, 1
  s_add_u32 s81, s81, 0
  s_mul_i32 s82, s81, 147
  s_lshr_b32 s82, s82, 10
  s_mul_i32 s83, s82, 7
  s_sub_u32 s83, s81, s83
  s_lshl_b32 s81, s82, 2
  s_mul_i32 s82, s82, 3
  s_add_u32 s82, s82, 59
  s_cmp_lt_u32 s83, 4
  s_cselect_b32 s82, s81, s82
  s_add_u32 s82, s82, s83
  s_lshr_b32 s81, s82, 3
  s_lshl_b32 s81, s81, 2
  s_and_b32 s83, s82, 2
  s_add_u32 s81, s81, s83
  s_bfe_u32 s83, s82, 0x10002
  s_add_u32 s81, s81, s83
  s_mul_i32 s81, s81, 5120
  s_and_b32 s82, s82, 1
  s_lshl_b32 s82, s82, 9
  s_add_u32 s81, s81, s82
  v_mov_b32 v51, s81
  s_lshr_b32 s81, s98, 2
  s_lshl_b32 s81, s81, 1
  s_add_u32 s81, s81, 1
  s_mul_i32 s82, s81, 147
  s_lshr_b32 s82, s82, 10
  s_mul_i32 s83, s82, 7
  s_sub_u32 s83, s81, s83
  s_lshl_b32 s81, s82, 2
  s_mul_i32 s82, s82, 3
  s_add_u32 s82, s82, 59
  s_cmp_lt_u32 s83, 4
  s_cselect_b32 s82, s81, s82
  s_add_u32 s82, s82, s83
  s_lshr_b32 s81, s82, 3
  s_lshl_b32 s81, s81, 2
  s_and_b32 s83, s82, 2
  s_add_u32 s81, s81, s83
  s_bfe_u32 s83, s82, 0x10002
  s_add_u32 s81, s81, s83
  s_mul_i32 s81, s81, 5120
  s_and_b32 s82, s82, 1
  s_lshl_b32 s82, s82, 9
  s_add_u32 s81, s81, s82
  v_mov_b32 v52, s81
  s_mov_b32 exec_lo, 0
  v_mov_b32 v51, v52
  s_mov_b32 exec_lo, -1
  v_and_b32 v52, 31, v1
  v_lshl_add_u32 v51, v52, 4, v51
  v_lshrrev_b32 v52, 5, v1
  v_lshlrev_b32 v52, 6, v52
  s_and_b32 s86, s98, 7
  s_lshr_b32 s83, s98, 3
  s_lshl_b32 s83, s83, 2
  s_add_u32 s83, s83, s22
  s_mul_i32 s87, s83, 147
  s_lshr_b32 s87, s87, 10
  s_mul_i32 s81, s87, 7
  s_sub_u32 s81, s83, s81
  s_mov_b32 s82, 0
  s_mov_b32 s85, 4
  s_cmp_ge_u32 s81, 4
  s_cselect_b32 s82, 4, s82
  s_cselect_b32 s85, 3, s85
  s_mul_i32 s87, s87, 286720
  s_mul_i32 s84, s82, 39
  s_add_u32 s84, s84, s81
  s_mul_i32 s82, s86, 5
  s_mul_i32 s82, s82, s85
  s_add_u32 s84, s84, s82
  s_lshl_b32 s84, s84, 10
  s_add_u32 s84, s84, s87
  s_add_u32 s84, s84, 4489216
  s_lshl_b32 s85, s85, 10
  s_lshl_b32 s83, s83, 3
  s_add_u32 s83, s83, s86
  s_lshl_b32 s83, s83, 7
  s_add_u32 s83, s83, 131072
  s_and_b32 s82, s98, 3
  s_lshl_b32 s82, s82, 1
  s_add_u32 s82, s82, s27
  s_mul_i32 s82, s82, 286720
  s_mul_i32 s81, s26, 3072
  s_add_u32 s82, s82, s81
  s_add_u32 s82, s82, 9076736
  s_cmp_ge_u32 s98, 216
  s_cmov_b32 s84, 2146435072
  s_cmov_b32 s83, 2146435072
  s_cmov_b32 s82, 2146435072
  s_lshl_b32 s81, s26, 10
  s_sub_u32 s81, s82, s81
  s_sub_u32 s86, s98, 216
  s_lshl_b32 s86, s86, 12
  s_add_u32 s86, s86, 8793088
  s_lshl_b32 s87, s22, 8
  s_sub_u32 s87, s98, s87
  s_cmp_ge_i32 s87, 216
  s_cmov_b32 s84, s86
  s_cmov_b32 s85, 0x20000000
  s_waitcnt vmcnt(17)
  s_waitcnt lgkmcnt(0)
  s_barrier
  s_cmp_ge_u32 s22, 2
  s_cbranch_scc1 hi_4
  s_lshl_b32 s32, s34, 1
  s_add_u32 s32, s32, s22
  s_mul_i32 s3, s32, 40
  s_cmp_lt_u32 s32, 2
  s_cselect_b32 s3, s32, s3
  s_mov_b32 s36, 1024
  s_cmov_b32 s36, 2048
  s_lshl_b32 s3, s3, 10
  s_mul_i32 s33, s35, 5
  s_mul_i32 s33, s33, s36
  s_add_u32 s33, s33, s49
  s_add_u32 s30, s33, s3
  s_lshl_b32 s33, s21, 2
  s_add_u32 s33, s33, s32
  s_lshl_b32 s33, s33, 3
  s_add_u32 s33, s33, s35
  s_lshl_b32 s33, s33, 7
  s_add_u32 s33, s33, 65536
  s_add_u32 s31, s30, s36
  s_add_u32 s32, s31, s36
  s_add_u32 s34, s32, s36
  s_add_u32 s35, s34, s36
  ds_read_b64_tr_b16 v[64:65], v134 offset:0
  ds_read_b64_tr_b16 v[66:67], v134 offset:2048
  ds_read_b64_tr_b16 v[68:69], v134 offset:1024
  ds_read_b64_tr_b16 v[70:71], v134 offset:3072
  ds_read_b64_tr_b16 v[72:73], v134 offset:4096
  ds_read_b64_tr_b16 v[74:75], v134 offset:6144
  ds_read_b64_tr_b16 v[76:77], v134 offset:5120
  ds_read_b64_tr_b16 v[78:79], v134 offset:7168
  ds_read_b64_tr_b16 v[80:81], v134 offset:8192
  ds_read_b64_tr_b16 v[82:83], v134 offset:9216
  s_waitcnt lgkmcnt(8)
  buffer_store_dwordx4 v[64:67], v2, s[4:7], s30 offen offset:0 sc1
  v_mfma_f32_32x32x16_bf16 v[88:103], v[64:67], v[56:59], 0
  s_waitcnt lgkmcnt(6)
  buffer_store_dwordx4 v[68:71], v2, s[4:7], s31 offen offset:0 sc1
  v_mfma_f32_32x32x16_bf16 v[88:103], v[68:71], v[56:59], v[88:103]
  s_waitcnt lgkmcnt(4)
  buffer_store_dwordx4 v[72:75], v2, s[4:7], s32 offen offset:0 sc1
  v_mfma_f32_32x32x16_bf16 v[88:103], v[72:75], v[56:59], v[88:103]
  s_waitcnt lgkmcnt(2)
  buffer_store_dwordx4 v[76:79], v2, s[4:7], s34 offen offset:0 sc1
  v_mfma_f32_32x32x16_bf16 v[88:103], v[76:79], v[56:59], v[88:103]
  s_waitcnt lgkmcnt(0)
  buffer_store_dwordx4 v[80:83], v2, s[4:7], s35 offen offset:0 sc1
  v_mfma_f32_32x32x16_bf16 v[88:103], v[80:83], v[56:59], v[88:103]
  v_lshrrev_b32 v84, 9, v2
  v_lshlrev_b32 v84, 6, v84
  s_nop 7
  s_mov_b32 exec_lo, 1
  s_mov_b32 exec_hi, 1
  buffer_store_dwordx4 v[88:91], v84, s[4:7], s33 offen offset:0 sc1
  buffer_store_dwordx4 v[92:95], v84, s[4:7], s33 offen offset:16 sc1
  buffer_store_dwordx4 v[96:99], v84, s[4:7], s33 offen offset:32 sc1
  buffer_store_dwordx4 v[100:103], v84, s[4:7], s33 offen offset:48 sc1
  s_mov_b64 exec, -1
  s_branch dn_5
hi_4:
  s_cmp_lg_u32 s22, 2
  s_cmov_b32 s30, 2146435072
  s_add_u32 s31, s30, 4096
  s_mov_b32 s32, 2146435072
  ds_read_b64_tr_b16 v[64:65], v135 offset:0
  ds_read_b64_tr_b16 v[66:67], v135 offset:640
  ds_read_b64_tr_b16 v[68:69], v135 offset:32
  ds_read_b64_tr_b16 v[70:71], v135 offset:672
  ds_read_b64_tr_b16 v[72:73], v135 offset:64
  ds_read_b64_tr_b16 v[74:75], v135 offset:704
  ds_read_b64_tr_b16 v[76:77], v135 offset:96
  ds_read_b64_tr_b16 v[78:79], v135 offset:736
  ds_read_b64_tr_b16 v[80:81], v135 offset:128
  ds_read_b64_tr_b16 v[82:83], v135 offset:768
  s_waitcnt lgkmcnt(0)
  buffer_store_dwordx4 v[64:67], v2, s[4:7], s30 offen offset:0 sc1
  buffer_store_dwordx4 v[68:71], v2, s[4:7], s30 offen offset:1024 sc1
  buffer_store_dwordx4 v[72:75], v2, s[4:7], s30 offen offset:2048 sc1
  buffer_store_dwordx4 v[76:79], v2, s[4:7], s30 offen offset:3072 sc1
  buffer_store_dwordx4 v[80:83], v2, s[4:7], s31 offen offset:0 sc1
  s_mov_b64 exec, 1
  buffer_store_dword v64, v2, s[4:7], s32 offen
  buffer_store_dword v64, v2, s[4:7], s32 offen
  buffer_store_dword v64, v2, s[4:7], s32 offen
  buffer_store_dword v64, v2, s[4:7], s32 offen
  s_mov_b64 exec, -1
dn_5:
  s_lshl_b32 s3, s98, 7
  s_add_u32 s3, s3, 8192
  s_cmp_lg_u32 s22, 0
  s_cmov_b32 s3, 2146435072
  s_mov_b64 exec, 1
  buffer_store_dword v136, v136, s[4:7], s3 offen sc1
  s_lshl_b32 s3, s22, 8
  buffer_load_dword v61, v136, s[16:19], s3 offen sc1
  s_mov_b64 exec, -1
  s_waitcnt vmcnt(19)
  v_xor_b32 v138, 0, v133
  ds_read_b64 a[0:1], v138 offset:0
  v_xor_b32 v139, 16, v133
  ds_read_b64 a[4:5], v139 offset:0
  s_add_u32 s37, s28, 512
  s_add_u32 m0, s29, 16384
  s_nop 0
  buffer_load_dwordx4 v129, s[8:11], s37 offen  lds
  s_add_u32 m0, s29, 17408
  v_xor_b32 v138, 32, v133
  ds_read_b64 a[2:3], v138 offset:0
  v_xor_b32 v139, 48, v133
  ds_read_b64 a[6:7], v139 offset:0
  buffer_load_dwordx4 v130, s[8:11], s37 offen  lds
  s_add_u32 m0, s29, 18432
  v_xor_b32 v138, 64, v133
  ds_read_b64 a[8:9], v138 offset:0
  v_xor_b32 v139, 80, v133
  ds_read_b64 a[12:13], v139 offset:0
  buffer_load_dwordx4 v131, s[8:11], s37 offen  lds
  s_add_u32 m0, s29, 19456
  v_xor_b32 v138, 96, v133
  ds_read_b64 a[10:11], v138 offset:0
  v_xor_b32 v139, 112, v133
  ds_read_b64 a[14:15], v139 offset:0
  buffer_load_dwordx4 v132, s[8:11], s37 offen  lds
  s_add_u32 s37, s28, 20992
  s_add_u32 m0, s29, 20480
  v_xor_b32 v138, 128, v133
  ds_read_b64 a[16:17], v138 offset:0
  v_xor_b32 v139, 144, v133
  ds_read_b64 a[18:19], v139 offset:0
  buffer_load_dwordx4 v129, s[8:11], s37 offen  lds
  s_add_u32 m0, s29, 21504
  v_xor_b32 v138, 160, v133
  ds_read_b64 a[20:21], v138 offset:0
  v_xor_b32 v139, 176, v133
  ds_read_b64 a[24:25], v139 offset:0
  buffer_load_dwordx4 v130, s[8:11], s37 offen  lds
  s_add_u32 m0, s29, 22528
  v_xor_b32 v138, 192, v133
  ds_read_b64 a[22:23], v138 offset:0
  v_xor_b32 v139, 208, v133
  ds_read_b64 a[26:27], v139 offset:0
  buffer_load_dwordx4 v131, s[8:11], s37 offen  lds
  s_add_u32 m0, s29, 23552
  v_xor_b32 v138, 224, v133
  ds_read_b64 a[28:29], v138 offset:0
  v_xor_b32 v139, 240, v133
  ds_read_b64 a[32:33], v139 offset:0
  buffer_load_dwordx4 v132, s[8:11], s37 offen  lds
  s_waitcnt lgkmcnt(0)
  s_mul_i32 s101, s22, 5120
  s_add_u32 m0, s101, 16384
  s_nop 0
  buffer_load_dwordx4 v160, s[56:59], s99 offen nt lds
  s_add_u32 s99, s99, 27648
  s_add_u32 m0, s101, 17408
  s_nop 0
  buffer_load_dwordx4 v160, s[56:59], s99 offen nt lds
  s_add_u32 s99, s99, 27648
  s_add_u32 m0, s101, 18432
  s_nop 0
  buffer_load_dwordx4 v160, s[56:59], s99 offen nt lds
  s_add_u32 s99, s99, 27648
  s_add_u32 m0, s101, 19456
  s_nop 0
  buffer_load_dwordx4 v160, s[56:59], s99 offen nt lds
  s_add_u32 s99, s99, 27648
  s_add_u32 m0, s101, 20480
  s_nop 0
  buffer_load_dwordx4 v160, s[56:59], s99 offen nt lds
  s_add_u32 s101, s22, 0
  s_min_u32 s101, s101, 9
  s_lshl_b32 s101, s101, 10
  s_add_u32 m0, s101, 36864
  s_nop 0
  buffer_load_dwordx4 v161, s[60:63], s100 offen nt lds
  s_add_u32 s101, s22, 4
  s_min_u32 s101, s101, 9
  s_lshl_b32 s101, s101, 10
  s_add_u32 m0, s101, 36864
  s_nop 0
  buffer_load_dwordx4 v162, s[60:63], s100 offen nt lds
  s_add_u32 s101, s22, 8
  s_min_u32 s101, s101, 9
  s_lshl_b32 s101, s101, 10
  s_add_u32 m0, s101, 36864
  s_nop 0
  buffer_load_dwordx4 v163, s[60:63], s100 offen nt lds
  s_waitcnt vmcnt(16)
  s_barrier
  s_cmp_lg_u32 s22, 0
  s_cbranch_scc1 w_6
  s_mov_b64 exec, 1
  v_cmp_gt_u32 vcc, 1, v61
  s_cbranch_vccz oki_7
  s_mov_b32 s30, 20000
  buffer_load_dword v254, v136, s[16:19], 0 offen sc1
poll_8:
  s_sleep 5
  buffer_load_dword v255, v136, s[16:19], 0 offen sc1
  s_waitcnt vmcnt(1)
  v_cmp_gt_u32 vcc, 1, v254
  s_cbranch_vccz pdone_9
  s_sleep 5
  buffer_load_dword v254, v136, s[16:19], 0 offen sc1
  s_waitcnt vmcnt(1)
  v_cmp_gt_u32 vcc, 1, v255
  s_cbranch_vccz pdone_9
  s_sub_u32 s30, s30, 1
  s_cmp_lg_u32 s30, 0
  s_cbranch_scc1 poll_8
  s_waitcnt vmcnt(0)
  v_mov_b32 v254, 16
  v_mov_b32 v255, 128
  buffer_store_dword v254, v255, s[16:19], 0 offen
pdone_9:
oki_7:
  s_cmp_lt_u32 s98, 160
  s_cselect_b32 exec_lo, 3, 1
  buffer_atomic_add v63, v62, s[4:7], 0 offen sc1
  s_mov_b64 exec, -1
w_6:
  v_xor_b32 v138, 0, v133
  ds_read_b64 a[30:31], v138 offset:8192
  v_xor_b32 v139, 16, v133
  ds_read_b64 a[34:35], v139 offset:8192
  s_add_u32 s37, s28, 768
  s_add_u32 m0, s29, 0
  s_nop 0
  buffer_load_dwordx4 v129, s[8:11], s37 offen  lds
  s_add_u32 m0, s29, 1024
  v_xor_b32 v138, 32, v133
  ds_read_b64 a[36:37], v138 offset:8192
  v_xor_b32 v139, 48, v133
  ds_read_b64 a[38:39], v139 offset:8192
  v_mfma_f32_32x32x16_bf16 v[176:191], a[0:3], a[0:3], 0
  buffer_load_dwordx4 v130, s[8:11], s37 offen  lds
  s_add_u32 m0, s29, 2048
  v_xor_b32 v138, 64, v133
  ds_read_b64 a[40:41], v138 offset:8192
  v_xor_b32 v139, 80, v133
  ds_read_b64 a[44:45], v139 offset:8192
  buffer_load_dwordx4 v131, s[8:11], s37 offen  lds
  s_add_u32 m0, s29, 3072
  v_xor_b32 v138, 96, v133
  ds_read_b64 a[42:43], v138 offset:8192
  v_xor_b32 v139, 112, v133
  ds_read_b64 a[46:47], v139 offset:8192
  v_mfma_f32_32x32x16_bf16 v[176:191], a[4:7], a[4:7], v[176:191]
  buffer_load_dwordx4 v132, s[8:11], s37 offen  lds
  s_add_u32 s37, s28, 21248
  s_add_u32 m0, s29, 4096
  v_xor_b32 v138, 128, v133
  ds_read_b64 a[48:49], v138 offset:8192
  v_xor_b32 v139, 144, v133
  ds_read_b64 a[52:53], v139 offset:8192
  buffer_load_dwordx4 v129, s[8:11], s37 offen  lds
  s_add_u32 m0, s29, 5120
  v_xor_b32 v138, 160, v133
  ds_read_b64 a[50:51], v138 offset:8192
  v_xor_b32 v139, 176, v133
  ds_read_b64 a[54:55], v139 offset:8192
  v_mfma_f32_32x32x16_bf16 v[176:191], a[8:11], a[8:11], v[176:191]
  buffer_load_dwordx4 v130, s[8:11], s37 offen  lds
  s_add_u32 m0, s29, 6144
  v_xor_b32 v138, 192, v133
  ds_read_b64 a[56:57], v138 offset:8192
  v_xor_b32 v139, 208, v133
  ds_read_b64 a[58:59], v139 offset:8192
  buffer_load_dwordx4 v131, s[8:11], s37 offen  lds
  s_add_u32 m0, s29, 7168
  v_xor_b32 v138, 224, v133
  ds_read_b64 a[60:61], v138 offset:8192
  v_xor_b32 v139, 240, v133
  ds_read_b64 a[64:65], v139 offset:8192
  v_mfma_f32_32x32x16_bf16 v[176:191], a[12:15], a[12:15], v[176:191]
  buffer_load_dwordx4 v132, s[8:11], s37 offen  lds
  s_waitcnt lgkmcnt(0)
  s_add_u32 s37, s28, 1024
  s_add_u32 m0, s29, 8192
  s_nop 0
  buffer_load_dwordx4 v129, s[8:11], s37 offen  lds
  v_mfma_f32_32x32x16_bf16 v[176:191], a[16:19], a[16:19], v[176:191]
  s_add_u32 m0, s29, 9216
  s_nop 0
  buffer_load_dwordx4 v130, s[8:11], s37 offen  lds
  s_add_u32 m0, s29, 10240
  v_mfma_f32_32x32x16_bf16 v[176:191], a[20:23], a[20:23], v[176:191]
  buffer_load_dwordx4 v131, s[8:11], s37 offen  lds
  s_add_u32 m0, s29, 11264
  v_mfma_f32_32x32x16_bf16 v[176:191], a[24:27], a[24:27], v[176:191]
  buffer_load_dwordx4 v132, s[8:11], s37 offen  lds
  s_add_u32 s37, s28, 21504
  s_add_u32 m0, s29, 12288
  v_mfma_f32_32x32x16_bf16 v[176:191], a[28:31], a[28:31], v[176:191]
  buffer_load_dwordx4 v129, s[8:11], s37 offen  lds
  s_add_u32 m0, s29, 13312
  v_mfma_f32_32x32x16_bf16 v[176:191], a[32:35], a[32:35], v[176:191]
  buffer_load_dwordx4 v130, s[8:11], s37 offen  lds
  s_add_u32 m0, s29, 14336
  v_mfma_f32_32x32x16_bf16 v[176:191], a[36:39], a[36:39], v[176:191]
  buffer_load_dwordx4 v131, s[8:11], s37 offen  lds
  s_add_u32 m0, s29, 15360
  v_mfma_f32_32x32x16_bf16 v[176:191], a[40:43], a[40:43], v[176:191]
  buffer_load_dwordx4 v132, s[8:11], s37 offen  lds
  s_add_u32 m0, s89, 0
  v_mfma_f32_32x32x16_bf16 v[176:191], a[44:47], a[44:47], v[176:191]
  buffer_load_dwordx4 v140, s[8:11], s88 offen lds
  s_add_u32 m0, s89, 1024
  v_mfma_f32_32x32x16_bf16 v[176:191], a[48:51], a[48:51], v[176:191]
  buffer_load_dwordx4 v141, s[8:11], s88 offen lds
  s_add_u32 m0, s89, 2048
  v_mfma_f32_32x32x16_bf16 v[176:191], a[52:55], a[52:55], v[176:191]
  s_mov_b32 exec_hi, 0
  buffer_load_dwordx4 v142, s[8:11], s88 offen lds
  s_mov_b32 exec_hi, -1
  v_mfma_f32_32x32x16_bf16 v[176:191], a[56:59], a[56:59], v[176:191]
  s_cmp_lg_u32 s22, 0
  s_cselect_b32 s3, 2146435072, 0
  s_mov_b64 exec, 3
  buffer_load_dword v55, v53, s[4:7], s3 offen sc1
  s_mov_b64 exec, -1
  s_waitcnt vmcnt(20)
  s_barrier
  ds_read_b64_tr_b16 v[192:193], v47 offset:0
  ds_read_b64_tr_b16 v[194:195], v47 offset:2048
  ds_read_b64_tr_b16 v[196:197], v47 offset:1024
  ds_read_b64_tr_b16 v[198:199], v47 offset:3072
  ds_read_b64_tr_b16 v[200:201], v47 offset:4096
  ds_read_b64_tr_b16 v[202:203], v47 offset:6144
  ds_read_b64_tr_b16 v[204:205], v47 offset:5120
  ds_read_b64_tr_b16 v[206:207], v47 offset:7168
  ds_read_b64_tr_b16 v[208:209], v47 offset:8192
  ds_read_b64_tr_b16 v[210:211], v47 offset:9216
  ds_read_b64_tr_b16 v[212:213], v49 offset:0
  ds_read_b64_tr_b16 v[214:215], v49 offset:1280
  ds_read_b64_tr_b16 v[216:217], v49 offset:32
  ds_read_b64_tr_b16 v[218:219], v49 offset:1312
  ds_read_b64_tr_b16 v[220:221], v50 offset:64
  ds_read_b64_tr_b16 v[222:223], v50 offset:1344
  s_waitcnt lgkmcnt(14)
  v_mfma_f32_32x32x16_bf16 v[224:239], v[192:195], v[56:59], 0
  s_waitcnt lgkmcnt(12)
  v_mfma_f32_32x32x16_bf16 v[224:239], v[196:199], v[56:59], v[224:239]
  s_waitcnt lgkmcnt(10)
  v_mfma_f32_32x32x16_bf16 v[224:239], v[200:203], v[56:59], v[224:239]
  s_waitcnt lgkmcnt(8)
  v_mfma_f32_32x32x16_bf16 v[224:239], v[204:207], v[56:59], v[224:239]
  s_waitcnt lgkmcnt(6)
  v_mfma_f32_32x32x16_bf16 v[224:239], v[208:211], v[56:59], v[224:239]
  s_waitcnt lgkmcnt(0)
  v_xor_b32 v138, 0, v133
  ds_read_b64 a[62:63], v138 offset:16384
  v_xor_b32 v139, 16, v133
  ds_read_b64 a[66:67], v139 offset:16384
  buffer_store_dwordx4 v[192:195], v2, s[4:7], s84 offen sc1
  s_add_u32 s84, s84, s85
  v_xor_b32 v138, 32, v133
  ds_read_b64 a[68:69], v138 offset:16384
  v_xor_b32 v139, 48, v133
  ds_read_b64 a[72:73], v139 offset:16384
  buffer_store_dwordx4 v[196:199], v2, s[4:7], s84 offen sc1
  s_add_u32 s84, s84, s85
  v_xor_b32 v138, 64, v133
  ds_read_b64 a[70:71], v138 offset:16384
  v_xor_b32 v139, 80, v133
  ds_read_b64 a[74:75], v139 offset:16384
  buffer_store_dwordx4 v[200:203], v2, s[4:7], s84 offen sc1
  s_add_u32 s84, s84, s85
  v_xor_b32 v138, 96, v133
  ds_read_b64 a[76:77], v138 offset:16384
  v_xor_b32 v139, 112, v133
  ds_read_b64 a[78:79], v139 offset:16384
  buffer_store_dwordx4 v[204:207], v2, s[4:7], s84 offen sc1
  s_add_u32 s84, s84, s85
  v_xor_b32 v138, 128, v133
  ds_read_b64 a[80:81], v138 offset:16384
  v_xor_b32 v139, 144, v133
  ds_read_b64 a[84:85], v139 offset:16384
  v_xor_b32 v138, 160, v133
  ds_read_b64 a[82:83], v138 offset:16384
  v_xor_b32 v139, 176, v133
  ds_read_b64 a[86:87], v139 offset:16384
  v_xor_b32 v138, 192, v133
  ds_read_b64 a[88:89], v138 offset:16384
  v_xor_b32 v139, 208, v133
  ds_read_b64 a[92:93], v139 offset:16384
  v_xor_b32 v138, 224, v133
  ds_read_b64 a[90:91], v138 offset:16384
  v_xor_b32 v139, 240, v133
  ds_read_b64 a[94:95], v139 offset:16384
  s_waitcnt lgkmcnt(0)
  s_waitcnt vmcnt(16)
  v_xor_b32 v138, 0, v133
  ds_read_b64 a[96:97], v138 offset:0
  v_xor_b32 v139, 16, v133
  ds_read_b64 a[98:99], v139 offset:0
  buffer_store_dwordx4 v[208:211], v2, s[4:7], s84 offen sc1
  v_xor_b32 v138, 32, v133
  ds_read_b64 a[100:101], v138 offset:0
  v_xor_b32 v139, 48, v133
  ds_read_b64 a[104:105], v139 offset:0
  v_mfma_f32_32x32x16_bf16 v[176:191], a[60:63], a[60:63], v[176:191]
  buffer_store_dwordx4 v[212:215], v51, s[4:7], s82 offen offset:0 sc1
  v_xor_b32 v138, 64, v133
  ds_read_b64 a[102:103], v138 offset:0
  v_xor_b32 v139, 80, v133
  ds_read_b64 a[106:107], v139 offset:0
  buffer_store_dwordx4 v[216:219], v51, s[4:7], s82 offen offset:1024 sc1
  v_xor_b32 v138, 96, v133
  ds_read_b64 a[108:109], v138 offset:0
  v_xor_b32 v139, 112, v133
  ds_read_b64 a[112:113], v139 offset:0
  v_mfma_f32_32x32x16_bf16 v[176:191], a[64:67], a[64:67], v[176:191]
  buffer_store_dwordx4 v[220:223], v51, s[4:7], s81 offen offset:2048 sc1
  v_xor_b32 v138, 128, v133
  ds_read_b64 a[110:111], v138 offset:0
  v_xor_b32 v139, 144, v133
  ds_read_b64 a[114:115], v139 offset:0
  s_mov_b32 exec_lo, 1
  s_mov_b32 exec_hi, 1
  buffer_store_dwordx4 v[224:227], v52, s[4:7], s83 offen offset:0 sc1
  s_mov_b64 exec, -1
  v_xor_b32 v138, 160, v133
  ds_read_b64 a[116:117], v138 offset:0
  v_xor_b32 v139, 176, v133
  ds_read_b64 a[118:119], v139 offset:0
  v_mfma_f32_32x32x16_bf16 v[176:191], a[68:71], a[68:71], v[176:191]
  s_mov_b32 exec_lo, 1
  s_mov_b32 exec_hi, 1
  buffer_store_dwordx4 v[228:231], v52, s[4:7], s83 offen offset:16 sc1
  s_mov_b64 exec, -1
  v_xor_b32 v138, 192, v133
  ds_read_b64 a[120:121], v138 offset:0
  v_xor_b32 v139, 208, v133
  ds_read_b64 a[124:125], v139 offset:0
  s_mov_b32 exec_lo, 1
  s_mov_b32 exec_hi, 1
  buffer_store_dwordx4 v[232:235], v52, s[4:7], s83 offen offset:32 sc1
  s_mov_b64 exec, -1
  v_xor_b32 v138, 224, v133
  ds_read_b64 a[122:123], v138 offset:0
  v_xor_b32 v139, 240, v133
  ds_read_b64 a[126:127], v139 offset:0
  v_mfma_f32_32x32x16_bf16 v[176:191], a[72:75], a[72:75], v[176:191]
  s_mov_b32 exec_lo, 1
  s_mov_b32 exec_hi, 1
  buffer_store_dwordx4 v[236:239], v52, s[4:7], s83 offen offset:48 sc1
  s_mov_b64 exec, -1
  s_waitcnt lgkmcnt(0)
  s_waitcnt vmcnt(16)
  v_xor_b32 v138, 0, v133
  ds_read_b64 a[128:129], v138 offset:8192
  v_xor_b32 v139, 16, v133
  ds_read_b64 a[132:133], v139 offset:8192
  v_mfma_f32_32x32x16_bf16 v[176:191], a[76:79], a[76:79], v[176:191]
  v_xor_b32 v138, 32, v133
  ds_read_b64 a[130:131], v138 offset:8192
  v_xor_b32 v139, 48, v133
  ds_read_b64 a[134:135], v139 offset:8192
  v_mfma_f32_32x32x16_bf16 v[176:191], a[80:83], a[80:83], v[176:191]
  v_xor_b32 v138, 64, v133
  ds_read_b64 a[136:137], v138 offset:8192
  v_xor_b32 v139, 80, v133
  ds_read_b64 a[138:139], v139 offset:8192
  v_mfma_f32_32x32x16_bf16 v[176:191], a[84:87], a[84:87], v[176:191]
  v_xor_b32 v138, 96, v133
  ds_read_b64 a[140:141], v138 offset:8192
  v_xor_b32 v139, 112, v133
  ds_read_b64 a[144:145], v139 offset:8192
  v_mfma_f32_32x32x16_bf16 v[176:191], a[88:91], a[88:91], v[176:191]
  v_xor_b32 v138, 128, v133
  ds_read_b64 a[142:143], v138 offset:8192
  v_xor_b32 v139, 144, v133
  ds_read_b64 a[146:147], v139 offset:8192
  v_mfma_f32_32x32x16_bf16 v[176:191], a[92:95], a[92:95], v[176:191]
  v_xor_b32 v138, 160, v133
  ds_read_b64 a[148:149], v138 offset:8192
  v_xor_b32 v139, 176, v133
  ds_read_b64 a[152:153], v139 offset:8192
  v_mfma_f32_32x32x16_bf16 v[176:191], a[96:99], a[96:99], v[176:191]
  v_xor_b32 v138, 192, v133
  ds_read_b64 a[150:151], v138 offset:8192
  v_xor_b32 v139, 208, v133
  ds_read_b64 a[154:155], v139 offset:8192
  v_mfma_f32_32x32x16_bf16 v[176:191], a[100:103], a[100:103], v[176:191]
  v_xor_b32 v138, 224, v133
  ds_read_b64 a[156:157], v138 offset:8192
  v_xor_b32 v139, 240, v133
  ds_read_b64 a[158:159], v139 offset:8192
  v_mfma_f32_32x32x16_bf16 v[176:191], a[104:107], a[104:107], v[176:191]
  s_waitcnt lgkmcnt(0)
  s_waitcnt vmcnt(12)
  ds_read_b64 v[4:5], v250 offset:0
  ds_read_b64 v[6:7], v250 offset:32
  ds_read_b64 v[8:9], v250 offset:64
  ds_read_b64 v[10:11], v250 offset:96
  ds_read_b64 v[12:13], v250 offset:128
  s_cmp_lg_u32 s22, 0
  s_cbranch_scc1 w_10
  s_mov_b64 exec, 3
  v_cmp_gt_u32 vcc, v54, v55
  s_cbranch_vccz w_10a
  s_mov_b32 s30, 20000
  buffer_load_dword v254, v53, s[4:7], 0 offen sc1
poll_11:
  s_sleep 5
  buffer_load_dword v255, v53, s[4:7], 0 offen sc1
  s_waitcnt vmcnt(1)
  v_cmp_gt_u32 vcc, v54, v254
  s_cbranch_vccz pdone_12
  s_sleep 5
  buffer_load_dword v254, v53, s[4:7], 0 offen sc1
  s_waitcnt vmcnt(1)
  v_cmp_gt_u32 vcc, v54, v255
  s_cbranch_vccz pdone_12
  s_sub_u32 s30, s30, 1
  s_cmp_lg_u32 s30, 0
  s_cbranch_scc1 poll_11
  s_waitcnt vmcnt(0)
  v_mov_b32 v254, 32
  v_mov_b32 v255, 128
  buffer_store_dword v254, v255, s[16:19], 0 offen
pdone_12:
w_10a:
  s_mov_b64 exec, -1
w_10:
  s_barrier
  s_mul_i32 s36, s22, 2048
  s_add_u32 s37, s36, s49
  s_add_u32 s37, s37, 0
  s_add_u32 m0, s36, 20480
  s_nop 0
  buffer_load_dwordx4 v2, s[4:7], s37 offen offset:0 sc1 lds
  v_and_b32 v44, 31, v1
  v_lshrrev_b32 v45, 5, v1
  v_and_b32 v46, 15, v1
  v_lshrrev_b32 v47, 4, v1
  v_lshlrev_b32 v3, 3, v44
  v_lshl_add_u32 v3, v45, 8, v3
  buffer_load_dwordx4 v2, s[4:7], s37 offen offset:1024 sc1 lds
  s_mul_i32 s36, s22, 2048
  s_add_u32 s37, s36, s49
  s_add_u32 s37, s37, 8192
  s_add_u32 m0, s36, 28672
  s_lshl_b32 s3, s20, 8
  v_mfma_f32_32x32x16_bf16 v[176:191], a[108:111], a[108:111], v[176:191]
  v_lshlrev_b32 v20, 7, v1
  v_add_u32 v20, s3, v20
  v_sub_u32 v21, s20, v1
  v_cmp_gt_i32 vcc, 0, v21
  v_mov_b32 v48, s20
  buffer_load_dwordx4 v2, s[4:7], s37 offen offset:0 sc1 lds
  v_cndmask_b32 v21, v21, v48, vcc
  v_lshlrev_b32 v21, 4, v21
  v_mfma_f32_32x32x16_bf16 v[176:191], a[112:115], a[112:115], v[176:191]
  v_add_u32 v21, s21, v21
  v_lshlrev_b32 v21, 7, v21
  v_add_u32 v21, 8192, v21
  s_mul_i32 s3, s21, 7
  buffer_load_dwordx4 v2, s[4:7], s37 offen offset:1024 sc1 lds
  s_mul_i32 s36, s22, 2048
  s_add_u32 s37, s36, s49
  s_add_u32 s37, s37, 16384
  s_add_u32 m0, s36, 36864
  s_lshr_b32 s3, s3, 2
  v_mov_b32 v15, 8
  s_add_u32 s100, s3, 0
  v_mfma_f32_32x32x16_bf16 v[176:191], a[116:119], a[116:119], v[176:191]
  s_min_u32 s100, s100, 26
  s_lshl_b32 s100, s100, 7
  s_add_u32 s100, s100, 40960
  buffer_load_dwordx4 v2, s[4:7], s37 offen offset:0 sc1 lds
  v_writelane_b32 v21, s100, 3
  s_add_u32 s100, s3, 1
  s_min_u32 s100, s100, 26
  s_lshl_b32 s100, s100, 7
  v_mfma_f32_32x32x16_bf16 v[176:191], a[120:123], a[120:123], v[176:191]
  s_add_u32 s100, s100, 40960
  v_writelane_b32 v21, s100, 4
  buffer_load_dwordx4 v2, s[4:7], s37 offen offset:1024 sc1 lds
  s_mul_i32 s36, s22, 2048
  s_add_u32 s37, s36, s49
  s_add_u32 s37, s37, 24576
  s_add_u32 m0, s36, 45056
  s_add_u32 s100, s3, 2
  s_min_u32 s100, s100, 26
  s_lshl_b32 s100, s100, 7
  s_add_u32 s100, s100, 40960
  v_writelane_b32 v21, s100, 5
  v_mfma_f32_32x32x16_bf16 v[176:191], a[124:127], a[124:127], v[176:191]
  s_lshr_b32 s3, s25, 1
  buffer_load_dwordx4 v2, s[4:7], s37 offen offset:0 sc1 lds
  s_lshl_b32 s3, s3, 7
  s_add_u32 s3, s3, 7168
  v_writelane_b32 v21, s3, 6
  v_writelane_b32 v15, 54, 6
  s_lshl_b32 s3, s20, 3
  s_lshl_b32 s100, s22, 1
  v_mfma_f32_32x32x16_bf16 v[176:191], a[128:131], a[128:131], v[176:191]
  buffer_load_dwordx4 v2, s[4:7], s37 offen offset:1024 sc1 lds
  s_mul_i32 s36, s22, 2048
  s_add_u32 s37, s36, s49
  s_add_u32 s37, s37, 32768
  s_add_u32 m0, s36, 53248
  s_add_u32 s3, s3, s100
  s_mul_i32 s3, s3, 20480
  s_mul_i32 s100, s21, 1280
  s_add_u32 s3, s3, s100
  s_add_u32 s3, s3, 5242880
  v_lshrrev_b32 v48, 4, v44
  buffer_load_dwordx4 v2, s[4:7], s37 offen offset:0 sc1 lds
  v_mul_u32_u24 v49, 20480, v48
  v_mfma_f32_32x32x16_bf16 v[176:191], a[132:135], a[132:135], v[176:191]
  v_lshl_add_u32 v49, v46, 4, v49
  v_add_u32 v16, s3, v49
  v_lshl_add_u32 v14, v45, 8, v16
  v_mul_u32_u24 v19, 55296, v48
  v_lshl_add_u32 v19, v46, 4, v19
  buffer_load_dwordx4 v2, s[4:7], s37 offen offset:1024 sc1 lds
  s_mul_i32 s36, s22, 2048
  s_add_u32 s37, s36, s49
  s_add_u32 s37, s37, 40960
  s_add_u32 m0, s36, 61440
  v_lshl_add_u32 v19, v45, 8, v19
  s_lshl_b32 s3, s27, 4
  v_mfma_f32_32x32x16_bf16 v[176:191], a[136:139], a[136:139], v[176:191]
  v_add_u32 v48, s3, v46
  v_lshlrev_b32 v18, 3, v48
  v_and_b32 v49, 1, v47
  v_lshl_add_u32 v48, v49, 5, v48
  buffer_load_dwordx4 v2, s[4:7], s37 offen offset:0 sc1 lds
  v_lshlrev_b32 v17, 4, v48
  v_lshl_add_u32 v17, v45, 10, v17
  s_mul_i32 s3, s22, 2560
  v_mfma_f32_32x32x16_bf16 v[176:191], a[140:143], a[140:143], v[176:191]
  s_add_u32 s3, s3, 36864
  v_add_u32 v22, s3, v2
  s_add_u32 s3, s3, 2048
  buffer_load_dwordx4 v2, s[4:7], s37 offen offset:1024 sc1 lds
  v_lshlrev_b32 v23, 3, v1
  v_add_u32 v23, s3, v23
  s_mul_i32 s3, s22, 3328
  s_add_u32 s3, s3, 67552
  v_mfma_f32_32x32x16_bf16 v[176:191], a[144:147], a[144:147], v[176:191]
  v_mul_u32_u24 v24, 416, v45
  v_and_b32 v48, 1, v47
  v_lshl_add_u32 v24, v48, 7, v24
  v_and_b32 v48, 3, v1
  v_lshl_add_u32 v24, v48, 5, v24
  v_bfe_u32 v48, v1, 2, 2
  v_lshl_add_u32 v24, v48, 3, v24
  v_mfma_f32_32x32x16_bf16 v[176:191], a[148:151], a[148:151], v[176:191]
  v_add_u32 v24, s3, v24
  s_add_u32 s3, s3, 26656
  v_lshrrev_b32 v48, 2, v44
  v_mul_u32_u24 v48, 416, v48
  v_and_b32 v49, 3, v1
  v_lshl_add_u32 v48, v49, 3, v48
  v_add_u32 v48, s3, v48
  v_mfma_f32_32x32x16_bf16 v[176:191], a[152:155], a[152:155], v[176:191]
  v_lshl_add_u32 v25, v45, 6, v48
  v_lshl_add_u32 v27, v45, 5, v48
  v_mul_u32_u24 v49, 384, v45
  v_add_u32 v26, v49, v48
  s_mul_i32 s3, s22, 5120
  v_add_u32 v28, s3, v2
  s_xor_b32 s3, s22, 1
  v_mfma_f32_32x32x16_bf16 v[176:191], a[156:159], a[156:159], v[176:191]
  s_mul_i32 s3, s3, 5120
  v_add_u32 v29, s3, v2
  v_lshlrev_b32 v48, 2, v45
  v_sub_u32 v48, v44, v48
  v_cmp_le_i32 s[64:65], 0, v48
  v_cmp_le_i32 s[66:67], 1, v48
  v_cmp_le_i32 s[68:69], 2, v48
  v_cmp_le_i32 s[70:71], 3, v48
  v_cmp_le_i32 s[72:73], 8, v48
  v_cmp_le_i32 s[74:75], 9, v48
  v_cmp_le_i32 s[76:77], 10, v48
  v_cmp_le_i32 s[78:79], 11, v48
  v_cmp_le_i32 s[80:81], 16, v48
  v_cmp_le_i32 s[82:83], 17, v48
  v_cmp_le_i32 s[84:85], 18, v48
  v_cmp_le_i32 s[86:87], 19, v48
  v_cmp_le_i32 s[88:89], 24, v48
  v_cmp_le_i32 s[90:91], 25, v48
  v_cmp_le_i32 s[92:93], 26, v48
  v_cmp_le_i32 s[94:95], 27, v48
  v_mov_b32 v49, 0xffff
  v_mov_b32 v50, 0xffff0000
  v_cndmask_b32 v32, 0, v49, s[64:65]
  v_cndmask_b32 v51, 0, v50, s[66:67]
  v_or_b32 v32, v32, v51
  v_cndmask_b32 v33, 0, v49, s[68:69]
  v_cndmask_b32 v51, 0, v50, s[70:71]
  v_or_b32 v33, v33, v51
  v_cndmask_b32 v34, 0, v49, s[72:73]
  v_cndmask_b32 v51, 0, v50, s[74:75]
  v_or_b32 v34, v34, v51
  v_cndmask_b32 v35, 0, v49, s[76:77]
  v_cndmask_b32 v51, 0, v50, s[78:79]
  v_or_b32 v35, v35, v51
  v_cndmask_b32 v36, 0, v49, s[80:81]
  v_cndmask_b32 v51, 0, v50, s[82:83]
  v_or_b32 v36, v36, v51
  v_cndmask_b32 v37, 0, v49, s[84:85]
  v_cndmask_b32 v51, 0, v50, s[86:87]
  v_or_b32 v37, v37, v51
  v_cndmask_b32 v38, 0, v49, s[88:89]
  v_cndmask_b32 v51, 0, v50, s[90:91]
  v_or_b32 v38, v38, v51
  v_cndmask_b32 v39, 0, v49, s[92:93]
  v_cndmask_b32 v51, 0, v50, s[94:95]
  v_or_b32 v39, v39, v51
  s_lshl_b32 s99, s21, 12
  s_add_u32 s99, s99, 65536
  s_waitcnt vmcnt(8)
  s_waitcnt lgkmcnt(0)
  s_barrier
  ds_read_b128 v[128:131], v2 offset:20480
  ds_read_b128 v[132:135], v2 offset:21504
  ds_read_b128 v[136:139], v2 offset:22528
  ds_read_b128 v[140:143], v2 offset:23552
  ds_read_b128 v[144:147], v2 offset:24576
  ds_read_b128 v[148:151], v2 offset:25600
  ds_read_b128 v[152:155], v2 offset:26624
  ds_read_b128 v[156:159], v2 offset:27648
  s_waitcnt lgkmcnt(6)
  v_mfma_f32_32x32x16_bf16 v[64:79], v[128:131], a[0:3], 0
  ds_read_b128 v[128:131], v2 offset:28672
  s_mul_i32 s36, s22, 2048
  s_add_u32 s37, s36, s49
  s_add_u32 s37, s37, 49152
  s_add_u32 m0, s36, 69632
  v_mfma_f32_32x32x16_bf16 v[80:95], v[132:135], a[0:3], 0
  ds_read_b128 v[132:135], v2 offset:29696
  buffer_load_dwordx4 v2, s[4:7], s37 offen offset:0 sc1 lds
  s_waitcnt lgkmcnt(6)
  v_mfma_f32_32x32x16_bf16 v[64:79], v[136:139], a[4:7], v[64:79]
  ds_read_b128 v[136:139], v2 offset:30720
  buffer_load_dwordx4 v2, s[4:7], s37 offen offset:1024 sc1 lds
  v_cndmask_b32 v176, v176, v177, s[66:67]
  v_mfma_f32_32x32x16_bf16 v[80:95], v[140:143], a[4:7], v[80:95]
  ds_read_b128 v[140:143], v2 offset:31744
  s_waitcnt lgkmcnt(6)
  v_mfma_f32_32x32x16_bf16 v[64:79], v[144:147], a[8:11], v[64:79]
  ds_read_b128 v[144:147], v2 offset:32768
  buffer_load_dword v240, v248, s[4:7], s99 offen offset:0 sc1
  v_cndmask_b32 v176, v176, v178, s[68:69]
  v_mfma_f32_32x32x16_bf16 v[80:95], v[148:151], a[8:11], v[80:95]
  ds_read_b128 v[148:151], v2 offset:33792
  s_waitcnt lgkmcnt(6)
  v_mfma_f32_32x32x16_bf16 v[64:79], v[152:155], a[12:15], v[64:79]
  ds_read_b128 v[152:155], v2 offset:34816
  buffer_load_dword v241, v248, s[4:7], s99 offen offset:128 sc1
  s_mul_i32 s36, s22, 2048
  v_mfma_f32_32x32x16_bf16 v[80:95], v[156:159], a[12:15], v[80:95]
  ds_read_b128 v[156:159], v2 offset:35840
  s_add_u32 s37, s36, s49
  s_add_u32 s37, s37, 57344
  s_add_u32 m0, s36, 77824
  s_waitcnt vmcnt(10)
  s_barrier
  s_waitcnt lgkmcnt(6)
  v_mfma_f32_32x32x16_bf16 v[64:79], v[128:131], a[16:19], v[64:79]
  ds_read_b128 v[128:131], v2 offset:36864
  buffer_load_dwordx4 v2, s[4:7], s37 offen offset:0 sc1 lds
  v_cndmask_b32 v176, v176, v179, s[70:71]
  v_mfma_f32_32x32x16_bf16 v[80:95], v[132:135], a[16:19], v[80:95]
  ds_read_b128 v[132:135], v2 offset:37888
  buffer_load_dwordx4 v2, s[4:7], s37 offen offset:1024 sc1 lds
  s_waitcnt lgkmcnt(6)
  v_mfma_f32_32x32x16_bf16 v[64:79], v[136:139], a[20:23], v[64:79]
  ds_read_b128 v[136:139], v2 offset:38912
  buffer_load_dword v242, v248, s[4:7], s99 offen offset:256 sc1
  v_cndmask_b32 v176, v176, v180, s[72:73]
  v_mfma_f32_32x32x16_bf16 v[80:95], v[140:143], a[20:23], v[80:95]
  ds_read_b128 v[140:143], v2 offset:39936
  s_waitcnt lgkmcnt(6)
  v_mfma_f32_32x32x16_bf16 v[64:79], v[144:147], a[24:27], v[64:79]
  ds_read_b128 v[144:147], v2 offset:40960
  buffer_load_dword v243, v248, s[4:7], s99 offen offset:384 sc1
  v_mfma_f32_32x32x16_bf16 v[80:95], v[148:151], a[24:27], v[80:95]
  ds_read_b128 v[148:151], v2 offset:41984
  buffer_load_dword v244, v248, s[4:7], s99 offen offset:512 sc1
  v_cndmask_b32 v176, v176, v181, s[74:75]
  s_waitcnt lgkmcnt(6)
  v_mfma_f32_32x32x16_bf16 v[64:79], v[152:155], a[28:31], v[64:79]
  ds_read_b128 v[152:155], v2 offset:43008
  buffer_load_dword v245, v248, s[4:7], s99 offen offset:640 sc1
  v_cndmask_b32 v176, v176, v182, s[76:77]
  v_mfma_f32_32x32x16_bf16 v[80:95], v[156:159], a[28:31], v[80:95]
  ds_read_b128 v[156:159], v2 offset:44032
  s_waitcnt vmcnt(14)
  s_barrier
  s_waitcnt lgkmcnt(6)
  v_mfma_f32_32x32x16_bf16 v[64:79], v[128:131], a[32:35], v[64:79]
  ds_read_b128 v[128:131], v2 offset:45056
  s_mul_i32 s36, s22, 2048
  s_add_u32 s37, s36, s49
  s_add_u32 s37, s37, 65536
  s_add_u32 m0, s36, 86016
  v_mfma_f32_32x32x16_bf16 v[80:95], v[132:135], a[32:35], v[80:95]
  ds_read_b128 v[132:135], v2 offset:46080
  buffer_load_dwordx4 v2, s[4:7], s37 offen offset:0 sc1 lds
  v_cndmask_b32 v176, v176, v183, s[78:79]
  s_waitcnt lgkmcnt(6)
  v_mfma_f32_32x32x16_bf16 v[64:79], v[136:139], a[36:39], v[64:79]
  ds_read_b128 v[136:139], v2 offset:47104
  buffer_load_dwordx4 v2, s[4:7], s37 offen offset:1024 sc1 lds
  v_mfma_f32_32x32x16_bf16 v[80:95], v[140:143], a[36:39], v[80:95]
  ds_read_b128 v[140:143], v2 offset:48128
  buffer_load_dword v246, v248, s[4:7], s99 offen offset:768 sc1
  s_waitcnt lgkmcnt(6)
  v_mfma_f32_32x32x16_bf16 v[64:79], v[144:147], a[40:43], v[64:79]
  ds_read_b128 v[144:147], v2 offset:49152
  buffer_load_dword v247, v248, s[4:7], s99 offen offset:896 sc1
  v_cndmask_b32 v176, v176, v184, s[80:81]
  v_mfma_f32_32x32x16_bf16 v[80:95], v[148:151], a[40:43], v[80:95]
  ds_read_b128 v[148:151], v2 offset:50176
  s_waitcnt lgkmcnt(6)
  v_mfma_f32_32x32x16_bf16 v[64:79], v[152:155], a[44:47], v[64:79]
  ds_read_b128 v[152:155], v2 offset:51200
  s_mul_i32 s36, s22, 2048
  s_add_u32 s37, s36, s49
  s_add_u32 s37, s37, 73728
  s_add_u32 m0, s36, 94208
  v_mfma_f32_32x32x16_bf16 v[80:95], v[156:159], a[44:47], v[80:95]
  ds_read_b128 v[156:159], v2 offset:52224
  buffer_load_dwordx4 v2, s[4:7], s37 offen offset:0 sc1 lds
  v_cndmask_b32 v176, v176, v185, s[82:83]
  s_waitcnt vmcnt(17)
  s_barrier
  s_waitcnt lgkmcnt(6)
  v_mfma_f32_32x32x16_bf16 v[64:79], v[128:131], a[48:51], v[64:79]
  ds_read_b128 v[128:131], v2 offset:53248
  buffer_load_dwordx4 v2, s[4:7], s37 offen offset:1024 sc1 lds
  v_cndmask_b32 v176, v176, v186, s[84:85]
  v_mfma_f32_32x32x16_bf16 v[80:95], v[132:135], a[48:51], v[80:95]
  ds_read_b128 v[132:135], v2 offset:54272
  s_waitcnt lgkmcnt(6)
  v_mfma_f32_32x32x16_bf16 v[64:79], v[136:139], a[52:55], v[64:79]
  ds_read_b128 v[136:139], v2 offset:55296
  s_mul_i32 s36, s22, 2048
  s_add_u32 s37, s36, s49
  s_add_u32 s37, s37, 81920
  s_add_u32 m0, s36, 110592
  v_mfma_f32_32x32x16_bf16 v[80:95], v[140:143], a[52:55], v[80:95]
  ds_read_b128 v[140:143], v2 offset:56320
  buffer_load_dwordx4 v2, s[4:7], s37 offen offset:0 sc1 lds
  s_waitcnt lgkmcnt(6)
  v_mfma_f32_32x32x16_bf16 v[64:79], v[144:147], a[56:59], v[64:79]
  ds_read_b128 v[144:147], v2 offset:57344
  buffer_load_dwordx4 v2, s[4:7], s37 offen offset:1024 sc1 lds
  v_cndmask_b32 v176, v176, v187, s[86:87]
  v_mfma_f32_32x32x16_bf16 v[80:95], v[148:151], a[56:59], v[80:95]
  ds_read_b128 v[148:151], v2 offset:58368
  s_mul_i32 s36, s22, 2048
  s_add_u32 s37, s36, s49
  s_add_u32 s37, s37, 90112
  s_add_u32 m0, s36, 118784
  s_waitcnt lgkmcnt(6)
  v_mfma_f32_32x32x16_bf16 v[64:79], v[152:155], a[60:63], v[64:79]
  ds_read_b128 v[152:155], v2 offset:59392
  buffer_load_dwordx4 v2, s[4:7], s37 offen offset:0 sc1 lds
  v_mfma_f32_32x32x16_bf16 v[80:95], v[156:159], a[60:63], v[80:95]
  ds_read_b128 v[156:159], v2 offset:60416
  buffer_load_dwordx4 v2, s[4:7], s37 offen offset:1024 sc1 lds
  v_cndmask_b32 v176, v176, v188, s[88:89]
  s_waitcnt vmcnt(20)
  s_barrier
  s_waitcnt lgkmcnt(6)
  v_mfma_f32_32x32x16_bf16 v[64:79], v[128:131], a[64:67], v[64:79]
  ds_read_b128 v[128:131], v2 offset:61440
  s_mul_i32 s36, s22, 2048
  s_add_u32 s37, s36, s49
  s_add_u32 s37, s37, 98304
  s_add_u32 m0, s36, 126976
  v_mfma_f32_32x32x16_bf16 v[80:95], v[132:135], a[64:67], v[80:95]
  ds_read_b128 v[132:135], v2 offset:62464
  buffer_load_dwordx4 v2, s[4:7], s37 offen offset:0 sc1 lds
  s_waitcnt lgkmcnt(6)
  v_mfma_f32_32x32x16_bf16 v[64:79], v[136:139], a[68:71], v[64:79]
  ds_read_b128 v[136:139], v2 offset:63488
  buffer_load_dwordx4 v2, s[4:7], s37 offen offset:1024 sc1 lds
  v_cndmask_b32 v176, v176, v189, s[90:91]
  v_mfma_f32_32x32x16_bf16 v[80:95], v[140:143], a[68:71], v[80:95]
  ds_read_b128 v[140:143], v2 offset:64512
  s_mul_i32 s36, s22, 2048
  s_add_u32 s37, s36, s49
  s_add_u32 s37, s37, 106496
  s_add_u32 m0, s36, 135168
  s_waitcnt lgkmcnt(6)
  v_mfma_f32_32x32x16_bf16 v[64:79], v[144:147], a[72:75], v[64:79]
  ds_read_b128 v[144:147], v30 offset:0
  buffer_load_dwordx4 v2, s[4:7], s37 offen offset:0 sc1 lds
  v_cndmask_b32 v176, v176, v190, s[92:93]
  v_mfma_f32_32x32x16_bf16 v[80:95], v[148:151], a[72:75], v[80:95]
  ds_read_b128 v[148:151], v30 offset:1024
  buffer_load_dwordx4 v2, s[4:7], s37 offen offset:1024 sc1 lds
  s_waitcnt lgkmcnt(6)
  v_mfma_f32_32x32x16_bf16 v[64:79], v[152:155], a[76:79], v[64:79]
  ds_read_b128 v[152:155], v30 offset:2048
  s_mul_i32 s36, s22, 2048
  s_add_u32 s37, s36, s49
  s_add_u32 s37, s37, 114688
  s_add_u32 m0, s36, 45056
  v_mfma_f32_32x32x16_bf16 v[80:95], v[156:159], a[76:79], v[80:95]
  ds_read_b128 v[156:159], v30 offset:3072
  buffer_load_dwordx4 v2, s[4:7], s37 offen offset:0 sc1 lds
  s_waitcnt vmcnt(23)
  s_barrier
  s_waitcnt lgkmcnt(6)
  v_mfma_f32_32x32x16_bf16 v[64:79], v[128:131], a[80:83], v[64:79]
  ds_read_b128 v[128:131], v30 offset:4096
  buffer_load_dwordx4 v2, s[4:7], s37 offen offset:1024 sc1 lds
  v_cndmask_b32 v176, v176, v191, s[94:95]
  v_mfma_f32_32x32x16_bf16 v[80:95], v[132:135], a[80:83], v[80:95]
  ds_read_b128 v[132:135], v30 offset:5120
  s_mul_i32 s36, s22, 2048
  s_add_u32 s37, s36, s49
  s_add_u32 s37, s37, 122880
  s_add_u32 m0, s36, 0
  s_waitcnt lgkmcnt(6)
  v_mfma_f32_32x32x16_bf16 v[64:79], v[136:139], a[84:87], v[64:79]
  ds_read_b128 v[136:139], v30 offset:6144
  buffer_load_dwordx4 v2, s[4:7], s37 offen offset:0 sc1 lds
  v_mov_b32 v177, v176
  v_mfma_f32_32x32x16_bf16 v[80:95], v[140:143], a[84:87], v[80:95]
  ds_read_b128 v[140:143], v30 offset:7168
  buffer_load_dwordx4 v2, s[4:7], s37 offen offset:1024 sc1 lds
  v_mov_b32 v178, v176
  s_waitcnt lgkmcnt(6)
  v_mfma_f32_32x32x16_bf16 v[64:79], v[144:147], a[88:91], v[64:79]
  ds_read_b128 v[144:147], v30 offset:8192
  s_mul_i32 s36, s22, 2048
  s_add_u32 s37, s36, s49
  s_add_u32 s37, s37, 131072
  s_add_u32 m0, s36, 8192
  v_mfma_f32_32x32x16_bf16 v[80:95], v[148:151], a[88:91], v[80:95]
  ds_read_b128 v[148:151], v30 offset:9216
  buffer_load_dwordx4 v2, s[4:7], s37 offen offset:0 sc1 lds
  v_permlane32_swap_b32 v177, v178
  s_waitcnt lgkmcnt(6)
  v_mfma_f32_32x32x16_bf16 v[64:79], v[152:155], a[92:95], v[64:79]
  ds_read_b128 v[152:155], v30 offset:10240
  buffer_load_dwordx4 v2, s[4:7], s37 offen offset:1024 sc1 lds
  s_mul_i32 s36, s22, 2048
  v_mfma_f32_32x32x16_bf16 v[80:95], v[156:159], a[92:95], v[80:95]
  ds_read_b128 v[156:159], v30 offset:11264
  s_add_u32 s37, s36, s49
  s_add_u32 s37, s37, 139264
  s_add_u32 m0, s36, 20480
  s_waitcnt vmcnt(24)
  s_barrier
  s_cmp_lg_u32 s22, 0
  s_cbranch_scc1 ps_13
  s_cmp_ge_u32 s98, 216
  s_cbranch_scc1 ps_13
  s_lshr_b32 s101, s98, 3
  s_lshl_b32 s101, s101, 7
  s_add_u32 s101, s101, 40960
  v_mov_b32 v60, s101
  s_and_b32 s101, s98, 3
  s_lshl_b32 s101, s101, 7
  s_add_u32 s101, s101, 7168
  v_writelane_b32 v60, s101, 1
  s_mov_b64 exec, 3
  v_mov_b32 v61, 1
  buffer_atomic_add v61, v60, s[4:7], 0 offen sc1
  s_mov_b64 exec, -1
ps_13:
  s_waitcnt lgkmcnt(6)
  v_mfma_f32_32x32x16_bf16 v[64:79], v[128:131], a[96:99], v[64:79]
  ds_read_b128 v[128:131], v30 offset:12288
  buffer_load_dwordx4 v2, s[4:7], s37 offen offset:0 sc1 lds
  v_mfma_f32_32x32x16_bf16 v[80:95], v[132:135], a[96:99], v[80:95]
  ds_read_b128 v[132:135], v30 offset:13312
  buffer_load_dwordx4 v2, s[4:7], s37 offen offset:1024 sc1 lds
  v_bfe_u32 v48, v1, 2, 1
  s_waitcnt lgkmcnt(6)
  v_mfma_f32_32x32x16_bf16 v[64:79], v[136:139], a[100:103], v[64:79]
  ds_read_b128 v[136:139], v30 offset:14336
  s_mul_i32 s36, s22, 2048
  s_add_u32 s37, s36, s49
  s_add_u32 s37, s37, 147456
  s_add_u32 m0, s36, 28672
  v_mfma_f32_32x32x16_bf16 v[80:95], v[140:143], a[100:103], v[80:95]
  ds_read_b128 v[140:143], v30 offset:15360
  buffer_load_dwordx4 v2, s[4:7], s37 offen offset:0 sc1 lds
  v_cmp_eq_u32 vcc, 0, v48
  s_waitcnt lgkmcnt(6)
  v_mfma_f32_32x32x16_bf16 v[64:79], v[144:147], a[104:107], v[64:79]
  ds_read_b128 v[144:147], v30 offset:16384
  buffer_load_dwordx4 v2, s[4:7], s37 offen offset:1024 sc1 lds
  s_mul_i32 s36, s22, 2048
  v_mfma_f32_32x32x16_bf16 v[80:95], v[148:151], a[104:107], v[80:95]
  ds_read_b128 v[148:151], v30 offset:17408
  s_add_u32 s37, s36, s49
  s_add_u32 s37, s37, 155648
  s_add_u32 m0, s36, 36864
  s_waitcnt lgkmcnt(6)
  v_mfma_f32_32x32x16_bf16 v[64:79], v[152:155], a[108:111], v[64:79]
  ds_read_b128 v[152:155], v30 offset:18432
  buffer_load_dwordx4 v2, s[4:7], s37 offen offset:0 sc1 lds
  v_cndmask_b32 v176, v178, v177, vcc
  v_mfma_f32_32x32x16_bf16 v[80:95], v[156:159], a[108:111], v[80:95]
  ds_read_b128 v[156:159], v30 offset:19456
  buffer_load_dwordx4 v2, s[4:7], s37 offen offset:1024 sc1 lds
  v_mul_f32 v176, 0x3acccccd, v176
  s_waitcnt vmcnt(24)
  s_barrier
  s_waitcnt lgkmcnt(6)
  v_mfma_f32_32x32x16_bf16 v[64:79], v[128:131], a[112:115], v[64:79]
  ds_read_b128 v[128:131], v30 offset:20480
  v_mfma_f32_32x32x16_bf16 v[80:95], v[132:135], a[112:115], v[80:95]
  ds_read_b128 v[132:135], v30 offset:21504
  s_waitcnt lgkmcnt(6)
  v_mfma_f32_32x32x16_bf16 v[64:79], v[136:139], a[116:119], v[64:79]
  ds_read_b128 v[136:139], v30 offset:22528
  s_waitcnt vmcnt(22)
  v_add_f32 v240, v240, v241
  v_add_f32 v240, v240, v242
  v_add_f32 v240, v240, v243
  v_mfma_f32_32x32x16_bf16 v[80:95], v[140:143], a[116:119], v[80:95]
  ds_read_b128 v[140:143], v30 offset:23552
  v_add_f32 v240, v240, v244
  v_add_f32 v240, v240, v245
  v_add_f32 v240, v240, v246
  v_add_f32 v240, v240, v247
  s_waitcnt lgkmcnt(6)
  v_mfma_f32_32x32x16_bf16 v[64:79], v[144:147], a[120:123], v[64:79]
  ds_read_b128 v[144:147], v30 offset:24576
  v_and_b32 v245, 0xffff0000, v240
  v_sub_f32 v240, v240, v245
  v_and_b32 v246, 0xffff0000, v240
  v_sub_f32 v240, v240, v246
  v_mfma_f32_32x32x16_bf16 v[80:95], v[148:151], a[120:123], v[80:95]
  ds_read_b128 v[148:151], v30 offset:25600
  v_lshrrev_b32 v244, 16, v245
  v_or_b32 v244, v244, v245
  v_lshrrev_b32 v247, 16, v246
  v_or_b32 v245, v245, v247
  s_waitcnt lgkmcnt(6)
  v_mfma_f32_32x32x16_bf16 v[64:79], v[152:155], a[124:127], v[64:79]
  ds_read_b128 v[152:155], v30 offset:26624
  v_lshrrev_b32 v240, 16, v240
  v_or_b32 v246, v246, v240
  v_mov_b32 v247, 0
  v_mov_b32 v160, 0
  v_mfma_f32_32x32x16_bf16 v[80:95], v[156:159], a[124:127], v[80:95]
  ds_read_b128 v[156:159], v30 offset:27648
  v_mov_b32 v161, 0
  v_mov_b32 v162, 0
  v_mov_b32 v163, 0
  s_waitcnt vmcnt(20)
  s_barrier
  s_waitcnt lgkmcnt(6)
  v_mfma_f32_32x32x16_bf16 v[64:79], v[128:131], a[128:131], v[64:79]
  ds_read_b128 v[128:131], v30 offset:28672
  ds_write_b128 v249, v[244:247]
  v_mfma_f32_32x32x16_bf16 v[80:95], v[132:135], a[128:131], v[80:95]
  ds_read_b128 v[132:135], v30 offset:29696
  ds_write_b128 v249, v[160:163] offset:512
  s_waitcnt lgkmcnt(8)
  v_mfma_f32_32x32x16_bf16 v[64:79], v[136:139], a[132:135], v[64:79]
  ds_read_b128 v[136:139], v30 offset:30720
  v_mfma_f32_32x32x16_bf16 v[80:95], v[140:143], a[132:135], v[80:95]
  ds_read_b128 v[140:143], v30 offset:31744
  s_waitcnt lgkmcnt(8)
  v_mfma_f32_32x32x16_bf16 v[64:79], v[144:147], a[136:139], v[64:79]
  ds_read_b128 v[144:147], v30 offset:32768
  v_mfma_f32_32x32x16_bf16 v[80:95], v[148:151], a[136:139], v[80:95]
  ds_read_b128 v[148:151], v30 offset:33792
  s_waitcnt lgkmcnt(8)
  v_mfma_f32_32x32x16_bf16 v[64:79], v[152:155], a[140:143], v[64:79]
  ds_read_b128 v[152:155], v30 offset:34816
  v_mfma_f32_32x32x16_bf16 v[80:95], v[156:159], a[140:143], v[80:95]
  ds_read_b128 v[156:159], v30 offset:35840
  s_waitcnt vmcnt(18)
  s_waitcnt lgkmcnt(6)
  s_barrier
  v_mfma_f32_32x32x16_bf16 v[64:79], v[128:131], a[144:147], v[64:79]
  ds_read_b128 v[128:131], v30 offset:45056
  v_mfma_f32_32x32x16_bf16 v[80:95], v[132:135], a[144:147], v[80:95]
  ds_read_b128 v[132:135], v30 offset:46080
  s_waitcnt lgkmcnt(6)
  v_mfma_f32_32x32x16_bf16 v[64:79], v[136:139], a[148:151], v[64:79]
  ds_read_b128 v[136:139], v30 offset:47104
  v_mfma_f32_32x32x16_bf16 v[80:95], v[140:143], a[148:151], v[80:95]
  ds_read_b128 v[140:143], v30 offset:48128
  s_waitcnt lgkmcnt(6)
  v_mfma_f32_32x32x16_bf16 v[64:79], v[144:147], a[152:155], v[64:79]
  ds_read_b128 v[144:147], v30 offset:49152
  v_mfma_f32_32x32x16_bf16 v[80:95], v[148:151], a[152:155], v[80:95]
  ds_read_b128 v[148:151], v31 offset:16384
  s_waitcnt lgkmcnt(6)
  v_mfma_f32_32x32x16_bf16 v[64:79], v[152:155], a[156:159], v[64:79]
  ds_read_b128 v[152:155], v31 offset:17408
  v_mfma_f32_32x32x16_bf16 v[80:95], v[156:159], a[156:159], v[80:95]
  ds_read_b128 v[156:159], v30 offset:50176
  s_waitcnt vmcnt(16)
  s_barrier
  s_waitcnt lgkmcnt(6)
  v_mfma_f32_32x32x16_bf16 v[96:111], v[128:131], a[0:3], 0
  ds_read_b128 v[128:131], v30 offset:51200
  v_mfma_f32_32x32x16_bf16 v[96:111], v[132:135], a[4:7], v[96:111]
  ds_read_b128 v[132:135], v30 offset:52224
  s_nop 3
  v_mul_f32 v168, 0xbacccccd, v84
  v_and_b32 v160, 0xffff0000, v168
  v_sub_f32 v161, v168, v160
  v_and_b32 v172, 0xffff0000, v161
  s_waitcnt lgkmcnt(6)
  v_mfma_f32_32x32x16_bf16 v[96:111], v[136:139], a[8:11], v[96:111]
  ds_read_b128 v[136:139], v30 offset:53248
  v_sub_f32 v161, v161, v172
  v_lshrrev_b32 v160, 16, v160
  v_and_b32 v173, 0xffff0000, v161
  v_or_b32 v172, v172, v160
  v_mfma_f32_32x32x16_bf16 v[96:111], v[140:143], a[12:15], v[96:111]
  ds_read_b128 v[140:143], v30 offset:54272
  v_or_b32 v173, v173, v160
  v_mov_b32 v174, v172
  v_mov_b32 v175, 0
  v_fma_f32 v176, -v168, v168, v176
  v_max_f32 v176, 0, v176
  v_add_f32 v176, 0x3727c5ac, v176
  v_rsq_f32 v169, v176
  s_waitcnt lgkmcnt(6)
  v_mfma_f32_32x32x16_bf16 v[96:111], v[144:147], a[16:19], v[96:111]
  ds_read_b128 v[144:147], v30 offset:55296
  v_mfma_f32_32x32x16_bf16 v[64:79], v[148:151], v[172:175], v[64:79]
  ds_read_b128 v[148:151], v30 offset:56320
  s_waitcnt lgkmcnt(6)
  v_mfma_f32_32x32x16_bf16 v[80:95], v[152:155], v[172:175], v[80:95]
  ds_read_b128 v[152:155], v30 offset:57344
  v_mfma_f32_32x32x16_bf16 v[96:111], v[156:159], a[20:23], v[96:111]
  ds_read_b128 v[156:159], v30 offset:58368
  s_waitcnt lgkmcnt(6)
  v_mfma_f32_32x32x16_bf16 v[96:111], v[128:131], a[24:27], v[96:111]
  ds_read_b128 v[128:131], v30 offset:59392
  s_add_u32 s32, s40, s44
  s_mul_i32 s33, s22, 2560
  s_add_u32 s33, s33, s32
  s_mul_i32 s34, s22, 3328
  s_add_u32 s35, s34, 94208
  v_mfma_f32_32x32x16_bf16 v[96:111], v[132:135], a[28:31], v[96:111]
  ds_read_b128 v[132:135], v30 offset:60416
  s_add_u32 s34, s34, s32
  s_add_u32 s34, s34, 10240
  v_add_u32 v187, s35, v2
  v_lshlrev_b32 v186, 3, v1
  v_mov_b32 v218, 0x3f803f80
  s_waitcnt vmcnt(14)
  s_barrier
  s_waitcnt lgkmcnt(6)
  v_mfma_f32_32x32x16_bf16 v[96:111], v[136:139], a[32:35], v[96:111]
  ds_read_b128 v[136:139], v30 offset:61440
  v_mov_b32 v219, 0x3f803f80
  ds_write_b64 v27, v[218:219] offset:160
  v_mul_f32 v170, 0x3ea52b5c, v169
  v_mfma_f32_32x32x16_bf16 v[96:111], v[140:143], a[36:39], v[96:111]
  ds_read_b128 v[140:143], v30 offset:62464
  v_mul_f32 v64, v169, v64
  v_mul_f32 v65, v169, v65
  v_mul_f32 v66, v169, v66
  v_mul_f32 v67, v169, v67
  v_cvt_pk_bf16_f32 v208, v64, v65
  s_waitcnt lgkmcnt(7)
  v_mfma_f32_32x32x16_bf16 v[96:111], v[144:147], a[40:43], v[96:111]
  ds_read_b128 v[144:147], v30 offset:63488
  v_cvt_pk_bf16_f32 v209, v66, v67
  ds_write_b64 v25, v[208:209] offset:32
  v_mul_f32 v68, v169, v68
  v_mfma_f32_32x32x16_bf16 v[96:111], v[148:151], a[44:47], v[96:111]
  ds_read_b128 v[148:151], v30 offset:64512
  v_mul_f32 v69, v169, v69
  v_mul_f32 v70, v169, v70
  v_mul_f32 v71, v169, v71
  v_cvt_pk_bf16_f32 v210, v68, v69
  v_cvt_pk_bf16_f32 v211, v70, v71
  s_waitcnt lgkmcnt(8)
  v_mfma_f32_32x32x16_bf16 v[96:111], v[152:155], a[48:51], v[96:111]
  ds_read_b128 v[152:155], v31 offset:0
  ds_write_b64 v25, v[210:211] offset:64
  v_mul_f32 v72, v169, v72
  v_mul_f32 v73, v169, v73
  v_mfma_f32_32x32x16_bf16 v[96:111], v[156:159], a[52:55], v[96:111]
  ds_read_b128 v[156:159], v31 offset:1024
  v_mul_f32 v74, v169, v74
  v_mul_f32 v75, v169, v75
  v_cvt_pk_bf16_f32 v212, v72, v73
  v_cvt_pk_bf16_f32 v213, v74, v75
  s_waitcnt lgkmcnt(9)
  v_mfma_f32_32x32x16_bf16 v[96:111], v[128:131], a[56:59], v[96:111]
  ds_read_b128 v[128:131], v31 offset:2048
  ds_write_b64 v26, v[212:213] offset:0
  v_mul_f32 v76, v169, v76
  v_mul_f32 v77, v169, v77
  v_mfma_f32_32x32x16_bf16 v[96:111], v[132:135], a[60:63], v[96:111]
  ds_read_b128 v[132:135], v31 offset:3072
  v_mul_f32 v78, v169, v78
  v_mul_f32 v79, v169, v79
  v_cvt_pk_bf16_f32 v214, v76, v77
  v_cvt_pk_bf16_f32 v215, v78, v79
  s_waitcnt vmcnt(12)
  s_barrier
  s_waitcnt lgkmcnt(9)
  v_mfma_f32_32x32x16_bf16 v[96:111], v[136:139], a[64:67], v[96:111]
  ds_read_b128 v[136:139], v31 offset:4096
  ds_write_b64 v25, v[214:215] offset:224
  v_mul_f32 v80, v169, v80
  v_mul_f32 v81, v169, v81
  v_mfma_f32_32x32x16_bf16 v[96:111], v[140:143], a[68:71], v[96:111]
  ds_read_b128 v[140:143], v31 offset:5120
  v_mul_f32 v82, v169, v82
  v_mul_f32 v83, v169, v83
  v_cvt_pk_bf16_f32 v216, v80, v81
  v_cvt_pk_bf16_f32 v217, v82, v83
  s_waitcnt lgkmcnt(9)
  v_mfma_f32_32x32x16_bf16 v[96:111], v[144:147], a[72:75], v[96:111]
  ds_read_b128 v[144:147], v31 offset:6144
  ds_write_b64 v25, v[216:217] offset:256
  v_mul_f32 v88, v169, v88
  v_mul_f32 v89, v169, v89
  v_mfma_f32_32x32x16_bf16 v[96:111], v[148:151], a[76:79], v[96:111]
  ds_read_b128 v[148:151], v31 offset:7168
  v_mul_f32 v90, v169, v90
  v_mul_f32 v91, v169, v91
  v_cvt_pk_bf16_f32 v176, v88, v89
  v_cvt_pk_bf16_f32 v177, v90, v91
  s_waitcnt lgkmcnt(1)
  v_mfma_f32_32x32x16_bf16 v[96:111], v[152:155], a[80:83], v[96:111]
  ds_read_b128 v[152:155], v31 offset:8192
  ds_read_b128 v[192:195], v187 offset:0
  ds_read_b128 v[196:199], v187 offset:1024
  ds_read_b128 v[200:203], v187 offset:2048
  ds_read_b128 v[204:207], v187 offset:3072
  v_mul_f32 v92, v169, v92
  v_mfma_f32_32x32x16_bf16 v[96:111], v[156:159], a[84:87], v[96:111]
  ds_read_b128 v[156:159], v31 offset:9216
  v_mul_f32 v93, v169, v93
  v_mul_f32 v94, v169, v94
  v_mul_f32 v95, v169, v95
  v_cvt_pk_bf16_f32 v178, v92, v93
  v_cvt_pk_bf16_f32 v179, v94, v95
  v_mfma_f32_32x32x16_bf16 v[96:111], v[128:131], a[88:91], v[96:111]
  ds_read_b128 v[128:131], v31 offset:10240
  buffer_store_dwordx4 v[176:179], v2, s[4:7], s33 offen sc1
  v_mfma_f32_32x32x16_bf16 v[96:111], v[132:135], a[92:95], v[96:111]
  ds_read_b128 v[132:135], v31 offset:11264
  ds_write_b128 v22, v[176:179] offset:20480
  s_waitcnt lgkmcnt(7)
  s_waitcnt vmcnt(11)
  s_barrier
  v_mfma_f32_32x32x16_bf16 v[96:111], v[136:139], a[96:99], v[96:111]
  ds_read_b128 v[136:139], v2 offset:45056
  buffer_store_dwordx4 v[192:195], v2, s[4:7], s34 offen offset:0 sc1
  v_mfma_f32_32x32x16_bf16 v[96:111], v[140:143], a[100:103], v[96:111]
  ds_read_b128 v[140:143], v2 offset:46080
  s_waitcnt lgkmcnt(8)
  v_mfma_f32_32x32x16_bf16 v[96:111], v[144:147], a[104:107], v[96:111]
  ds_read_b128 v[144:147], v2 offset:47104
  buffer_store_dwordx4 v[196:199], v2, s[4:7], s34 offen offset:1024 sc1
  v_mfma_f32_32x32x16_bf16 v[96:111], v[148:151], a[108:111], v[96:111]
  ds_read_b128 v[148:151], v2 offset:48128
  s_waitcnt lgkmcnt(9)
  s_waitcnt lgkmcnt(7)
  v_mfma_f32_32x32x16_bf16 v[96:111], v[152:155], a[112:115], v[96:111]
  ds_read_b128 v[152:155], v2 offset:49152
  buffer_store_dwordx4 v[200:203], v2, s[4:7], s34 offen offset:2048 sc1
  v_mfma_f32_32x32x16_bf16 v[96:111], v[156:159], a[116:119], v[96:111]
  ds_read_b128 v[156:159], v2 offset:50176
  s_waitcnt lgkmcnt(7)
  v_mfma_f32_32x32x16_bf16 v[96:111], v[128:131], a[120:123], v[96:111]
  ds_read_b128 v[128:131], v2 offset:51200
  s_mov_b64 exec, 0xffff
  buffer_store_dwordx4 v[204:207], v2, s[4:7], s34 offen offset:3072 sc1
  s_mov_b64 exec, -1
  v_mfma_f32_32x32x16_bf16 v[96:111], v[132:135], a[124:127], v[96:111]
  ds_read_b128 v[132:135], v2 offset:52224
  s_waitcnt vmcnt(13)
  s_barrier
  s_waitcnt lgkmcnt(6)
  v_mfma_f32_32x32x16_bf16 v[96:111], v[136:139], a[128:131], v[96:111]
  ds_read_b128 v[136:139], v31 offset:18432
  v_mfma_f32_32x32x16_bf16 v[96:111], v[140:143], a[132:135], v[96:111]
  ds_read_b128 v[140:143], v2 offset:0
  s_waitcnt lgkmcnt(6)
  v_mfma_f32_32x32x16_bf16 v[96:111], v[144:147], a[136:139], v[96:111]
  ds_read_b128 v[144:147], v2 offset:1024
  v_mfma_f32_32x32x16_bf16 v[96:111], v[148:151], a[140:143], v[96:111]
  ds_read_b128 v[148:151], v2 offset:2048
  s_waitcnt lgkmcnt(6)
  v_mfma_f32_32x32x16_bf16 v[96:111], v[152:155], a[144:147], v[96:111]
  ds_read_b128 v[152:155], v2 offset:3072
  v_mfma_f32_32x32x16_bf16 v[96:111], v[156:159], a[148:151], v[96:111]
  ds_read_b128 v[156:159], v2 offset:4096
  s_waitcnt lgkmcnt(6)
  v_mfma_f32_32x32x16_bf16 v[96:111], v[128:131], a[152:155], v[96:111]
  ds_read_b128 v[128:131], v2 offset:5120
  v_mfma_f32_32x32x16_bf16 v[96:111], v[132:135], a[156:159], v[96:111]
  ds_read_b128 v[132:135], v2 offset:6144
  s_waitcnt lgkmcnt(6)
  v_mfma_f32_32x32x16_bf16 v[96:111], v[136:139], v[172:175], v[96:111]
  ds_read_b128 v[136:139], v2 offset:7168
  s_waitcnt vmcnt(11)
  s_barrier
  v_mfma_f32_32x32x16_bf16 v[112:127], v[140:143], a[0:3], 0
  ds_read_b128 v[140:143], v2 offset:8192
  s_waitcnt lgkmcnt(6)
  v_mfma_f32_32x32x16_bf16 v[112:127], v[144:147], a[4:7], v[112:127]
  ds_read_b128 v[144:147], v2 offset:9216
  v_mfma_f32_32x32x16_bf16 v[112:127], v[148:151], a[8:11], v[112:127]
  ds_read_b128 v[148:151], v2 offset:10240
  s_nop 1
  v_mul_f32 v100, v169, v100
  v_mul_f32 v101, v169, v101
  v_mul_f32 v102, v169, v102
  v_mul_f32 v103, v169, v103
  v_cvt_pk_bf16_f32 v180, v100, v101
  v_cvt_pk_bf16_f32 v181, v102, v103
  s_waitcnt lgkmcnt(6)
  v_mfma_f32_32x32x16_bf16 v[112:127], v[152:155], a[12:15], v[112:127]
  ds_read_b128 v[152:155], v2 offset:11264
  v_mul_f32 v104, v169, v104
  v_mul_f32 v105, v169, v105
  v_mul_f32 v106, v169, v106
  v_mul_f32 v107, v169, v107
  v_cvt_pk_bf16_f32 v182, v104, v105
  v_cvt_pk_bf16_f32 v183, v106, v107
  v_mfma_f32_32x32x16_bf16 v[112:127], v[156:159], a[16:19], v[112:127]
  ds_read_b128 v[156:159], v2 offset:12288
  buffer_store_dwordx4 v[180:183], v2, s[4:7], s33 offen offset:1024 sc1
  v_mul_f32 v96, v169, v96
  s_waitcnt lgkmcnt(6)
  v_mfma_f32_32x32x16_bf16 v[112:127], v[128:131], a[20:23], v[112:127]
  ds_read_b128 v[128:131], v2 offset:13312
  v_mul_f32 v97, v169, v97
  v_mul_f32 v98, v169, v98
  v_mul_f32 v99, v169, v99
  v_cvt_pk_bf16_f32 v184, v96, v97
  v_cvt_pk_bf16_f32 v185, v98, v99
  v_mfma_f32_32x32x16_bf16 v[112:127], v[132:135], a[24:27], v[112:127]
  ds_read_b128 v[132:135], v2 offset:14336
  buffer_store_dwordx2 v[184:185], v186, s[4:7], s33 offen offset:2048 sc1
  s_waitcnt lgkmcnt(6)
  v_mfma_f32_32x32x16_bf16 v[112:127], v[136:139], a[28:31], v[112:127]
  ds_read_b128 v[136:139], v2 offset:15360
  ds_write_b128 v22, v[180:183] offset:21504
  s_waitcnt vmcnt(11)
  s_barrier
  v_mfma_f32_32x32x16_bf16 v[112:127], v[140:143], a[32:35], v[112:127]
  ds_read_b128 v[140:143], v2 offset:20480
  ds_write_b64 v23, v[184:185] offset:20480
  v_mul_f32 v108, v170, v108
  v_mul_f32 v109, v170, v109
  v_mul_f32 v110, v170, v110
  s_waitcnt lgkmcnt(8)
  v_mfma_f32_32x32x16_bf16 v[112:127], v[144:147], a[36:39], v[112:127]
  ds_read_b128 v[144:147], v2 offset:21504
  v_mul_f32 v111, v170, v111
  v_cvt_pk_bf16_f32 v224, v108, v109
  v_cvt_pk_bf16_f32 v225, v110, v111
  v_mov_b32 v234, 0
  v_mov_b32 v235, 0
  v_mov_b32 v238, 0
  v_mfma_f32_32x32x16_bf16 v[112:127], v[148:151], a[40:43], v[112:127]
  ds_read_b128 v[148:151], v2 offset:22528
  v_mov_b32 v239, 0
  s_waitcnt lgkmcnt(8)
  v_mfma_f32_32x32x16_bf16 v[112:127], v[152:155], a[44:47], v[112:127]
  ds_read_b128 v[152:155], v2 offset:23552
  v_mfma_f32_32x32x16_bf16 v[112:127], v[156:159], a[48:51], v[112:127]
  ds_read_b128 v[156:159], v2 offset:24576
  s_waitcnt lgkmcnt(8)
  v_mfma_f32_32x32x16_bf16 v[112:127], v[128:131], a[52:55], v[112:127]
  ds_read_b128 v[128:131], v2 offset:25600
  v_mfma_f32_32x32x16_bf16 v[112:127], v[132:135], a[56:59], v[112:127]
  ds_read_b128 v[132:135], v2 offset:26624
  s_waitcnt lgkmcnt(7)
  v_mfma_f32_32x32x16_bf16 v[112:127], v[136:139], a[60:63], v[112:127]
  ds_read_b128 v[136:139], v2 offset:27648
  s_waitcnt vmcnt(9)
  s_barrier
  v_mfma_f32_32x32x16_bf16 v[112:127], v[140:143], a[64:67], v[112:127]
  ds_read_b128 v[140:143], v2 offset:28672
  s_mul_i32 s36, s22, 8192
  s_add_u32 s37, s36, s50
  s_add_u32 s37, s37, 30720
  s_add_u32 m0, s36, 107520
  s_waitcnt lgkmcnt(6)
  v_mfma_f32_32x32x16_bf16 v[112:127], v[144:147], a[68:71], v[112:127]
  ds_read_b128 v[144:147], v2 offset:29696
  buffer_load_dwordx4 v2, s[4:7], s37 offen offset:0 sc1 lds
  v_mfma_f32_32x32x16_bf16 v[112:127], v[148:151], a[72:75], v[112:127]
  ds_read_b128 v[148:151], v2 offset:30720
  buffer_load_dwordx4 v2, s[4:7], s37 offen offset:1024 sc1 lds
  s_waitcnt lgkmcnt(6)
  v_mfma_f32_32x32x16_bf16 v[112:127], v[152:155], a[76:79], v[112:127]
  ds_read_b128 v[152:155], v2 offset:31744
  v_mfma_f32_32x32x16_bf16 v[112:127], v[156:159], a[80:83], v[112:127]
  ds_read_b128 v[156:159], v2 offset:32768
  buffer_load_dwordx4 v2, s[4:7], s37 offen offset:2048 sc1 lds
  s_waitcnt lgkmcnt(6)
  v_mfma_f32_32x32x16_bf16 v[112:127], v[128:131], a[84:87], v[112:127]
  ds_read_b128 v[128:131], v2 offset:33792
  v_mfma_f32_32x32x16_bf16 v[112:127], v[132:135], a[88:91], v[112:127]
  ds_read_b128 v[132:135], v2 offset:34816
  s_waitcnt lgkmcnt(6)
  v_mfma_f32_32x32x16_bf16 v[112:127], v[136:139], a[92:95], v[112:127]
  ds_read_b128 v[136:139], v2 offset:35840
  buffer_load_dwordx4 v2, s[4:7], s37 offen offset:3072 sc1 lds
  s_waitcnt vmcnt(11)
  s_barrier
  v_mfma_f32_32x32x16_bf16 v[112:127], v[140:143], a[96:99], v[112:127]
  ds_read_b128 v[140:143], v2 offset:36864
  s_waitcnt lgkmcnt(6)
  v_mfma_f32_32x32x16_bf16 v[112:127], v[144:147], a[100:103], v[112:127]
  ds_read_b128 v[144:147], v2 offset:37888
  s_add_u32 s37, s37, 4096
  s_add_u32 m0, m0, 4096
  v_mfma_f32_32x32x16_bf16 v[112:127], v[148:151], a[104:107], v[112:127]
  ds_read_b128 v[148:151], v2 offset:38912
  buffer_load_dwordx4 v2, s[4:7], s37 offen offset:0 sc1 lds
  s_waitcnt lgkmcnt(6)
  v_mfma_f32_32x32x16_bf16 v[112:127], v[152:155], a[108:111], v[112:127]
  ds_read_b128 v[152:155], v2 offset:39936
  v_mfma_f32_32x32x16_bf16 v[112:127], v[156:159], a[112:115], v[112:127]
  ds_read_b128 v[156:159], v2 offset:40960
  buffer_load_dwordx4 v2, s[4:7], s37 offen offset:1024 sc1 lds
  s_waitcnt lgkmcnt(6)
  v_mfma_f32_32x32x16_bf16 v[112:127], v[128:131], a[116:119], v[112:127]
  ds_read_b128 v[128:131], v2 offset:41984
  v_mfma_f32_32x32x16_bf16 v[112:127], v[132:135], a[120:123], v[112:127]
  ds_read_b128 v[132:135], v2 offset:43008
  buffer_load_dwordx4 v2, s[4:7], s37 offen offset:2048 sc1 lds
  s_waitcnt lgkmcnt(6)
  v_mfma_f32_32x32x16_bf16 v[112:127], v[136:139], a[124:127], v[112:127]
  ds_read_b128 v[136:139], v2 offset:44032
  v_mfma_f32_32x32x16_bf16 v[112:127], v[140:143], a[128:131], v[112:127]
  ds_read_b128 v[140:143], v31 offset:19456
  s_waitcnt lgkmcnt(6)
  v_mfma_f32_32x32x16_bf16 v[112:127], v[144:147], a[132:135], v[112:127]
  buffer_load_dwordx4 v2, s[4:7], s37 offen offset:3072 sc1 lds
  v_mfma_f32_32x32x16_bf16 v[112:127], v[148:151], a[136:139], v[112:127]
  s_waitcnt lgkmcnt(4)
  v_mfma_f32_32x32x16_bf16 v[112:127], v[152:155], a[140:143], v[112:127]
  v_mfma_f32_32x32x16_bf16 v[112:127], v[156:159], a[144:147], v[112:127]
  s_waitcnt lgkmcnt(2)
  v_mfma_f32_32x32x16_bf16 v[112:127], v[128:131], a[148:151], v[112:127]
  v_mfma_f32_32x32x16_bf16 v[112:127], v[132:135], a[152:155], v[112:127]
  s_waitcnt lgkmcnt(0)
  v_mfma_f32_32x32x16_bf16 v[112:127], v[136:139], a[156:159], v[112:127]
  v_mfma_f32_32x32x16_bf16 v[112:127], v[140:143], v[172:175], v[112:127]
  s_waitcnt vmcnt(8)
  s_waitcnt lgkmcnt(0)
main_layer:
  s_barrier
  s_cmp_lg_u32 s22, 0
  s_cbranch_scc1 nw0_16
  s_add_u32 s3, s23, 1
  s_mov_b64 exec, 7
  v_mov_b32 v15, s3
  s_mov_b64 exec, 1
  buffer_store_dword v15, v21, s[4:7], 0 offen sc1
  s_mov_b64 exec, -1
nw0_16:
  s_nop 7
  v_mul_f32 v112, v170, v112
  v_mul_f32 v113, v170, v113
  v_mul_f32 v114, v170, v114
  v_mul_f32 v115, v170, v115
  v_cvt_pk_bf16_f32 v226, v112, v113
  v_cvt_pk_bf16_f32 v227, v114, v115
  v_mul_f32 v116, v170, v116
  v_mul_f32 v117, v170, v117
  v_mul_f32 v118, v170, v118
  v_mul_f32 v119, v170, v119
  v_cvt_pk_bf16_f32 v232, v116, v117
  v_cvt_pk_bf16_f32 v233, v118, v119
  v_mul_f32 v120, v170, v120
  v_mul_f32 v121, v170, v121
  v_mul_f32 v122, v170, v122
  v_mul_f32 v123, v170, v123
  v_cvt_pk_bf16_f32 v228, v120, v121
  v_cvt_pk_bf16_f32 v229, v122, v123
  v_mul_f32 v124, v170, v124
  v_mul_f32 v125, v170, v125
  v_mul_f32 v126, v170, v126
  v_mul_f32 v127, v170, v127
  v_cvt_pk_bf16_f32 v230, v124, v125
  v_cvt_pk_bf16_f32 v231, v126, v127
  v_mov_b32 v236, v232
  v_mov_b32 v237, v233
  s_mov_b32 exec_lo, 0
  v_mov_b32 v232, 0
  v_mov_b32 v233, 0
  s_mov_b32 exec_lo, -1
  s_mov_b32 exec_hi, 0
  v_mov_b32 v236, 0
  v_mov_b32 v237, 0
  s_mov_b32 exec_hi, -1
  s_lshl_b32 s3, s23, 2
  s_add_u32 s3, s3, s22
  s_cmp_lg_u32 s3, 3
  s_cbranch_scc1 ct_17
  s_getpc_b64 s[28:29]
pc_18:
  s_sub_u32 s28, s28, pc_18 - interleave_layers__sliding_block__glu_gated_reglu__prompt_kernel
  s_subb_u32 s29, s29, 0
  s_mov_b32 s30, main_last - interleave_layers__sliding_block__glu_gated_reglu__prompt_kernel
  s_mov_b32 s31, 0x20000
  s_and_b32 s3, s21, 7
  s_lshl_b32 s3, s3, 13
  v_lshlrev_b32 v252, 3, v2
  buffer_load_dword v43, v252, s[28:31], s3 offen
ct_17:
  s_mul_i32 s100, s22, 6144
  s_add_u32 s101, s100, 4096
  s_min_u32 s101, s101, 21504
  s_add_u32 s3, s40, s44
  s_sub_u32 s3, s3, 753664
  s_cmp_lt_u32 s20, 2
  s_cmov_b32 s3, 2146435072
  s_add_u32 s28, s3, s100
  s_add_u32 s31, s3, s101
  s_cmp_lt_u32 s22, 2
  s_mov_b32 s29, 57344
  s_cmov_b32 s29, 36864
  s_cmp_lt_u32 s22, 1
  s_mov_b32 s32, 57344
  s_cmov_b32 s32, 36864
  s_add_u32 s29, s29, s100
  s_add_u32 s32, s32, s101
  s_add_u32 s3, s40, s44
  s_sub_u32 s3, s3, 376832
  s_cmp_lt_u32 s20, 1
  s_cmov_b32 s3, 2146435072
  s_add_u32 s33, s3, s100
  s_add_u32 s35, s3, s101
  s_cmp_lt_u32 s22, 2
  s_mov_b32 s34, 70656
  s_cmov_b32 s34, 47104
  s_cmp_lt_u32 s22, 1
  s_mov_b32 s99, 70656
  s_cmov_b32 s99, 47104
  s_add_u32 s34, s34, s100
  s_add_u32 s99, s99, s101
  s_cmp_lg_u32 s22, 0
  s_cbranch_scc1 nw0_14
  s_cmp_eq_u32 s23, 0
  s_cselect_b32 exec_lo, 0x7f, 7
  s_mov_b32 exec_hi, 0
  s_mov_b32 s30, 20000
  buffer_load_dword v254, v21, s[4:7], 0 offen sc1
poll_19:
  s_sleep 5
  buffer_load_dword v255, v21, s[4:7], 0 offen sc1
  s_waitcnt vmcnt(1)
  v_cmp_gt_u32 vcc, v15, v254
  s_cbranch_vccz pdone_20
  s_sleep 5
  buffer_load_dword v254, v21, s[4:7], 0 offen sc1
  s_waitcnt vmcnt(1)
  v_cmp_gt_u32 vcc, v15, v255
  s_cbranch_vccz pdone_20
  s_sub_u32 s30, s30, 1
  s_cmp_lg_u32 s30, 0
  s_cbranch_scc1 poll_19
  s_waitcnt vmcnt(0)
  v_mov_b32 v254, 256
  v_mov_b32 v255, 128
  buffer_store_dword v254, v255, s[16:19], 0 offen
pdone_20:
  s_mov_b64 exec, -1
  s_branch syn_15
nw0_14:
  s_mul_i32 s36, s55, 10240
  s_add_u32 s37, s36, s50
  s_add_u32 s37, s37, 0
  s_add_u32 m0, s36, 0
  s_nop 0
  buffer_load_dwordx4 v2, s[4:7], s37 offen offset:0 sc1 lds
  buffer_load_dwordx4 v2, s[4:7], s37 offen offset:1024 sc1 lds
  buffer_load_dwordx4 v2, s[4:7], s37 offen offset:2048 sc1 lds
  buffer_load_dwordx4 v2, s[4:7], s37 offen offset:3072 sc1 lds
  s_add_u32 s37, s37, 4096
  s_add_u32 m0, m0, 4096
  s_nop 0
  buffer_load_dwordx4 v2, s[4:7], s37 offen offset:0 sc1 lds
  buffer_load_dwordx4 v2, s[4:7], s37 offen offset:1024 sc1 lds
  buffer_load_dwordx4 v2, s[4:7], s37 offen offset:2048 sc1 lds
  buffer_load_dwordx4 v2, s[4:7], s37 offen offset:3072 sc1 lds
  s_add_u32 s37, s37, 4096
  s_add_u32 m0, m0, 4096
  s_nop 0
  buffer_load_dwordx4 v2, s[4:7], s37 offen offset:0 sc1 lds
  buffer_load_dwordx4 v2, s[4:7], s37 offen offset:1024 sc1 lds
syn_15:
  s_barrier
  s_mov_b32 m0, s34
  s_nop 0
  buffer_load_dwordx4 v2, s[4:7], s33 offen offset:0 sc1 lds
  buffer_load_dwordx4 v2, s[4:7], s33 offen offset:1024 sc1 lds
  buffer_load_dwordx4 v2, s[4:7], s33 offen offset:2048 sc1 lds
  buffer_load_dwordx4 v2, s[4:7], s33 offen offset:3072 sc1 lds
  s_mov_b32 m0, s99
  s_nop 0
  buffer_load_dwordx4 v2, s[4:7], s35 offen offset:0 sc1 lds
  buffer_load_dwordx4 v2, s[4:7], s35 offen offset:1024 sc1 lds
  s_mov_b32 m0, s29
  s_nop 0
  buffer_load_dwordx4 v2, s[4:7], s28 offen offset:0 sc1 lds
  buffer_load_dwordx4 v2, s[4:7], s28 offen offset:1024 sc1 lds
  buffer_load_dwordx4 v2, s[4:7], s28 offen offset:2048 sc1 lds
  buffer_load_dwordx4 v2, s[4:7], s28 offen offset:3072 sc1 lds
  s_mov_b32 m0, s32
  s_nop 0
  buffer_load_dwordx4 v2, s[4:7], s31 offen offset:0 sc1 lds
  buffer_load_dwordx4 v2, s[4:7], s31 offen offset:1024 sc1 lds
  ds_read_b64 v[162:163], v23 offset:20480
  ds_read_b128 v[164:167], v22 offset:20480
  ds_read_b128 v[168:171], v22 offset:21504
  s_waitcnt lgkmcnt(0)
  v_mfma_f32_32x32x16_bf16 v[80:95], v[164:167], v[224:227], 0
  v_mfma_f32_32x32x16_bf16 v[80:95], v[162:165], v[232:235], v[80:95]
  v_mfma_f32_32x32x16_bf16 v[208:223], v[168:171], v[228:231], 0
  v_mfma_f32_32x32x16_bf16 v[208:223], v[162:165], v[236:239], v[208:223]
  s_waitcnt vmcnt(6)
  s_barrier
  ds_read_b64 v[174:175], v23 offset:17920
  ds_read_b128 v[176:179], v22 offset:17920
  ds_read_b128 v[180:183], v22 offset:18944
  s_waitcnt lgkmcnt(0)
  v_mfma_f32_32x32x16_bf16 v[48:63], v[176:179], v[224:227], 0
  v_mfma_f32_32x32x16_bf16 v[48:63], v[174:177], v[232:235], v[48:63]
  v_mfma_f32_32x32x16_bf16 v[64:79], v[180:183], v[228:231], 0
  ds_read_b64 v[162:163], v23 offset:15360
  ds_read_b128 v[164:167], v22 offset:15360
  ds_read_b128 v[168:171], v22 offset:16384
  ds_read_b64_tr_b16 v[184:185], v24 offset:23296
  ds_read_b64_tr_b16 v[186:187], v24 offset:24128
  ds_read_b64_tr_b16 v[188:189], v24 offset:24960
  ds_read_b64_tr_b16 v[190:191], v24 offset:25792
  s_nop 3
  v_exp_f32 v48, v48
  v_exp_f32 v49, v49
  v_exp_f32 v50, v50
  v_exp_f32 v51, v51
  v_cvt_pk_bf16_f32 v96, v48, v49
  v_exp_f32 v52, v52
  v_exp_f32 v53, v53
  v_cvt_pk_bf16_f32 v97, v50, v51
  v_exp_f32 v54, v54
  v_exp_f32 v55, v55
  v_mfma_f32_32x32x16_bf16 v[64:79], v[174:177], v[236:239], v[64:79]
  v_cvt_pk_bf16_f32 v98, v52, v53
  v_exp_f32 v56, v56
  v_exp_f32 v57, v57
  v_cvt_pk_bf16_f32 v99, v54, v55
  v_exp_f32 v58, v58
  v_exp_f32 v59, v59
  v_cvt_pk_bf16_f32 v100, v56, v57
  v_exp_f32 v60, v60
  v_exp_f32 v61, v61
  v_cvt_pk_bf16_f32 v101, v58, v59
  v_exp_f32 v62, v62
  v_exp_f32 v63, v63
  v_cvt_pk_bf16_f32 v102, v60, v61
  v_cvt_pk_bf16_f32 v103, v62, v63
  s_waitcnt lgkmcnt(4)
  v_mfma_f32_32x32x16_bf16 v[48:63], v[164:167], v[224:227], 0
  ds_read_b64_tr_b16 v[192:193], v24 offset:23488
  ds_read_b64_tr_b16 v[194:195], v24 offset:24320
  ds_read_b64_tr_b16 v[196:197], v24 offset:25152
  ds_read_b64_tr_b16 v[198:199], v24 offset:25984
  v_exp_f32 v64, v64
  v_exp_f32 v65, v65
  v_exp_f32 v66, v66
  v_exp_f32 v67, v67
  v_mfma_f32_32x32x16_bf16 v[48:63], v[162:165], v[232:235], v[48:63]
  v_cvt_pk_bf16_f32 v104, v64, v65
  v_exp_f32 v68, v68
  v_exp_f32 v69, v69
  v_cvt_pk_bf16_f32 v105, v66, v67
  v_exp_f32 v70, v70
  v_exp_f32 v71, v71
  s_waitcnt lgkmcnt(4)
  v_mfma_f32_32x32x16_bf16 v[128:143], v[184:187], v[96:99], 0
  v_cvt_pk_bf16_f32 v106, v68, v69
  v_exp_f32 v72, v72
  v_exp_f32 v73, v73
  v_cvt_pk_bf16_f32 v107, v70, v71
  v_exp_f32 v74, v74
  v_exp_f32 v75, v75
  v_cvt_pk_bf16_f32 v108, v72, v73
  v_mfma_f32_32x32x16_bf16 v[128:143], v[188:191], v[100:103], v[128:143]
  v_exp_f32 v76, v76
  v_exp_f32 v77, v77
  v_cvt_pk_bf16_f32 v109, v74, v75
  v_exp_f32 v78, v78
  v_exp_f32 v79, v79
  v_cvt_pk_bf16_f32 v110, v76, v77
  v_cvt_pk_bf16_f32 v111, v78, v79
  v_mfma_f32_32x32x16_bf16 v[64:79], v[168:171], v[228:231], 0
  ds_read_b64 v[174:175], v23 offset:12800
  ds_read_b128 v[176:179], v22 offset:12800
  ds_read_b128 v[180:183], v22 offset:13824
  ds_read_b64_tr_b16 v[184:185], v24 offset:19968
  ds_read_b64_tr_b16 v[186:187], v24 offset:20800
  ds_read_b64_tr_b16 v[188:189], v24 offset:21632
  ds_read_b64_tr_b16 v[190:191], v24 offset:22464
  v_exp_f32 v48, v48
  v_exp_f32 v49, v49
  v_exp_f32 v50, v50
  v_mfma_f32_32x32x16_bf16 v[64:79], v[162:165], v[236:239], v[64:79]
  v_exp_f32 v51, v51
  v_cvt_pk_bf16_f32 v96, v48, v49
  v_exp_f32 v52, v52
  v_exp_f32 v53, v53
  v_cvt_pk_bf16_f32 v97, v50, v51
  v_exp_f32 v54, v54
  v_exp_f32 v55, v55
  s_waitcnt lgkmcnt(7)
  v_mfma_f32_32x32x16_bf16 v[144:159], v[192:195], v[104:107], 0
  v_cvt_pk_bf16_f32 v98, v52, v53
  v_exp_f32 v56, v56
  v_exp_f32 v57, v57
  v_cvt_pk_bf16_f32 v99, v54, v55
  v_exp_f32 v58, v58
  v_exp_f32 v59, v59
  v_cvt_pk_bf16_f32 v100, v56, v57
  v_mfma_f32_32x32x16_bf16 v[144:159], v[196:199], v[108:111], v[144:159]
  v_exp_f32 v60, v60
  v_exp_f32 v61, v61
  v_cvt_pk_bf16_f32 v101, v58, v59
  v_exp_f32 v62, v62
  v_exp_f32 v63, v63
  v_cvt_pk_bf16_f32 v102, v60, v61
  v_cvt_pk_bf16_f32 v103, v62, v63
  s_waitcnt lgkmcnt(4)
  v_mfma_f32_32x32x16_bf16 v[48:63], v[176:179], v[224:227], 0
  ds_read_b64_tr_b16 v[192:193], v24 offset:20160
  ds_read_b64_tr_b16 v[194:195], v24 offset:20992
  ds_read_b64_tr_b16 v[196:197], v24 offset:21824
  ds_read_b64_tr_b16 v[198:199], v24 offset:22656
  v_exp_f32 v64, v64
  v_exp_f32 v65, v65
  v_exp_f32 v66, v66
  v_exp_f32 v67, v67
  v_mfma_f32_32x32x16_bf16 v[48:63], v[174:177], v[232:235], v[48:63]
  v_cvt_pk_bf16_f32 v104, v64, v65
  v_exp_f32 v68, v68
  v_exp_f32 v69, v69
  v_cvt_pk_bf16_f32 v105, v66, v67
  v_exp_f32 v70, v70
  v_exp_f32 v71, v71
  s_waitcnt lgkmcnt(4)
  v_mfma_f32_32x32x16_bf16 v[128:143], v[184:187], v[96:99], v[128:143]
  v_cvt_pk_bf16_f32 v106, v68, v69
  v_exp_f32 v72, v72
  v_exp_f32 v73, v73
  v_cvt_pk_bf16_f32 v107, v70, v71
  v_exp_f32 v74, v74
  v_exp_f32 v75, v75
  v_cvt_pk_bf16_f32 v108, v72, v73
  v_mfma_f32_32x32x16_bf16 v[128:143], v[188:191], v[100:103], v[128:143]
  v_exp_f32 v76, v76
  v_exp_f32 v77, v77
  v_cvt_pk_bf16_f32 v109, v74, v75
  v_exp_f32 v78, v78
  v_exp_f32 v79, v79
  v_cvt_pk_bf16_f32 v110, v76, v77
  v_cvt_pk_bf16_f32 v111, v78, v79
  v_mfma_f32_32x32x16_bf16 v[64:79], v[180:183], v[228:231], 0
  ds_read_b64 v[162:163], v23 offset:10240
  ds_read_b128 v[164:167], v22 offset:10240
  ds_read_b128 v[168:171], v22 offset:11264
  ds_read_b64_tr_b16 v[184:185], v24 offset:16640
  ds_read_b64_tr_b16 v[186:187], v24 offset:17472
  ds_read_b64_tr_b16 v[188:189], v24 offset:18304
  ds_read_b64_tr_b16 v[190:191], v24 offset:19136
  v_exp_f32 v48, v48
  v_exp_f32 v49, v49
  v_exp_f32 v50, v50
  v_mfma_f32_32x32x16_bf16 v[64:79], v[174:177], v[236:239], v[64:79]
  v_exp_f32 v51, v51
  v_cvt_pk_bf16_f32 v96, v48, v49
  v_exp_f32 v52, v52
  v_exp_f32 v53, v53
  v_cvt_pk_bf16_f32 v97, v50, v51
  v_exp_f32 v54, v54
  v_exp_f32 v55, v55
  s_waitcnt lgkmcnt(7)
  v_mfma_f32_32x32x16_bf16 v[144:159], v[192:195], v[104:107], v[144:159]
  v_cvt_pk_bf16_f32 v98, v52, v53
  v_exp_f32 v56, v56
  v_exp_f32 v57, v57
  v_cvt_pk_bf16_f32 v99, v54, v55
  v_exp_f32 v58, v58
  v_exp_f32 v59, v59
  v_cvt_pk_bf16_f32 v100, v56, v57
  v_mfma_f32_32x32x16_bf16 v[144:159], v[196:199], v[108:111], v[144:159]
  v_exp_f32 v60, v60
  v_exp_f32 v61, v61
  v_cvt_pk_bf16_f32 v101, v58, v59
  v_exp_f32 v62, v62
  v_exp_f32 v63, v63
  v_cvt_pk_bf16_f32 v102, v60, v61
  v_cvt_pk_bf16_f32 v103, v62, v63
  s_waitcnt lgkmcnt(4)
  v_mfma_f32_32x32x16_bf16 v[48:63], v[164:167], v[224:227], 0
  ds_read_b64_tr_b16 v[192:193], v24 offset:16832
  ds_read_b64_tr_b16 v[194:195], v24 offset:17664
  ds_read_b64_tr_b16 v[196:197], v24 offset:18496
  ds_read_b64_tr_b16 v[198:199], v24 offset:19328
  v_exp_f32 v64, v64
  v_exp_f32 v65, v65
  v_exp_f32 v66, v66
  v_exp_f32 v67, v67
  v_mfma_f32_32x32x16_bf16 v[48:63], v[162:165], v[232:235], v[48:63]
  v_cvt_pk_bf16_f32 v104, v64, v65
  v_exp_f32 v68, v68
  v_exp_f32 v69, v69
  v_cvt_pk_bf16_f32 v105, v66, v67
  v_exp_f32 v70, v70
  v_exp_f32 v71, v71
  s_waitcnt lgkmcnt(4)
  v_mfma_f32_32x32x16_bf16 v[128:143], v[184:187], v[96:99], v[128:143]
  v_cvt_pk_bf16_f32 v106, v68, v69
  v_exp_f32 v72, v72
  v_exp_f32 v73, v73
  v_cvt_pk_bf16_f32 v107, v70, v71
  v_exp_f32 v74, v74
  v_exp_f32 v75, v75
  v_cvt_pk_bf16_f32 v108, v72, v73
  v_mfma_f32_32x32x16_bf16 v[128:143], v[188:191], v[100:103], v[128:143]
  v_exp_f32 v76, v76
  v_exp_f32 v77, v77
  v_cvt_pk_bf16_f32 v109, v74, v75
  v_exp_f32 v78, v78
  v_exp_f32 v79, v79
  v_cvt_pk_bf16_f32 v110, v76, v77
  v_cvt_pk_bf16_f32 v111, v78, v79
  s_waitcnt vmcnt(0)
  s_barrier
  v_mfma_f32_32x32x16_bf16 v[64:79], v[168:171], v[228:231], 0
  ds_read_b64 v[174:175], v23 offset:7680
  ds_read_b128 v[176:179], v22 offset:7680
  ds_read_b128 v[180:183], v22 offset:8704
  ds_read_b64_tr_b16 v[184:185], v24 offset:13312
  ds_read_b64_tr_b16 v[186:187], v24 offset:14144
  ds_read_b64_tr_b16 v[188:189], v24 offset:14976
  ds_read_b64_tr_b16 v[190:191], v24 offset:15808
  v_exp_f32 v48, v48
  v_exp_f32 v49, v49
  v_exp_f32 v50, v50
  v_mfma_f32_32x32x16_bf16 v[64:79], v[162:165], v[236:239], v[64:79]
  v_exp_f32 v51, v51
  v_cvt_pk_bf16_f32 v96, v48, v49
  v_exp_f32 v52, v52
  v_exp_f32 v53, v53
  v_cvt_pk_bf16_f32 v97, v50, v51
  v_exp_f32 v54, v54
  v_exp_f32 v55, v55
  s_waitcnt lgkmcnt(7)
  v_mfma_f32_32x32x16_bf16 v[144:159], v[192:195], v[104:107], v[144:159]
  v_cvt_pk_bf16_f32 v98, v52, v53
  v_exp_f32 v56, v56
  v_exp_f32 v57, v57
  v_cvt_pk_bf16_f32 v99, v54, v55
  v_exp_f32 v58, v58
  v_exp_f32 v59, v59
  v_cvt_pk_bf16_f32 v100, v56, v57
  v_mfma_f32_32x32x16_bf16 v[144:159], v[196:199], v[108:111], v[144:159]
  v_exp_f32 v60, v60
  v_exp_f32 v61, v61
  v_cvt_pk_bf16_f32 v101, v58, v59
  v_exp_f32 v62, v62
  v_exp_f32 v63, v63
  v_cvt_pk_bf16_f32 v102, v60, v61
  v_cvt_pk_bf16_f32 v103, v62, v63
  s_waitcnt lgkmcnt(4)
  v_mfma_f32_32x32x16_bf16 v[48:63], v[176:179], v[224:227], 0
  ds_read_b64_tr_b16 v[192:193], v24 offset:13504
  ds_read_b64_tr_b16 v[194:195], v24 offset:14336
  ds_read_b64_tr_b16 v[196:197], v24 offset:15168
  ds_read_b64_tr_b16 v[198:199], v24 offset:16000
  v_exp_f32 v64, v64
  v_exp_f32 v65, v65
  v_exp_f32 v66, v66
  v_exp_f32 v67, v67
  v_mfma_f32_32x32x16_bf16 v[48:63], v[174:177], v[232:235], v[48:63]
  v_cvt_pk_bf16_f32 v104, v64, v65
  v_exp_f32 v68, v68
  v_exp_f32 v69, v69
  v_cvt_pk_bf16_f32 v105, v66, v67
  v_exp_f32 v70, v70
  v_exp_f32 v71, v71
  s_waitcnt lgkmcnt(4)
  v_mfma_f32_32x32x16_bf16 v[128:143], v[184:187], v[96:99], v[128:143]
  v_cvt_pk_bf16_f32 v106, v68, v69
  v_exp_f32 v72, v72
  v_exp_f32 v73, v73
  v_cvt_pk_bf16_f32 v107, v70, v71
  v_exp_f32 v74, v74
  v_exp_f32 v75, v75
  v_cvt_pk_bf16_f32 v108, v72, v73
  v_mfma_f32_32x32x16_bf16 v[128:143], v[188:191], v[100:103], v[128:143]
  v_exp_f32 v76, v76
  v_exp_f32 v77, v77
  v_cvt_pk_bf16_f32 v109, v74, v75
  v_exp_f32 v78, v78
  v_exp_f32 v79, v79
  v_cvt_pk_bf16_f32 v110, v76, v77
  v_cvt_pk_bf16_f32 v111, v78, v79
  v_mfma_f32_32x32x16_bf16 v[64:79], v[180:183], v[228:231], 0
  ds_read_b64 v[162:163], v23 offset:5120
  ds_read_b128 v[164:167], v22 offset:5120
  ds_read_b128 v[168:171], v22 offset:6144
  ds_read_b64_tr_b16 v[184:185], v24 offset:9984
  ds_read_b64_tr_b16 v[186:187], v24 offset:10816
  ds_read_b64_tr_b16 v[188:189], v24 offset:11648
  ds_read_b64_tr_b16 v[190:191], v24 offset:12480
  v_exp_f32 v48, v48
  v_exp_f32 v49, v49
  v_exp_f32 v50, v50
  v_mfma_f32_32x32x16_bf16 v[64:79], v[174:177], v[236:239], v[64:79]
  v_exp_f32 v51, v51
  v_cvt_pk_bf16_f32 v96, v48, v49
  v_exp_f32 v52, v52
  v_exp_f32 v53, v53
  v_cvt_pk_bf16_f32 v97, v50, v51
  v_exp_f32 v54, v54
  v_exp_f32 v55, v55
  s_waitcnt lgkmcnt(7)
  v_mfma_f32_32x32x16_bf16 v[144:159], v[192:195], v[104:107], v[144:159]
  v_cvt_pk_bf16_f32 v98, v52, v53
  v_exp_f32 v56, v56
  v_exp_f32 v57, v57
  v_cvt_pk_bf16_f32 v99, v54, v55
  v_exp_f32 v58, v58
  v_exp_f32 v59, v59
  v_cvt_pk_bf16_f32 v100, v56, v57
  v_mfma_f32_32x32x16_bf16 v[144:159], v[196:199], v[108:111], v[144:159]
  v_exp_f32 v60, v60
  v_exp_f32 v61, v61
  v_cvt_pk_bf16_f32 v101, v58, v59
  v_exp_f32 v62, v62
  v_exp_f32 v63, v63
  v_cvt_pk_bf16_f32 v102, v60, v61
  v_cvt_pk_bf16_f32 v103, v62, v63
  s_waitcnt lgkmcnt(4)
  v_mfma_f32_32x32x16_bf16 v[48:63], v[164:167], v[224:227], 0
  ds_read_b64_tr_b16 v[192:193], v24 offset:10176
  ds_read_b64_tr_b16 v[194:195], v24 offset:11008
  ds_read_b64_tr_b16 v[196:197], v24 offset:11840
  ds_read_b64_tr_b16 v[198:199], v24 offset:12672
  v_exp_f32 v64, v64
  v_exp_f32 v65, v65
  v_exp_f32 v66, v66
  v_exp_f32 v67, v67
  v_mfma_f32_32x32x16_bf16 v[48:63], v[162:165], v[232:235], v[48:63]
  v_cvt_pk_bf16_f32 v104, v64, v65
  v_exp_f32 v68, v68
  v_exp_f32 v69, v69
  v_cvt_pk_bf16_f32 v105, v66, v67
  v_exp_f32 v70, v70
  v_exp_f32 v71, v71
  s_waitcnt lgkmcnt(4)
  v_mfma_f32_32x32x16_bf16 v[128:143], v[184:187], v[96:99], v[128:143]
  v_cvt_pk_bf16_f32 v106, v68, v69
  v_exp_f32 v72, v72
  v_exp_f32 v73, v73
  v_cvt_pk_bf16_f32 v107, v70, v71
  v_exp_f32 v74, v74
  v_exp_f32 v75, v75
  v_cvt_pk_bf16_f32 v108, v72, v73
  v_mfma_f32_32x32x16_bf16 v[128:143], v[188:191], v[100:103], v[128:143]
  v_exp_f32 v76, v76
  v_exp_f32 v77, v77
  v_cvt_pk_bf16_f32 v109, v74, v75
  v_exp_f32 v78, v78
  v_exp_f32 v79, v79
  v_cvt_pk_bf16_f32 v110, v76, v77
  v_cvt_pk_bf16_f32 v111, v78, v79
  v_mfma_f32_32x32x16_bf16 v[64:79], v[168:171], v[228:231], 0
  ds_read_b64 v[174:175], v23 offset:2560
  ds_read_b128 v[176:179], v22 offset:2560
  ds_read_b128 v[180:183], v22 offset:3584
  ds_read_b64_tr_b16 v[184:185], v24 offset:6656
  ds_read_b64_tr_b16 v[186:187], v24 offset:7488
  ds_read_b64_tr_b16 v[188:189], v24 offset:8320
  ds_read_b64_tr_b16 v[190:191], v24 offset:9152
  v_exp_f32 v48, v48
  v_exp_f32 v49, v49
  v_exp_f32 v50, v50
  v_mfma_f32_32x32x16_bf16 v[64:79], v[162:165], v[236:239], v[64:79]
  v_exp_f32 v51, v51
  v_cvt_pk_bf16_f32 v96, v48, v49
  v_exp_f32 v52, v52
  v_exp_f32 v53, v53
  v_cvt_pk_bf16_f32 v97, v50, v51
  v_exp_f32 v54, v54
  v_exp_f32 v55, v55
  s_waitcnt lgkmcnt(7)
  v_mfma_f32_32x32x16_bf16 v[144:159], v[192:195], v[104:107], v[144:159]
  v_cvt_pk_bf16_f32 v98, v52, v53
  v_exp_f32 v56, v56
  v_exp_f32 v57, v57
  v_cvt_pk_bf16_f32 v99, v54, v55
  v_exp_f32 v58, v58
  v_exp_f32 v59, v59
  v_cvt_pk_bf16_f32 v100, v56, v57
  v_mfma_f32_32x32x16_bf16 v[144:159], v[196:199], v[108:111], v[144:159]
  v_exp_f32 v60, v60
  v_exp_f32 v61, v61
  v_cvt_pk_bf16_f32 v101, v58, v59
  v_exp_f32 v62, v62
  v_exp_f32 v63, v63
  v_cvt_pk_bf16_f32 v102, v60, v61
  v_cvt_pk_bf16_f32 v103, v62, v63
  s_waitcnt lgkmcnt(4)
  v_mfma_f32_32x32x16_bf16 v[48:63], v[176:179], v[224:227], 0
  ds_read_b64_tr_b16 v[192:193], v24 offset:6848
  ds_read_b64_tr_b16 v[194:195], v24 offset:7680
  ds_read_b64_tr_b16 v[196:197], v24 offset:8512
  ds_read_b64_tr_b16 v[198:199], v24 offset:9344
  v_exp_f32 v64, v64
  v_exp_f32 v65, v65
  v_exp_f32 v66, v66
  v_exp_f32 v67, v67
  v_mfma_f32_32x32x16_bf16 v[48:63], v[174:177], v[232:235], v[48:63]
  v_cvt_pk_bf16_f32 v104, v64, v65
  v_exp_f32 v68, v68
  v_exp_f32 v69, v69
  v_cvt_pk_bf16_f32 v105, v66, v67
  v_exp_f32 v70, v70
  v_exp_f32 v71, v71
  s_waitcnt lgkmcnt(4)
  v_mfma_f32_32x32x16_bf16 v[128:143], v[184:187], v[96:99], v[128:143]
  v_cvt_pk_bf16_f32 v106, v68, v69
  v_exp_f32 v72, v72
  v_exp_f32 v73, v73
  v_cvt_pk_bf16_f32 v107, v70, v71
  v_exp_f32 v74, v74
  v_exp_f32 v75, v75
  v_cvt_pk_bf16_f32 v108, v72, v73
  v_mfma_f32_32x32x16_bf16 v[128:143], v[188:191], v[100:103], v[128:143]
  v_exp_f32 v76, v76
  v_exp_f32 v77, v77
  v_cvt_pk_bf16_f32 v109, v74, v75
  v_exp_f32 v78, v78
  v_exp_f32 v79, v79
  v_cvt_pk_bf16_f32 v110, v76, v77
  v_cvt_pk_bf16_f32 v111, v78, v79
  v_mfma_f32_32x32x16_bf16 v[64:79], v[180:183], v[228:231], 0
  ds_read_b64 v[162:163], v23 offset:0
  ds_read_b128 v[164:167], v22 offset:0
  ds_read_b128 v[168:171], v22 offset:1024
  ds_read_b64_tr_b16 v[184:185], v24 offset:3328
  ds_read_b64_tr_b16 v[186:187], v24 offset:4160
  ds_read_b64_tr_b16 v[188:189], v24 offset:4992
  ds_read_b64_tr_b16 v[190:191], v24 offset:5824
  v_exp_f32 v48, v48
  v_exp_f32 v49, v49
  v_exp_f32 v50, v50
  v_mfma_f32_32x32x16_bf16 v[64:79], v[174:177], v[236:239], v[64:79]
  v_exp_f32 v51, v51
  v_cvt_pk_bf16_f32 v96, v48, v49
  v_exp_f32 v52, v52
  v_exp_f32 v53, v53
  v_cvt_pk_bf16_f32 v97, v50, v51
  v_exp_f32 v54, v54
  v_exp_f32 v55, v55
  s_waitcnt lgkmcnt(7)
  v_mfma_f32_32x32x16_bf16 v[144:159], v[192:195], v[104:107], v[144:159]
  v_cvt_pk_bf16_f32 v98, v52, v53
  v_exp_f32 v56, v56
  v_exp_f32 v57, v57
  v_cvt_pk_bf16_f32 v99, v54, v55
  v_exp_f32 v58, v58
  v_exp_f32 v59, v59
  v_cvt_pk_bf16_f32 v100, v56, v57
  v_mfma_f32_32x32x16_bf16 v[144:159], v[196:199], v[108:111], v[144:159]
  v_exp_f32 v60, v60
  v_exp_f32 v61, v61
  v_cvt_pk_bf16_f32 v101, v58, v59
  v_exp_f32 v62, v62
  v_exp_f32 v63, v63
  v_cvt_pk_bf16_f32 v102, v60, v61
  v_cvt_pk_bf16_f32 v103, v62, v63
  s_waitcnt lgkmcnt(4)
  v_mfma_f32_32x32x16_bf16 v[48:63], v[164:167], v[224:227], 0
  ds_read_b64_tr_b16 v[192:193], v24 offset:3520
  ds_read_b64_tr_b16 v[194:195], v24 offset:4352
  ds_read_b64_tr_b16 v[196:197], v24 offset:5184
  ds_read_b64_tr_b16 v[198:199], v24 offset:6016
  v_exp_f32 v64, v64
  v_exp_f32 v65, v65
  v_exp_f32 v66, v66
  v_exp_f32 v67, v67
  v_mfma_f32_32x32x16_bf16 v[48:63], v[162:165], v[232:235], v[48:63]
  v_cvt_pk_bf16_f32 v104, v64, v65
  v_exp_f32 v68, v68
  v_exp_f32 v69, v69
  v_cvt_pk_bf16_f32 v105, v66, v67
  v_exp_f32 v70, v70
  v_exp_f32 v71, v71
  s_waitcnt lgkmcnt(4)
  v_mfma_f32_32x32x16_bf16 v[128:143], v[184:187], v[96:99], v[128:143]
  v_cvt_pk_bf16_f32 v106, v68, v69
  v_exp_f32 v72, v72
  v_exp_f32 v73, v73
  v_cvt_pk_bf16_f32 v107, v70, v71
  v_exp_f32 v74, v74
  v_exp_f32 v75, v75
  v_cvt_pk_bf16_f32 v108, v72, v73
  v_mfma_f32_32x32x16_bf16 v[128:143], v[188:191], v[100:103], v[128:143]
  v_exp_f32 v76, v76
  v_exp_f32 v77, v77
  v_cvt_pk_bf16_f32 v109, v74, v75
  v_exp_f32 v78, v78
  v_exp_f32 v79, v79
  v_cvt_pk_bf16_f32 v110, v76, v77
  v_cvt_pk_bf16_f32 v111, v78, v79
  v_cndmask_b32 v48, v48, v80, s[64:65]
  v_cndmask_b32 v49, v49, v81, s[66:67]
  v_cndmask_b32 v50, v50, v82, s[68:69]
  v_cndmask_b32 v51, v51, v83, s[70:71]
  v_cndmask_b32 v52, v52, v84, s[72:73]
  v_cndmask_b32 v53, v53, v85, s[74:75]
  v_cndmask_b32 v54, v54, v86, s[76:77]
  v_cndmask_b32 v55, v55, v87, s[78:79]
  v_cndmask_b32 v56, v56, v88, s[80:81]
  v_cndmask_b32 v57, v57, v89, s[82:83]
  v_cndmask_b32 v58, v58, v90, s[84:85]
  v_cndmask_b32 v59, v59, v91, s[86:87]
  v_cndmask_b32 v60, v60, v92, s[88:89]
  v_cndmask_b32 v61, v61, v93, s[90:91]
  v_cndmask_b32 v62, v62, v94, s[92:93]
  v_cndmask_b32 v63, v63, v95, s[94:95]
  s_waitcnt lgkmcnt(0)
  v_mfma_f32_32x32x16_bf16 v[144:159], v[192:195], v[104:107], v[144:159]
  v_mfma_f32_32x32x16_bf16 v[144:159], v[196:199], v[108:111], v[144:159]
  v_mfma_f32_32x32x16_bf16 v[64:79], v[168:171], v[228:231], 0
  ds_read_b64_tr_b16 v[184:185], v24 offset:0
  ds_read_b64_tr_b16 v[186:187], v24 offset:832
  ds_read_b64_tr_b16 v[188:189], v24 offset:1664
  ds_read_b64_tr_b16 v[190:191], v24 offset:2496
  ds_read_b64_tr_b16 v[200:201], v24 offset:26624
  ds_read_b64_tr_b16 v[202:203], v24 offset:27456
  ds_read_b64_tr_b16 v[204:205], v24 offset:28288
  ds_read_b64_tr_b16 v[206:207], v24 offset:29120
  v_exp_f32 v48, v48
  v_exp_f32 v49, v49
  v_exp_f32 v50, v50
  v_exp_f32 v51, v51
  v_cvt_pk_bf16_f32 v96, v48, v49
  v_exp_f32 v52, v52
  v_exp_f32 v53, v53
  v_cvt_pk_bf16_f32 v97, v50, v51
  v_exp_f32 v54, v54
  v_exp_f32 v55, v55
  v_cvt_pk_bf16_f32 v98, v52, v53
  v_exp_f32 v56, v56
  v_exp_f32 v57, v57
  v_cvt_pk_bf16_f32 v99, v54, v55
  v_mfma_f32_32x32x16_bf16 v[64:79], v[162:165], v[236:239], v[64:79]
  v_exp_f32 v58, v58
  v_exp_f32 v59, v59
  v_cvt_pk_bf16_f32 v100, v56, v57
  v_exp_f32 v60, v60
  v_exp_f32 v61, v61
  v_cvt_pk_bf16_f32 v101, v58, v59
  v_exp_f32 v62, v62
  v_exp_f32 v63, v63
  v_cvt_pk_bf16_f32 v102, v60, v61
  v_cvt_pk_bf16_f32 v103, v62, v63
  v_and_b32 v112, v32, v96
  v_bfi_b32 v96, v32, 0, v96
  v_and_b32 v113, v33, v97
  v_bfi_b32 v97, v33, 0, v97
  v_and_b32 v114, v34, v98
  v_bfi_b32 v98, v34, 0, v98
  v_and_b32 v115, v35, v99
  v_bfi_b32 v99, v35, 0, v99
  v_and_b32 v116, v36, v100
  v_bfi_b32 v100, v36, 0, v100
  v_and_b32 v117, v37, v101
  v_bfi_b32 v101, v37, 0, v101
  v_and_b32 v118, v38, v102
  v_bfi_b32 v102, v38, 0, v102
  v_and_b32 v119, v39, v103
  v_bfi_b32 v103, v39, 0, v103
  v_cndmask_b32 v64, v64, v208, s[64:65]
  v_cndmask_b32 v65, v65, v209, s[66:67]
  v_cndmask_b32 v66, v66, v210, s[68:69]
  v_cndmask_b32 v67, v67, v211, s[70:71]
  v_cndmask_b32 v68, v68, v212, s[72:73]
  v_cndmask_b32 v69, v69, v213, s[74:75]
  v_cndmask_b32 v70, v70, v214, s[76:77]
  v_cndmask_b32 v71, v71, v215, s[78:79]
  v_cndmask_b32 v72, v72, v216, s[80:81]
  v_cndmask_b32 v73, v73, v217, s[82:83]
  v_cndmask_b32 v74, v74, v218, s[84:85]
  v_cndmask_b32 v75, v75, v219, s[86:87]
  v_cndmask_b32 v76, v76, v220, s[88:89]
  v_cndmask_b32 v77, v77, v221, s[90:91]
  v_cndmask_b32 v78, v78, v222, s[92:93]
  v_cndmask_b32 v79, v79, v223, s[94:95]
  s_waitcnt lgkmcnt(4)
  v_mfma_f32_32x32x16_bf16 v[128:143], v[184:187], v[96:99], v[128:143]
  v_mfma_f32_32x32x16_bf16 v[128:143], v[188:191], v[100:103], v[128:143]
  s_waitcnt lgkmcnt(0)
  v_mfma_f32_32x32x16_bf16 v[128:143], v[200:203], v[112:115], v[128:143]
  v_mfma_f32_32x32x16_bf16 v[128:143], v[204:207], v[116:119], v[128:143]
  ds_read_b64_tr_b16 v[192:193], v24 offset:192
  ds_read_b64_tr_b16 v[194:195], v24 offset:1024
  ds_read_b64_tr_b16 v[196:197], v24 offset:1856
  ds_read_b64_tr_b16 v[198:199], v24 offset:2688
  ds_read_b64_tr_b16 v[200:201], v24 offset:26816
  ds_read_b64_tr_b16 v[202:203], v24 offset:27648
  ds_read_b64_tr_b16 v[204:205], v24 offset:28480
  ds_read_b64_tr_b16 v[206:207], v24 offset:29312
  v_exp_f32 v64, v64
  v_exp_f32 v65, v65
  v_exp_f32 v66, v66
  v_exp_f32 v67, v67
  v_cvt_pk_bf16_f32 v104, v64, v65
  v_exp_f32 v68, v68
  v_exp_f32 v69, v69
  v_cvt_pk_bf16_f32 v105, v66, v67
  v_exp_f32 v70, v70
  v_exp_f32 v71, v71
  v_cvt_pk_bf16_f32 v106, v68, v69
  v_exp_f32 v72, v72
  v_exp_f32 v73, v73
  v_cvt_pk_bf16_f32 v107, v70, v71
  v_exp_f32 v74, v74
  v_exp_f32 v75, v75
  v_cvt_pk_bf16_f32 v108, v72, v73
  v_exp_f32 v76, v76
  v_exp_f32 v77, v77
  v_cvt_pk_bf16_f32 v109, v74, v75
  v_exp_f32 v78, v78
  v_exp_f32 v79, v79
  v_cvt_pk_bf16_f32 v110, v76, v77
  v_cvt_pk_bf16_f32 v111, v78, v79
  v_and_b32 v112, v32, v104
  v_bfi_b32 v104, v32, 0, v104
  v_and_b32 v113, v33, v105
  v_bfi_b32 v105, v33, 0, v105
  v_and_b32 v114, v34, v106
  v_bfi_b32 v106, v34, 0, v106
  v_and_b32 v115, v35, v107
  v_bfi_b32 v107, v35, 0, v107
  v_and_b32 v116, v36, v108
  v_bfi_b32 v108, v36, 0, v108
  v_and_b32 v117, v37, v109
  v_bfi_b32 v109, v37, 0, v109
  v_and_b32 v118, v38, v110
  v_bfi_b32 v110, v38, 0, v110
  v_and_b32 v119, v39, v111
  v_bfi_b32 v111, v39, 0, v111
  s_waitcnt lgkmcnt(4)
  v_mfma_f32_32x32x16_bf16 v[144:159], v[192:195], v[104:107], v[144:159]
  v_mfma_f32_32x32x16_bf16 v[144:159], v[196:199], v[108:111], v[144:159]
  s_waitcnt lgkmcnt(0)
  v_mfma_f32_32x32x16_bf16 v[144:159], v[200:203], v[112:115], v[144:159]
  v_mfma_f32_32x32x16_bf16 v[144:159], v[204:207], v[116:119], v[144:159]
  s_nop 11
  v_min_f32 v48, v140, v144
  v_max_f32 v49, v140, v144
  v_cmp_u_f32 s[36:37], v140, v144
  v_cmp_gt_f32 vcc, 0x21800000, v48
  s_nop 0
  s_or_b64 s[36:37], s[36:37], vcc
  v_cmp_lt_f32 vcc, 0x5d800000, v49
  s_nop 0
  s_or_b64 s[36:37], s[36:37], vcc
  s_cbranch_scc1 main_slow
main_slow_back:
  s_barrier
  v_rcp_f32 v48, v140
  v_rcp_f32 v49, v144
  s_nop 0
  v_mul_f32 v132, v48, v132
  v_mul_f32 v133, v48, v133
  v_mul_f32 v134, v48, v134
  v_mul_f32 v135, v48, v135
  v_cvt_pk_bf16_f32 v52, v132, v133
  v_cvt_pk_bf16_f32 v53, v134, v135
  v_mul_f32 v136, v48, v136
  v_mul_f32 v137, v48, v137
  v_mul_f32 v138, v48, v138
  v_mul_f32 v139, v48, v139
  v_cvt_pk_bf16_f32 v54, v136, v137
  v_cvt_pk_bf16_f32 v55, v138, v139
  buffer_store_dwordx4 v[52:55], v14, s[4:7], s40 offen sc1
  v_mul_f32 v148, v49, v148
  v_mul_f32 v149, v49, v149
  v_mul_f32 v150, v49, v150
  v_mul_f32 v151, v49, v151
  v_cvt_pk_bf16_f32 v56, v148, v149
  v_cvt_pk_bf16_f32 v57, v150, v151
  v_mul_f32 v152, v49, v152
  v_mul_f32 v153, v49, v153
  v_mul_f32 v154, v49, v154
  v_mul_f32 v155, v49, v155
  v_cvt_pk_bf16_f32 v58, v152, v153
  v_cvt_pk_bf16_f32 v59, v154, v155
  buffer_store_dwordx4 v[56:59], v14, s[4:7], s40 offen offset:768 sc1
  v_mul_f32 v128, v48, v128
  v_mul_f32 v129, v48, v129
  v_mul_f32 v130, v48, v130
  v_mul_f32 v131, v48, v131
  v_cvt_pk_bf16_f32 v60, v128, v129
  v_cvt_pk_bf16_f32 v61, v130, v131
  v_mul_f32 v156, v49, v156
  v_mul_f32 v157, v49, v157
  v_mul_f32 v158, v49, v158
  v_mul_f32 v159, v49, v159
  v_cvt_pk_bf16_f32 v62, v156, v157
  v_cvt_pk_bf16_f32 v63, v158, v159
  s_mov_b32 exec_lo, 0
  buffer_store_dwordx4 v[60:63], v16, s[4:7], s40 offen offset:512 sc1
  s_mov_b32 exec_lo, -1
  s_cmp_eq_u32 s22, 0
  s_cbranch_scc1 p0_23
  s_mul_i32 s36, s55, 14336
  s_add_u32 s37, s36, s50
  s_add_u32 s37, s37, 61440
  s_add_u32 m0, s36, 36864
  s_nop 0
  buffer_load_dwordx4 v2, s[4:7], s37 offen offset:0 sc1 lds
  buffer_load_dwordx4 v2, s[4:7], s37 offen offset:1024 sc1 lds
  buffer_load_dwordx4 v2, s[4:7], s37 offen offset:2048 sc1 lds
  buffer_load_dwordx4 v2, s[4:7], s37 offen offset:3072 sc1 lds
  s_add_u32 s37, s37, 4096
  s_add_u32 m0, m0, 4096
  s_nop 0
  buffer_load_dwordx4 v2, s[4:7], s37 offen offset:0 sc1 lds
  buffer_load_dwordx4 v2, s[4:7], s37 offen offset:1024 sc1 lds
  buffer_load_dwordx4 v2, s[4:7], s37 offen offset:2048 sc1 lds
  buffer_load_dwordx4 v2, s[4:7], s37 offen offset:3072 sc1 lds
  s_add_u32 s37, s37, 4096
  s_add_u32 m0, m0, 4096
  s_nop 0
  buffer_load_dwordx4 v2, s[4:7], s37 offen offset:0 sc1 lds
  buffer_load_dwordx4 v2, s[4:7], s37 offen offset:1024 sc1 lds
  buffer_load_dwordx4 v2, s[4:7], s37 offen offset:2048 sc1 lds
  buffer_load_dwordx4 v2, s[4:7], s37 offen offset:3072 sc1 lds
  s_add_u32 s37, s37, 4096
  s_add_u32 m0, m0, 4096
  s_nop 0
  buffer_load_dwordx4 v2, s[4:7], s37 offen offset:0 sc1 lds
  buffer_load_dwordx4 v2, s[4:7], s37 offen offset:1024 sc1 lds
  s_waitcnt vmcnt(14) lgkmcnt(0)
  s_branch pe_24
p0_23:
  s_waitcnt vmcnt(0) lgkmcnt(0)
pe_24:
  s_barrier
  s_add_u32 s41, s41, 16
  s_cmp_lg_u32 s22, 0
  s_cbranch_scc1 nw0_21
  s_mov_b64 exec, 1
  v_mov_b32 v252, 1
  s_and_b32 s3, s21, 0
  s_lshl_b32 s3, s3, 7
  buffer_atomic_add v252, v20, s[4:7], s3 offen sc0 sc1
  s_mov_b64 exec, 1
  s_mov_b64 exec, -1
  s_mul_i32 s34, s27, 10240
  s_add_u32 s34, s34, s52
  s_add_u32 s34, s34, 204800
  s_add_u32 s35, s34, 4096
  buffer_load_dwordx4 v[44:47], v2, s[4:7], s34 offen offset:0 sc1
  buffer_load_dwordx4 v[48:51], v2, s[4:7], s34 offen offset:1024 sc1
  buffer_load_dwordx4 v[52:55], v2, s[4:7], s34 offen offset:2048 sc1
  buffer_load_dwordx4 v[56:59], v2, s[4:7], s34 offen offset:3072 sc1
  buffer_load_dwordx4 v[60:63], v2, s[4:7], s35 offen offset:0 sc1
  s_mul_i32 s34, s27, 10240
  s_add_u32 s34, s34, s52
  s_add_u32 s34, s34, 209920
  s_add_u32 s35, s34, 4096
  buffer_load_dwordx4 v[236:239], v2, s[4:7], s34 offen offset:0 sc1
  buffer_load_dwordx4 v[244:247], v2, s[4:7], s34 offen offset:1024 sc1
  buffer_load_dwordx4 v[248:251], v2, s[4:7], s34 offen offset:2048 sc1
  buffer_load_dwordx4 v[208:211], v2, s[4:7], s34 offen offset:3072 sc1
  buffer_load_dwordx4 v[212:215], v2, s[4:7], s35 offen offset:0 sc1
  s_cmp_lg_u32 s23, 0
  s_cbranch_scc1 wr_26
  s_mul_i32 s34, s27, 10240
  s_add_u32 s34, s34, s52
  s_add_u32 s34, s34, 225280
  s_add_u32 s35, s34, 4096
  buffer_load_dwordx4 a[160:163], v2, s[4:7], s34 offen offset:0 sc1
  buffer_load_dwordx4 a[164:167], v2, s[4:7], s34 offen offset:1024 sc1
  buffer_load_dwordx4 a[168:171], v2, s[4:7], s34 offen offset:2048 sc1
  buffer_load_dwordx4 a[172:175], v2, s[4:7], s34 offen offset:3072 sc1
  buffer_load_dwordx4 a[176:179], v2, s[4:7], s35 offen offset:0 sc1
  s_mul_i32 s34, s27, 10240
  s_add_u32 s34, s34, s52
  s_add_u32 s34, s34, 230400
  s_add_u32 s35, s34, 4096
  buffer_load_dwordx4 a[180:183], v2, s[4:7], s34 offen offset:0 sc1
  buffer_load_dwordx4 a[184:187], v2, s[4:7], s34 offen offset:1024 sc1
  buffer_load_dwordx4 a[188:191], v2, s[4:7], s34 offen offset:2048 sc1
  buffer_load_dwordx4 a[192:195], v2, s[4:7], s34 offen offset:3072 sc1
  buffer_load_dwordx4 a[196:199], v2, s[4:7], s35 offen offset:0 sc1
  s_mul_i32 s34, s27, 10240
  s_add_u32 s34, s34, s52
  s_add_u32 s34, s34, 245760
  s_add_u32 s35, s34, 4096
  buffer_load_dwordx4 a[200:203], v2, s[4:7], s34 offen offset:0 sc1
  buffer_load_dwordx4 a[204:207], v2, s[4:7], s34 offen offset:1024 sc1
  buffer_load_dwordx4 a[208:211], v2, s[4:7], s34 offen offset:2048 sc1
  buffer_load_dwordx4 a[212:215], v2, s[4:7], s34 offen offset:3072 sc1
  buffer_load_dwordx4 a[216:219], v2, s[4:7], s35 offen offset:0 sc1
  s_mul_i32 s34, s27, 10240
  s_add_u32 s34, s34, s52
  s_add_u32 s34, s34, 250880
  s_add_u32 s35, s34, 4096
  buffer_load_dwordx4 a[220:223], v2, s[4:7], s34 offen offset:0 sc1
  buffer_load_dwordx4 a[224:227], v2, s[4:7], s34 offen offset:1024 sc1
  buffer_load_dwordx4 a[228:231], v2, s[4:7], s34 offen offset:2048 sc1
  buffer_load_dwordx4 a[232:235], v2, s[4:7], s34 offen offset:3072 sc1
  buffer_load_dwordx4 a[236:239], v2, s[4:7], s35 offen offset:0 sc1
  s_mul_i32 s34, s27, 10240
  s_add_u32 s34, s34, s52
  s_add_u32 s34, s34, 266240
  s_add_u32 s35, s34, 4096
  buffer_load_dwordx4 a[240:243], v2, s[4:7], s34 offen offset:0 sc1
  buffer_load_dwordx4 a[244:247], v2, s[4:7], s34 offen offset:1024 sc1
  buffer_load_dwordx4 a[248:251], v2, s[4:7], s34 offen offset:2048 sc1
  buffer_load_dwordx4 a[252:255], v2, s[4:7], s34 offen offset:3072 sc1
  buffer_load_dwordx4 v[240:243], v2, s[4:7], s35 offen offset:0 sc1
wr_26:
  s_mov_b64 exec, 1
  s_waitcnt vmcnt(0)
  v_readfirstlane_b32 s3, v252
  s_nop 0
  s_sub_u32 s3, s41, s3
  s_cmp_le_u32 s3, 1
  s_cbranch_scc1 rk_25
  s_cmp_le_u32 s3, 6
  s_cbranch_scc1 rk_25a
  s_sleep 1
rk_25a:
  s_mov_b32 s30, 20000
  buffer_load_dword v254, v20, s[4:7], 0 offen sc1
poll_27:
  s_sleep 5
  buffer_load_dword v255, v20, s[4:7], 0 offen sc1
  s_waitcnt vmcnt(1)
  v_cmp_gt_u32 vcc, s41, v254
  s_cbranch_vccz pdone_28
  s_sleep 5
  buffer_load_dword v254, v20, s[4:7], 0 offen sc1
  s_waitcnt vmcnt(1)
  v_cmp_gt_u32 vcc, s41, v255
  s_cbranch_vccz pdone_28
  s_sub_u32 s30, s30, 1
  s_cmp_lg_u32 s30, 0
  s_cbranch_scc1 poll_27
  s_waitcnt vmcnt(0)
  v_mov_b32 v254, 512
  v_mov_b32 v255, 128
  buffer_store_dword v254, v255, s[16:19], 0 offen
pdone_28:
rk_25:
  s_mov_b64 exec, -1
  s_branch syn_22
nw0_21:
  s_lshl_b32 s3, s23, 2
  s_add_u32 s3, s3, s22
  s_cmp_lg_u32 s3, 3
  s_cbranch_scc1 ct_29
  s_getpc_b64 s[28:29]
pc_30:
  s_sub_u32 s28, s28, pc_30 - interleave_layers__sliding_block__glu_gated_reglu__prompt_kernel
  s_subb_u32 s29, s29, 0
  s_mov_b32 s30, main_last - interleave_layers__sliding_block__glu_gated_reglu__prompt_kernel
  s_mov_b32 s31, 0x20000
  s_and_b32 s3, s21, 7
  s_lshl_b32 s3, s3, 13
  v_lshlrev_b32 v252, 3, v2
  buffer_load_dword v43, v252, s[28:31], s3 offen
ct_29:
  s_mul_i32 s34, s27, 10240
  s_add_u32 s34, s34, s52
  s_add_u32 s34, s34, 204800
  s_add_u32 s35, s34, 4096
  buffer_load_dwordx4 v[44:47], v2, s[4:7], s34 offen offset:0 sc1
  buffer_load_dwordx4 v[48:51], v2, s[4:7], s34 offen offset:1024 sc1
  buffer_load_dwordx4 v[52:55], v2, s[4:7], s34 offen offset:2048 sc1
  buffer_load_dwordx4 v[56:59], v2, s[4:7], s34 offen offset:3072 sc1
  buffer_load_dwordx4 v[60:63], v2, s[4:7], s35 offen offset:0 sc1
  s_mul_i32 s34, s27, 10240
  s_add_u32 s34, s34, s52
  s_add_u32 s34, s34, 209920
  s_add_u32 s35, s34, 4096
  buffer_load_dwordx4 v[236:239], v2, s[4:7], s34 offen offset:0 sc1
  buffer_load_dwordx4 v[244:247], v2, s[4:7], s34 offen offset:1024 sc1
  buffer_load_dwordx4 v[248:251], v2, s[4:7], s34 offen offset:2048 sc1
  buffer_load_dwordx4 v[208:211], v2, s[4:7], s34 offen offset:3072 sc1
  buffer_load_dwordx4 v[212:215], v2, s[4:7], s35 offen offset:0 sc1
  s_cmp_lg_u32 s23, 0
  s_cbranch_scc1 wr_31
  s_mul_i32 s34, s27, 10240
  s_add_u32 s34, s34, s52
  s_add_u32 s34, s34, 225280
  s_add_u32 s35, s34, 4096
  buffer_load_dwordx4 a[160:163], v2, s[4:7], s34 offen offset:0 sc1
  buffer_load_dwordx4 a[164:167], v2, s[4:7], s34 offen offset:1024 sc1
  buffer_load_dwordx4 a[168:171], v2, s[4:7], s34 offen offset:2048 sc1
  buffer_load_dwordx4 a[172:175], v2, s[4:7], s34 offen offset:3072 sc1
  buffer_load_dwordx4 a[176:179], v2, s[4:7], s35 offen offset:0 sc1
  s_mul_i32 s34, s27, 10240
  s_add_u32 s34, s34, s52
  s_add_u32 s34, s34, 230400
  s_add_u32 s35, s34, 4096
  buffer_load_dwordx4 a[180:183], v2, s[4:7], s34 offen offset:0 sc1
  buffer_load_dwordx4 a[184:187], v2, s[4:7], s34 offen offset:1024 sc1
  buffer_load_dwordx4 a[188:191], v2, s[4:7], s34 offen offset:2048 sc1
  buffer_load_dwordx4 a[192:195], v2, s[4:7], s34 offen offset:3072 sc1
  buffer_load_dwordx4 a[196:199], v2, s[4:7], s35 offen offset:0 sc1
  s_mul_i32 s34, s27, 10240
  s_add_u32 s34, s34, s52
  s_add_u32 s34, s34, 245760
  s_add_u32 s35, s34, 4096
  buffer_load_dwordx4 a[200:203], v2, s[4:7], s34 offen offset:0 sc1
  buffer_load_dwordx4 a[204:207], v2, s[4:7], s34 offen offset:1024 sc1
  buffer_load_dwordx4 a[208:211], v2, s[4:7], s34 offen offset:2048 sc1
  buffer_load_dwordx4 a[212:215], v2, s[4:7], s34 offen offset:3072 sc1
  buffer_load_dwordx4 a[216:219], v2, s[4:7], s35 offen offset:0 sc1
  s_mul_i32 s34, s27, 10240
  s_add_u32 s34, s34, s52
  s_add_u32 s34, s34, 250880
  s_add_u32 s35, s34, 4096
  buffer_load_dwordx4 a[220:223], v2, s[4:7], s34 offen offset:0 sc1
  buffer_load_dwordx4 a[224:227], v2, s[4:7], s34 offen offset:1024 sc1
  buffer_load_dwordx4 a[228:231], v2, s[4:7], s34 offen offset:2048 sc1
  buffer_load_dwordx4 a[232:235], v2, s[4:7], s34 offen offset:3072 sc1
  buffer_load_dwordx4 a[236:239], v2, s[4:7], s35 offen offset:0 sc1
  s_mul_i32 s34, s27, 10240
  s_add_u32 s34, s34, s52
  s_add_u32 s34, s34, 266240
  s_add_u32 s35, s34, 4096
  buffer_load_dwordx4 a[240:243], v2, s[4:7], s34 offen offset:0 sc1
  buffer_load_dwordx4 a[244:247], v2, s[4:7], s34 offen offset:1024 sc1
  buffer_load_dwordx4 a[248:251], v2, s[4:7], s34 offen offset:2048 sc1
  buffer_load_dwordx4 a[252:255], v2, s[4:7], s34 offen offset:3072 sc1
  buffer_load_dwordx4 v[240:243], v2, s[4:7], s35 offen offset:0 sc1
wr_31:
syn_22:
  s_barrier
  s_mul_i32 s32, s45, 20480
  s_add_u32 s32, s32, s40
  s_add_u32 s32, s32, 5242880
  s_add_u32 s33, s32, 10240
  buffer_load_dwordx4 a[0:3], v2, s[4:7], s32 offen offset:0 sc1
  buffer_load_dwordx4 a[4:7], v2, s[4:7], s33 offen offset:0 sc1
  buffer_load_dwordx4 a[8:11], v2, s[4:7], s32 offen offset:1024 sc1
  buffer_load_dwordx4 a[12:15], v2, s[4:7], s33 offen offset:1024 sc1
  buffer_load_dwordx4 a[16:19], v2, s[4:7], s32 offen offset:2048 sc1
  buffer_load_dwordx4 a[20:23], v2, s[4:7], s33 offen offset:2048 sc1
  buffer_load_dwordx4 a[24:27], v2, s[4:7], s32 offen offset:3072 sc1
  buffer_load_dwordx4 a[28:31], v2, s[4:7], s33 offen offset:3072 sc1
  s_add_u32 s32, s32, 4096
  s_add_u32 s33, s33, 4096
  buffer_load_dwordx4 a[32:35], v2, s[4:7], s32 offen offset:0 sc1
  buffer_load_dwordx4 a[36:39], v2, s[4:7], s33 offen offset:0 sc1
  buffer_load_dwordx4 a[40:43], v2, s[4:7], s32 offen offset:1024 sc1
  buffer_load_dwordx4 a[44:47], v2, s[4:7], s33 offen offset:1024 sc1
  s_mul_i32 s35, s27, 5120
  v_add_u32 v124, s35, v2
  v_add_u32 v125, s35, v30
  v_add_u32 v126, s35, v31
  v_lshlrev_b32 v64, 16, v4
  v_and_b32 v65, 0xffff0000, v4
  v_lshlrev_b32 v66, 16, v5
  v_and_b32 v67, 0xffff0000, v5
  v_lshlrev_b32 v68, 16, v6
  v_and_b32 v69, 0xffff0000, v6
  v_lshlrev_b32 v70, 16, v7
  v_and_b32 v71, 0xffff0000, v7
  v_lshlrev_b32 v72, 16, v8
  v_and_b32 v73, 0xffff0000, v8
  v_lshlrev_b32 v74, 16, v9
  v_and_b32 v75, 0xffff0000, v9
  v_lshlrev_b32 v76, 16, v10
  v_and_b32 v77, 0xffff0000, v10
  v_lshlrev_b32 v78, 16, v11
  v_and_b32 v79, 0xffff0000, v11
  v_lshlrev_b32 v80, 16, v12
  v_and_b32 v81, 0xffff0000, v12
  v_lshlrev_b32 v82, 16, v13
  v_and_b32 v83, 0xffff0000, v13
  ds_read_b128 v[104:107], v2 offset:0
  ds_read_b128 v[108:111], v2 offset:1024
  ds_read_b128 v[112:115], v2 offset:2048
  ds_read_b128 v[116:119], v2 offset:3072
  ds_read_b128 v[120:123], v2 offset:4096
  ds_read_b128 v[128:131], v2 offset:5120
  ds_read_b128 v[132:135], v2 offset:6144
  ds_read_b128 v[136:139], v2 offset:7168
  ds_read_b128 v[140:143], v2 offset:8192
  ds_read_b128 v[144:147], v2 offset:9216
  s_waitcnt vmcnt(10)
  s_barrier
  s_waitcnt lgkmcnt(8)
  v_mfma_f32_16x16x32_bf16 v[64:67], v[104:107], a[0:3], v[64:67]
  ds_read_b128 v[104:107], v2 offset:10240
  v_mfma_f32_16x16x32_bf16 v[68:71], v[108:111], a[0:3], v[68:71]
  ds_read_b128 v[108:111], v2 offset:11264
  buffer_load_dwordx4 a[48:51], v2, s[4:7], s32 offen offset:2048 sc1
  s_waitcnt lgkmcnt(8)
  v_mfma_f32_16x16x32_bf16 v[72:75], v[112:115], a[0:3], v[72:75]
  ds_read_b128 v[112:115], v2 offset:12288
  v_mfma_f32_16x16x32_bf16 v[76:79], v[116:119], a[0:3], v[76:79]
  ds_read_b128 v[116:119], v2 offset:13312
  buffer_load_dwordx4 a[52:55], v2, s[4:7], s33 offen offset:2048 sc1
  s_waitcnt lgkmcnt(8)
  v_mfma_f32_16x16x32_bf16 v[80:83], v[120:123], a[0:3], v[80:83]
  ds_read_b128 v[120:123], v2 offset:14336
  v_mfma_f32_16x16x32_bf16 v[64:67], v[128:131], a[4:7], v[64:67]
  ds_read_b128 v[128:131], v2 offset:15360
  buffer_load_dwordx4 a[56:59], v2, s[4:7], s32 offen offset:3072 sc1
  s_waitcnt lgkmcnt(8)
  v_mfma_f32_16x16x32_bf16 v[68:71], v[132:135], a[4:7], v[68:71]
  ds_read_b128 v[132:135], v2 offset:16384
  v_mfma_f32_16x16x32_bf16 v[72:75], v[136:139], a[4:7], v[72:75]
  ds_read_b128 v[136:139], v2 offset:17408
  s_waitcnt lgkmcnt(8)
  v_mfma_f32_16x16x32_bf16 v[76:79], v[140:143], a[4:7], v[76:79]
  ds_read_b128 v[140:143], v2 offset:18432
  v_mfma_f32_16x16x32_bf16 v[80:83], v[144:147], a[4:7], v[80:83]
  ds_read_b128 v[144:147], v2 offset:19456
  s_waitcnt vmcnt(11)
  s_waitcnt lgkmcnt(8)
  v_mfma_f32_16x16x32_bf16 v[64:67], v[104:107], a[8:11], v[64:67]
  ds_read_b128 v[104:107], v2 offset:20480
  v_mfma_f32_16x16x32_bf16 v[68:71], v[108:111], a[8:11], v[68:71]
  ds_read_b128 v[108:111], v2 offset:21504
  buffer_load_dwordx4 a[60:63], v2, s[4:7], s33 offen offset:3072 sc1
  s_add_u32 s32, s32, 4096
  s_waitcnt lgkmcnt(8)
  v_mfma_f32_16x16x32_bf16 v[72:75], v[112:115], a[8:11], v[72:75]
  ds_read_b128 v[112:115], v2 offset:22528
  v_mfma_f32_16x16x32_bf16 v[76:79], v[116:119], a[8:11], v[76:79]
  ds_read_b128 v[116:119], v2 offset:23552
  s_add_u32 s33, s33, 4096
  buffer_load_dwordx4 a[64:67], v2, s[4:7], s32 offen offset:0 sc1
  s_waitcnt lgkmcnt(8)
  v_mfma_f32_16x16x32_bf16 v[80:83], v[120:123], a[8:11], v[80:83]
  ds_read_b128 v[120:123], v2 offset:24576
  v_mfma_f32_16x16x32_bf16 v[64:67], v[128:131], a[12:15], v[64:67]
  ds_read_b128 v[128:131], v2 offset:25600
  buffer_load_dwordx4 a[68:71], v2, s[4:7], s33 offen offset:0 sc1
  s_waitcnt lgkmcnt(8)
  v_mfma_f32_16x16x32_bf16 v[68:71], v[132:135], a[12:15], v[68:71]
  ds_read_b128 v[132:135], v2 offset:26624
  v_mfma_f32_16x16x32_bf16 v[72:75], v[136:139], a[12:15], v[72:75]
  ds_read_b128 v[136:139], v2 offset:27648
  s_waitcnt lgkmcnt(8)
  v_mfma_f32_16x16x32_bf16 v[76:79], v[140:143], a[12:15], v[76:79]
  ds_read_b128 v[140:143], v2 offset:28672
  v_mfma_f32_16x16x32_bf16 v[80:83], v[144:147], a[12:15], v[80:83]
  ds_read_b128 v[144:147], v2 offset:29696
  s_waitcnt vmcnt(12)
  s_waitcnt lgkmcnt(8)
  v_mfma_f32_16x16x32_bf16 v[64:67], v[104:107], a[16:19], v[64:67]
  ds_read_b128 v[104:107], v30 offset:41984
  v_mfma_f32_16x16x32_bf16 v[68:71], v[108:111], a[16:19], v[68:71]
  ds_read_b128 v[108:111], v30 offset:43008
  buffer_load_dwordx4 a[72:75], v2, s[4:7], s32 offen offset:1024 sc1
  s_waitcnt lgkmcnt(8)
  v_mfma_f32_16x16x32_bf16 v[72:75], v[112:115], a[16:19], v[72:75]
  ds_read_b128 v[112:115], v30 offset:44032
  v_mfma_f32_16x16x32_bf16 v[76:79], v[116:119], a[16:19], v[76:79]
  ds_read_b128 v[116:119], v30 offset:45056
  buffer_load_dwordx4 a[76:79], v2, s[4:7], s33 offen offset:1024 sc1
  s_waitcnt lgkmcnt(8)
  v_mfma_f32_16x16x32_bf16 v[80:83], v[120:123], a[16:19], v[80:83]
  ds_read_b128 v[120:123], v30 offset:46080
  v_mfma_f32_16x16x32_bf16 v[64:67], v[128:131], a[20:23], v[64:67]
  ds_read_b128 v[128:131], v30 offset:47104
  s_waitcnt lgkmcnt(8)
  v_mfma_f32_16x16x32_bf16 v[68:71], v[132:135], a[20:23], v[68:71]
  ds_read_b128 v[132:135], v30 offset:48128
  v_mfma_f32_16x16x32_bf16 v[72:75], v[136:139], a[20:23], v[72:75]
  ds_read_b128 v[136:139], v30 offset:49152
  s_waitcnt lgkmcnt(8)
  v_mfma_f32_16x16x32_bf16 v[76:79], v[140:143], a[20:23], v[76:79]
  ds_read_b128 v[140:143], v30 offset:50176
  v_mfma_f32_16x16x32_bf16 v[80:83], v[144:147], a[20:23], v[80:83]
  ds_read_b128 v[144:147], v30 offset:51200
  s_waitcnt vmcnt(12)
  s_waitcnt lgkmcnt(8)
  v_mfma_f32_16x16x32_bf16 v[64:67], v[104:107], a[24:27], v[64:67]
  ds_read_b128 v[104:107], v30 offset:52224
  v_mfma_f32_16x16x32_bf16 v[68:71], v[108:111], a[24:27], v[68:71]
  ds_read_b128 v[108:111], v30 offset:53248
  s_waitcnt lgkmcnt(8)
  v_mfma_f32_16x16x32_bf16 v[72:75], v[112:115], a[24:27], v[72:75]
  ds_read_b128 v[112:115], v30 offset:54272
  v_mfma_f32_16x16x32_bf16 v[76:79], v[116:119], a[24:27], v[76:79]
  ds_read_b128 v[116:119], v30 offset:55296
  s_waitcnt lgkmcnt(8)
  v_mfma_f32_16x16x32_bf16 v[80:83], v[120:123], a[24:27], v[80:83]
  ds_read_b128 v[120:123], v30 offset:56320
  v_mfma_f32_16x16x32_bf16 v[64:67], v[128:131], a[28:31], v[64:67]
  ds_read_b128 v[128:131], v30 offset:57344
  s_waitcnt lgkmcnt(8)
  v_mfma_f32_16x16x32_bf16 v[68:71], v[132:135], a[28:31], v[68:71]
  ds_read_b128 v[132:135], v30 offset:58368
  v_mfma_f32_16x16x32_bf16 v[72:75], v[136:139], a[28:31], v[72:75]
  ds_read_b128 v[136:139], v30 offset:59392
  s_waitcnt lgkmcnt(8)
  v_mfma_f32_16x16x32_bf16 v[76:79], v[140:143], a[28:31], v[76:79]
  ds_read_b128 v[140:143], v30 offset:60416
  v_mfma_f32_16x16x32_bf16 v[80:83], v[144:147], a[28:31], v[80:83]
  ds_read_b128 v[144:147], v30 offset:61440
  s_barrier
  s_waitcnt vmcnt(10)
  s_waitcnt lgkmcnt(8)
  v_mfma_f32_16x16x32_bf16 v[64:67], v[104:107], a[32:35], v[64:67]
  ds_read_b128 v[104:107], v30 offset:62464
  v_mfma_f32_16x16x32_bf16 v[68:71], v[108:111], a[32:35], v[68:71]
  ds_read_b128 v[108:111], v30 offset:63488
  s_mul_i32 s36, s22, 4096
  s_add_u32 s37, s36, s51
  s_waitcnt lgkmcnt(8)
  v_mfma_f32_16x16x32_bf16 v[72:75], v[112:115], a[32:35], v[72:75]
  ds_read_b128 v[112:115], v30 offset:64512
  v_mfma_f32_16x16x32_bf16 v[76:79], v[116:119], a[32:35], v[76:79]
  ds_read_b128 v[116:119], v31 offset:0
  s_add_u32 s37, s37, 0
  s_add_u32 m0, s36, 0
  s_waitcnt lgkmcnt(8)
  v_mfma_f32_16x16x32_bf16 v[80:83], v[120:123], a[32:35], v[80:83]
  ds_read_b128 v[120:123], v31 offset:1024
  v_mfma_f32_16x16x32_bf16 v[64:67], v[128:131], a[36:39], v[64:67]
  ds_read_b128 v[128:131], v31 offset:2048
  buffer_load_dwordx4 v2, s[4:7], s37 offen offset:0 sc1 lds
  s_waitcnt lgkmcnt(8)
  v_mfma_f32_16x16x32_bf16 v[68:71], v[132:135], a[36:39], v[68:71]
  ds_read_b128 v[132:135], v31 offset:3072
  v_mfma_f32_16x16x32_bf16 v[72:75], v[136:139], a[36:39], v[72:75]
  ds_read_b128 v[136:139], v31 offset:4096
  buffer_load_dwordx4 v2, s[4:7], s37 offen offset:1024 sc1 lds
  s_waitcnt lgkmcnt(8)
  v_mfma_f32_16x16x32_bf16 v[76:79], v[140:143], a[36:39], v[76:79]
  ds_read_b128 v[140:143], v31 offset:5120
  v_mfma_f32_16x16x32_bf16 v[80:83], v[144:147], a[36:39], v[80:83]
  ds_read_b128 v[144:147], v31 offset:6144
  buffer_load_dwordx4 v2, s[4:7], s37 offen offset:2048 sc1 lds
  s_waitcnt vmcnt(11)
  s_waitcnt lgkmcnt(8)
  v_mfma_f32_16x16x32_bf16 v[64:67], v[104:107], a[40:43], v[64:67]
  ds_read_b128 v[104:107], v2 offset:36864
  v_mfma_f32_16x16x32_bf16 v[68:71], v[108:111], a[40:43], v[68:71]
  ds_read_b128 v[108:111], v2 offset:37888
  buffer_load_dwordx4 v2, s[4:7], s37 offen offset:3072 sc1 lds
  s_mul_i32 s36, s22, 4096
  s_waitcnt lgkmcnt(8)
  v_mfma_f32_16x16x32_bf16 v[72:75], v[112:115], a[40:43], v[72:75]
  ds_read_b128 v[112:115], v2 offset:38912
  v_mfma_f32_16x16x32_bf16 v[76:79], v[116:119], a[40:43], v[76:79]
  ds_read_b128 v[116:119], v2 offset:39936
  s_add_u32 s37, s36, s51
  s_add_u32 s37, s37, 16384
  s_waitcnt lgkmcnt(8)
  v_mfma_f32_16x16x32_bf16 v[80:83], v[120:123], a[40:43], v[80:83]
  ds_read_b128 v[120:123], v2 offset:40960
  v_mfma_f32_16x16x32_bf16 v[64:67], v[128:131], a[44:47], v[64:67]
  ds_read_b128 v[128:131], v2 offset:41984
  s_add_u32 m0, s36, 16384
  s_nop 0
  buffer_load_dwordx4 v2, s[4:7], s37 offen offset:0 sc1 lds
  s_waitcnt lgkmcnt(8)
  v_mfma_f32_16x16x32_bf16 v[68:71], v[132:135], a[44:47], v[68:71]
  ds_read_b128 v[132:135], v2 offset:43008
  v_mfma_f32_16x16x32_bf16 v[72:75], v[136:139], a[44:47], v[72:75]
  ds_read_b128 v[136:139], v2 offset:44032
  buffer_load_dwordx4 v2, s[4:7], s37 offen offset:1024 sc1 lds
  s_waitcnt lgkmcnt(8)
  v_mfma_f32_16x16x32_bf16 v[76:79], v[140:143], a[44:47], v[76:79]
  ds_read_b128 v[140:143], v2 offset:45056
  v_mfma_f32_16x16x32_bf16 v[80:83], v[144:147], a[44:47], v[80:83]
  ds_read_b128 v[144:147], v2 offset:46080
  buffer_load_dwordx4 v2, s[4:7], s37 offen offset:2048 sc1 lds
  s_waitcnt vmcnt(13)
  s_waitcnt lgkmcnt(8)
  v_mfma_f32_16x16x32_bf16 v[64:67], v[104:107], a[48:51], v[64:67]
  ds_read_b128 v[104:107], v2 offset:47104
  v_mfma_f32_16x16x32_bf16 v[68:71], v[108:111], a[48:51], v[68:71]
  ds_read_b128 v[108:111], v2 offset:48128
  buffer_load_dwordx4 v2, s[4:7], s37 offen offset:3072 sc1 lds
  s_waitcnt lgkmcnt(8)
  v_mfma_f32_16x16x32_bf16 v[72:75], v[112:115], a[48:51], v[72:75]
  ds_read_b128 v[112:115], v2 offset:49152
  v_mfma_f32_16x16x32_bf16 v[76:79], v[116:119], a[48:51], v[76:79]
  ds_read_b128 v[116:119], v2 offset:50176
  s_waitcnt lgkmcnt(8)
  v_mfma_f32_16x16x32_bf16 v[80:83], v[120:123], a[48:51], v[80:83]
  ds_read_b128 v[120:123], v2 offset:51200
  v_mfma_f32_16x16x32_bf16 v[64:67], v[128:131], a[52:55], v[64:67]
  ds_read_b128 v[128:131], v2 offset:52224
  s_waitcnt lgkmcnt(8)
  v_mfma_f32_16x16x32_bf16 v[68:71], v[132:135], a[52:55], v[68:71]
  ds_read_b128 v[132:135], v2 offset:53248
  v_mfma_f32_16x16x32_bf16 v[72:75], v[136:139], a[52:55], v[72:75]
  ds_read_b128 v[136:139], v2 offset:54272
  s_waitcnt lgkmcnt(8)
  v_mfma_f32_16x16x32_bf16 v[76:79], v[140:143], a[52:55], v[76:79]
  ds_read_b128 v[140:143], v2 offset:55296
  v_mfma_f32_16x16x32_bf16 v[80:83], v[144:147], a[52:55], v[80:83]
  ds_read_b128 v[144:147], v2 offset:56320
  s_waitcnt vmcnt(12)
  s_waitcnt lgkmcnt(8)
  v_mfma_f32_16x16x32_bf16 v[64:67], v[104:107], a[56:59], v[64:67]
  ds_read_b128 v[104:107], v2 offset:57344
  v_mfma_f32_16x16x32_bf16 v[68:71], v[108:111], a[56:59], v[68:71]
  ds_read_b128 v[108:111], v2 offset:58368
  s_waitcnt lgkmcnt(8)
  v_mfma_f32_16x16x32_bf16 v[72:75], v[112:115], a[56:59], v[72:75]
  ds_read_b128 v[112:115], v2 offset:59392
  v_mfma_f32_16x16x32_bf16 v[76:79], v[116:119], a[56:59], v[76:79]
  ds_read_b128 v[116:119], v2 offset:60416
  s_waitcnt lgkmcnt(8)
  v_mfma_f32_16x16x32_bf16 v[80:83], v[120:123], a[56:59], v[80:83]
  ds_read_b128 v[120:123], v2 offset:61440
  v_mfma_f32_16x16x32_bf16 v[64:67], v[128:131], a[60:63], v[64:67]
  ds_read_b128 v[128:131], v2 offset:62464
  s_waitcnt lgkmcnt(8)
  v_mfma_f32_16x16x32_bf16 v[68:71], v[132:135], a[60:63], v[68:71]
  ds_read_b128 v[132:135], v2 offset:63488
  v_mfma_f32_16x16x32_bf16 v[72:75], v[136:139], a[60:63], v[72:75]
  ds_read_b128 v[136:139], v2 offset:64512
  s_waitcnt lgkmcnt(8)
  v_mfma_f32_16x16x32_bf16 v[76:79], v[140:143], a[60:63], v[76:79]
  ds_read_b128 v[140:143], v30 offset:0
  v_mfma_f32_16x16x32_bf16 v[80:83], v[144:147], a[60:63], v[80:83]
  ds_read_b128 v[144:147], v30 offset:1024
  s_waitcnt vmcnt(10)
  s_waitcnt lgkmcnt(8)
  v_mfma_f32_16x16x32_bf16 v[64:67], v[104:107], a[64:67], v[64:67]
  ds_read_b128 v[104:107], v30 offset:2048
  v_mfma_f32_16x16x32_bf16 v[68:71], v[108:111], a[64:67], v[68:71]
  ds_read_b128 v[108:111], v30 offset:3072
  s_waitcnt lgkmcnt(8)
  v_mfma_f32_16x16x32_bf16 v[72:75], v[112:115], a[64:67], v[72:75]
  ds_read_b128 v[112:115], v30 offset:4096
  v_mfma_f32_16x16x32_bf16 v[76:79], v[116:119], a[64:67], v[76:79]
  ds_read_b128 v[116:119], v30 offset:5120
  s_waitcnt lgkmcnt(8)
  v_mfma_f32_16x16x32_bf16 v[80:83], v[120:123], a[64:67], v[80:83]
  ds_read_b128 v[120:123], v30 offset:6144
  v_mfma_f32_16x16x32_bf16 v[64:67], v[128:131], a[68:71], v[64:67]
  ds_read_b128 v[128:131], v30 offset:7168
  s_waitcnt lgkmcnt(8)
  v_mfma_f32_16x16x32_bf16 v[68:71], v[132:135], a[68:71], v[68:71]
  ds_read_b128 v[132:135], v30 offset:8192
  v_mfma_f32_16x16x32_bf16 v[72:75], v[136:139], a[68:71], v[72:75]
  ds_read_b128 v[136:139], v30 offset:9216
  s_waitcnt lgkmcnt(8)
  v_mfma_f32_16x16x32_bf16 v[76:79], v[140:143], a[68:71], v[76:79]
  ds_read_b128 v[140:143], v30 offset:10240
  v_mfma_f32_16x16x32_bf16 v[80:83], v[144:147], a[68:71], v[80:83]
  ds_read_b128 v[144:147], v30 offset:11264
  s_waitcnt vmcnt(8)
  s_waitcnt lgkmcnt(8)
  v_mfma_f32_16x16x32_bf16 v[64:67], v[104:107], a[72:75], v[64:67]
  v_mfma_f32_16x16x32_bf16 v[68:71], v[108:111], a[72:75], v[68:71]
  s_waitcnt lgkmcnt(6)
  v_mfma_f32_16x16x32_bf16 v[72:75], v[112:115], a[72:75], v[72:75]
  v_mfma_f32_16x16x32_bf16 v[76:79], v[116:119], a[72:75], v[76:79]
  s_waitcnt lgkmcnt(4)
  v_mfma_f32_16x16x32_bf16 v[80:83], v[120:123], a[72:75], v[80:83]
  v_mfma_f32_16x16x32_bf16 v[64:67], v[128:131], a[76:79], v[64:67]
  s_waitcnt lgkmcnt(2)
  v_mfma_f32_16x16x32_bf16 v[68:71], v[132:135], a[76:79], v[68:71]
  v_mfma_f32_16x16x32_bf16 v[72:75], v[136:139], a[76:79], v[72:75]
  s_waitcnt lgkmcnt(0)
  v_mfma_f32_16x16x32_bf16 v[76:79], v[140:143], a[76:79], v[76:79]
  v_mfma_f32_16x16x32_bf16 v[80:83], v[144:147], a[76:79], v[80:83]
  s_barrier
  s_add_u32 s32, s40, s47
  s_add_u32 s32, s32, 2621440
  s_add_u32 s33, s32, 4096
  s_add_u32 s34, s40, s48
  s_add_u32 s34, s34, 20971520
  v_cvt_pk_bf16_f32 v4, v64, v65
  v_cvt_pk_bf16_f32 v5, v66, v67
  v_cvt_pk_bf16_f32 v6, v68, v69
  v_cvt_pk_bf16_f32 v7, v70, v71
  v_cvt_pk_bf16_f32 v8, v72, v73
  v_cvt_pk_bf16_f32 v9, v74, v75
  v_cvt_pk_bf16_f32 v10, v76, v77
  v_cvt_pk_bf16_f32 v11, v78, v79
  v_cvt_pk_bf16_f32 v12, v80, v81
  v_cvt_pk_bf16_f32 v13, v82, v83
  buffer_store_dwordx4 v[4:7], v17, s[4:7], s32 offen sc1
  buffer_store_dwordx4 v[8:11], v17, s[4:7], s32 offen offset:2048 sc1
  v_mov_b32 v112, v12
  v_mov_b32 v113, v13
  v_mov_b32 v114, v12
  v_mov_b32 v115, v13
  v_mov_b32 v116, v12
  v_mov_b32 v117, v13
  s_nop 0
  v_permlane32_swap_b32 v116, v114
  v_permlane32_swap_b32 v117, v115
  s_mov_b32 exec_hi, 0
  buffer_store_dwordx4 v[112:115], v17, s[4:7], s33 offen sc1
  s_mov_b32 exec_hi, -1
  v_pk_add_f32 v[124:125], v[64:65], v[66:67]
  v_pk_mul_f32 v[126:127], v[64:65], v[64:65]
  v_pk_fma_f32 v[126:127], v[66:67], v[66:67], v[126:127]
  v_pk_add_f32 v[124:125], v[124:125], v[68:69]
  v_pk_fma_f32 v[126:127], v[68:69], v[68:69], v[126:127]
  v_pk_add_f32 v[124:125], v[124:125], v[70:71]
  v_pk_fma_f32 v[126:127], v[70:71], v[70:71], v[126:127]
  v_pk_add_f32 v[124:125], v[124:125], v[72:73]
  v_pk_fma_f32 v[126:127], v[72:73], v[72:73], v[126:127]
  v_pk_add_f32 v[124:125], v[124:125], v[74:75]
  v_pk_fma_f32 v[126:127], v[74:75], v[74:75], v[126:127]
  v_pk_add_f32 v[124:125], v[124:125], v[76:77]
  v_pk_fma_f32 v[126:127], v[76:77], v[76:77], v[126:127]
  v_pk_add_f32 v[124:125], v[124:125], v[78:79]
  v_pk_fma_f32 v[126:127], v[78:79], v[78:79], v[126:127]
  v_pk_add_f32 v[124:125], v[124:125], v[80:81]
  v_pk_fma_f32 v[126:127], v[80:81], v[80:81], v[126:127]
  v_pk_add_f32 v[124:125], v[124:125], v[82:83]
  v_pk_fma_f32 v[126:127], v[82:83], v[82:83], v[126:127]
  v_add_f32 v120, v124, v125
  v_add_f32 v121, v126, v127
  v_mov_b32 v122, v120
  v_mov_b32 v123, v121
  s_nop 0
  v_permlane16_swap_b32 v120, v122
  v_permlane16_swap_b32 v121, v123
  v_add_f32 v120, v120, v122
  v_add_f32 v121, v121, v123
  v_mov_b32 v122, v120
  v_mov_b32 v123, v121
  s_nop 0
  v_permlane32_swap_b32 v120, v122
  v_permlane32_swap_b32 v121, v123
  v_add_f32 v120, v120, v122
  v_add_f32 v121, v121, v123
  s_mov_b64 exec, 0xffff
  buffer_store_dwordx2 v[120:121], v18, s[4:7], s34 offen sc1
  s_mov_b64 exec, -1
  s_cmp_eq_u32 s22, 0
  s_cbranch_scc1 p0_34
  s_mul_i32 s36, s55, 11264
  s_add_u32 s37, s36, s51
  s_add_u32 s37, s37, 32768
  s_add_u32 m0, s36, 32768
  s_nop 0
  buffer_load_dwordx4 v2, s[4:7], s37 offen offset:0 sc1 lds
  buffer_load_dwordx4 v2, s[4:7], s37 offen offset:1024 sc1 lds
  buffer_load_dwordx4 v2, s[4:7], s37 offen offset:2048 sc1 lds
  buffer_load_dwordx4 v2, s[4:7], s37 offen offset:3072 sc1 lds
  s_add_u32 s37, s37, 4096
  s_add_u32 m0, m0, 4096
  s_nop 0
  buffer_load_dwordx4 v2, s[4:7], s37 offen offset:0 sc1 lds
  buffer_load_dwordx4 v2, s[4:7], s37 offen offset:1024 sc1 lds
  buffer_load_dwordx4 v2, s[4:7], s37 offen offset:2048 sc1 lds
  buffer_load_dwordx4 v2, s[4:7], s37 offen offset:3072 sc1 lds
  s_add_u32 s37, s37, 4096
  s_add_u32 m0, m0, 4096
  s_nop 0
  buffer_load_dwordx4 v2, s[4:7], s37 offen offset:0 sc1 lds
  buffer_load_dwordx4 v2, s[4:7], s37 offen offset:1024 sc1 lds
  buffer_load_dwordx4 v2, s[4:7], s37 offen offset:2048 sc1 lds
  s_waitcnt vmcnt(11) lgkmcnt(0)
  s_branch pe_35
p0_34:
  s_waitcnt vmcnt(0) lgkmcnt(0)
pe_35:
  s_barrier
  s_add_u32 s41, s41, 16
  s_cmp_lg_u32 s22, 0
  s_cbranch_scc1 nw0_32
  s_mov_b64 exec, 1
  v_mov_b32 v252, 1
  s_and_b32 s3, s21, 0
  s_lshl_b32 s3, s3, 7
  buffer_atomic_add v252, v20, s[4:7], s3 offen sc0 sc1
  s_mov_b64 exec, 1
  s_waitcnt vmcnt(0)
  v_readfirstlane_b32 s3, v252
  s_nop 0
  s_sub_u32 s3, s41, s3
  s_cmp_le_u32 s3, 1
  s_cbranch_scc1 rk_36
  s_cmp_le_u32 s3, 6
  s_cbranch_scc1 rk_36a
  s_sleep 1
rk_36a:
  s_mov_b32 s30, 20000
  buffer_load_dword v254, v20, s[4:7], 0 offen sc1
poll_37:
  s_sleep 5
  buffer_load_dword v255, v20, s[4:7], 0 offen sc1
  s_waitcnt vmcnt(1)
  v_cmp_gt_u32 vcc, s41, v254
  s_cbranch_vccz pdone_38
  s_sleep 5
  buffer_load_dword v254, v20, s[4:7], 0 offen sc1
  s_waitcnt vmcnt(1)
  v_cmp_gt_u32 vcc, s41, v255
  s_cbranch_vccz pdone_38
  s_sub_u32 s30, s30, 1
  s_cmp_lg_u32 s30, 0
  s_cbranch_scc1 poll_37
  s_waitcnt vmcnt(0)
  v_mov_b32 v254, 768
  v_mov_b32 v255, 128
  buffer_store_dword v254, v255, s[16:19], 0 offen
pdone_38:
rk_36:
  s_mov_b64 exec, -1
  s_branch syn_33
nw0_32:
  s_lshl_b32 s3, s23, 2
  s_add_u32 s3, s3, s22
  s_cmp_lg_u32 s3, 3
  s_cbranch_scc1 ct_39
  s_getpc_b64 s[28:29]
pc_40:
  s_sub_u32 s28, s28, pc_40 - interleave_layers__sliding_block__glu_gated_reglu__prompt_kernel
  s_subb_u32 s29, s29, 0
  s_mov_b32 s30, main_last - interleave_layers__sliding_block__glu_gated_reglu__prompt_kernel
  s_mov_b32 s31, 0x20000
  s_and_b32 s3, s21, 7
  s_lshl_b32 s3, s3, 13
  v_lshlrev_b32 v252, 3, v2
  buffer_load_dword v43, v252, s[28:31], s3 offen
ct_39:
  s_lshl_b32 s35, s23, 2
  s_sub_u32 s35, s26, s35
  s_cmp_lg_u32 s35, 1
  s_cbranch_scc1 x1_42
  s_mul_i32 s33, s21, 7168
  s_add_u32 s33, s33, 126976
  s_lshl_b32 s34, s55, 7
  v_add_u32 v80, s34, v1
  v_add_u32 v81, 0, v80
  v_lshrrev_b32 v82, 5, v81
  v_and_b32 v83, 31, v81
  v_lshlrev_b32 v83, 2, v83
  v_lshl_add_u32 v82, v82, 10, v83
  buffer_load_dword v84, v82, s[4:7], s33 offen offset:0 sc1
  buffer_load_dword v85, v82, s[4:7], s33 offen offset:128 sc1
  buffer_load_dword v86, v82, s[4:7], s33 offen offset:256 sc1
  buffer_load_dword v87, v82, s[4:7], s33 offen offset:384 sc1
  buffer_load_dword v88, v82, s[4:7], s33 offen offset:512 sc1
  buffer_load_dword v89, v82, s[4:7], s33 offen offset:640 sc1
  buffer_load_dword v90, v82, s[4:7], s33 offen offset:768 sc1
  buffer_load_dword v91, v82, s[4:7], s33 offen offset:896 sc1
  v_add_u32 v81, 64, v80
  v_lshrrev_b32 v82, 5, v81
  v_and_b32 v83, 31, v81
  v_lshlrev_b32 v83, 2, v83
  v_lshl_add_u32 v82, v82, 10, v83
  buffer_load_dword v92, v82, s[4:7], s33 offen offset:0 sc1
  buffer_load_dword v93, v82, s[4:7], s33 offen offset:128 sc1
  buffer_load_dword v94, v82, s[4:7], s33 offen offset:256 sc1
  buffer_load_dword v95, v82, s[4:7], s33 offen offset:384 sc1
  buffer_load_dword v96, v82, s[4:7], s33 offen offset:512 sc1
  buffer_load_dword v97, v82, s[4:7], s33 offen offset:640 sc1
  buffer_load_dword v98, v82, s[4:7], s33 offen offset:768 sc1
  buffer_load_dword v99, v82, s[4:7], s33 offen offset:896 sc1
x1_42:
  s_mul_i32 s36, s55, 11264
  s_add_u32 s37, s36, s51
  s_add_u32 s37, s37, 66560
  s_add_u32 m0, s36, 66560
  s_nop 0
  buffer_load_dwordx4 v2, s[4:7], s37 offen offset:0 sc1 lds
  buffer_load_dwordx4 v2, s[4:7], s37 offen offset:1024 sc1 lds
  buffer_load_dwordx4 v2, s[4:7], s37 offen offset:2048 sc1 lds
  buffer_load_dwordx4 v2, s[4:7], s37 offen offset:3072 sc1 lds
  s_add_u32 s37, s37, 4096
  s_add_u32 m0, m0, 4096
  s_nop 0
  buffer_load_dwordx4 v2, s[4:7], s37 offen offset:0 sc1 lds
  buffer_load_dwordx4 v2, s[4:7], s37 offen offset:1024 sc1 lds
  buffer_load_dwordx4 v2, s[4:7], s37 offen offset:2048 sc1 lds
  buffer_load_dwordx4 v2, s[4:7], s37 offen offset:3072 sc1 lds
  s_add_u32 s37, s37, 4096
  s_add_u32 m0, m0, 4096
  s_nop 0
  buffer_load_dwordx4 v2, s[4:7], s37 offen offset:0 sc1 lds
  buffer_load_dwordx4 v2, s[4:7], s37 offen offset:1024 sc1 lds
  buffer_load_dwordx4 v2, s[4:7], s37 offen offset:2048 sc1 lds
  s_cmp_lg_u32 s35, 1
  s_cbranch_scc1 x0_41
  v_lshrrev_b32 v82, 5, v80
  v_lshlrev_b32 v82, 10, v82
  v_bfe_u32 v83, v80, 2, 2
  v_lshl_add_u32 v82, v83, 7, v82
  v_bfe_u32 v83, v80, 4, 1
  v_lshl_add_u32 v82, v83, 6, v82
  v_and_b32 v83, 3, v80
  v_lshl_add_u32 v82, v83, 4, v82
  v_add_u32 v82, 147456, v82
  v_add_u32 v83, 2048, v82
  s_waitcnt vmcnt(11)
  v_add_f32 v84, v84, v85
  v_add_f32 v92, v92, v93
  v_add_f32 v84, v84, v86
  v_add_f32 v92, v92, v94
  v_add_f32 v84, v84, v87
  v_add_f32 v92, v92, v95
  v_add_f32 v84, v84, v88
  v_add_f32 v92, v92, v96
  v_add_f32 v84, v84, v89
  v_add_f32 v92, v92, v97
  v_add_f32 v84, v84, v90
  v_add_f32 v92, v92, v98
  v_add_f32 v84, v84, v91
  v_add_f32 v92, v92, v99
  v_and_b32 v65, 0xffff0000, v84
  v_sub_f32 v84, v84, v65
  v_and_b32 v66, 0xffff0000, v84
  v_sub_f32 v84, v84, v66
  v_lshrrev_b32 v64, 16, v65
  v_or_b32 v64, v64, v65
  v_lshrrev_b32 v67, 16, v66
  v_or_b32 v65, v65, v67
  v_lshrrev_b32 v84, 16, v84
  v_or_b32 v66, v66, v84
  v_mov_b32 v67, 0
  v_mov_b32 v68, 0
  v_mov_b32 v69, 0
  v_mov_b32 v70, 0
  v_mov_b32 v71, 0
  ds_write_b128 v82, v[64:67]
  ds_write_b128 v82, v[68:71] offset:512
  v_and_b32 v73, 0xffff0000, v92
  v_sub_f32 v92, v92, v73
  v_and_b32 v74, 0xffff0000, v92
  v_sub_f32 v92, v92, v74
  v_lshrrev_b32 v72, 16, v73
  v_or_b32 v72, v72, v73
  v_lshrrev_b32 v75, 16, v74
  v_or_b32 v73, v73, v75
  v_lshrrev_b32 v92, 16, v92
  v_or_b32 v74, v74, v92
  v_mov_b32 v75, 0
  v_mov_b32 v68, 0
  v_mov_b32 v69, 0
  v_mov_b32 v70, 0
  v_mov_b32 v71, 0
  ds_write_b128 v83, v[72:75]
  ds_write_b128 v83, v[68:71] offset:512
  s_waitcnt lgkmcnt(0)
x0_41:
syn_33:
  s_barrier
  s_add_u32 s32, s40, s42
  s_add_u32 s32, s32, 2621440
  s_add_u32 s31, s40, s43
  s_add_u32 s31, s31, 20971520
  buffer_load_dwordx2 v[224:225], v3, s[4:7], s31 offen offset:0 sc1
  buffer_load_dwordx2 v[226:227], v3, s[4:7], s31 offen offset:512 sc1
  buffer_load_dwordx2 v[228:229], v3, s[4:7], s31 offen offset:1024 sc1
  buffer_load_dwordx2 v[230:231], v3, s[4:7], s31 offen offset:1536 sc1
  buffer_load_dwordx4 a[0:3], v2, s[4:7], s32 offen offset:0 sc1
  buffer_load_dwordx4 a[4:7], v2, s[4:7], s32 offen offset:1024 sc1
  buffer_load_dwordx4 a[8:11], v2, s[4:7], s32 offen offset:2048 sc1
  buffer_load_dwordx4 a[12:15], v2, s[4:7], s32 offen offset:3072 sc1
  s_add_u32 s32, s32, 4096
  buffer_load_dwordx4 a[16:19], v2, s[4:7], s32 offen offset:0 sc1
  buffer_load_dwordx4 a[20:23], v2, s[4:7], s32 offen offset:1024 sc1
  buffer_load_dwordx4 a[24:27], v2, s[4:7], s32 offen offset:2048 sc1
  buffer_load_dwordx4 a[28:31], v2, s[4:7], s32 offen offset:3072 sc1
  s_add_u32 s32, s32, 4096
  buffer_load_dwordx4 a[32:35], v2, s[4:7], s32 offen offset:0 sc1
  buffer_load_dwordx4 a[36:39], v2, s[4:7], s32 offen offset:1024 sc1
  s_add_u32 s28, s40, s53
  s_add_u32 s28, s28, 7864320
  s_mul_i32 s31, s21, 1536
  s_add_u32 s31, s31, s28
  s_add_u32 s31, s31, 32256
  s_lshl_b32 s3, s21, 11
  s_add_u32 s28, s28, s3
  s_mov_b32 s29, s28
  s_cmp_eq_u32 s21, 15
  s_cmov_b32 s29, 2146435072
  s_cmov_b32 s31, 2146435072
  s_waitcnt vmcnt(9)
  s_barrier
  ds_read_b128 v[176:179], v2 offset:0
  ds_read_b128 v[180:183], v2 offset:1024
  ds_read_b128 v[184:187], v2 offset:2048
  ds_read_b128 v[188:191], v2 offset:3072
  ds_read_b128 v[192:195], v2 offset:4096
  ds_read_b128 v[196:199], v2 offset:5120
  ds_read_b128 v[200:203], v2 offset:6144
  ds_read_b128 v[204:207], v2 offset:7168
  s_waitcnt lgkmcnt(6)
  v_mfma_f32_32x32x16_bf16 v[64:79], v[176:179], a[0:3], 0
  ds_read_b128 v[176:179], v2 offset:8192
  buffer_load_dwordx4 a[40:43], v2, s[4:7], s32 offen offset:2048 sc1
  v_mfma_f32_32x32x16_bf16 v[80:95], v[180:183], a[0:3], 0
  ds_read_b128 v[180:183], v2 offset:9216
  s_waitcnt lgkmcnt(6)
  v_mfma_f32_32x32x16_bf16 v[96:111], v[184:187], a[0:3], 0
  ds_read_b128 v[184:187], v2 offset:10240
  v_mfma_f32_32x32x16_bf16 v[112:127], v[188:191], a[0:3], 0
  ds_read_b128 v[188:191], v2 offset:11264
  s_waitcnt vmcnt(9)
  s_waitcnt lgkmcnt(6)
  v_mfma_f32_32x32x16_bf16 v[64:79], v[192:195], a[4:7], v[64:79]
  ds_read_b128 v[192:195], v2 offset:12288
  buffer_load_dwordx4 a[44:47], v2, s[4:7], s32 offen offset:3072 sc1
  s_add_u32 s32, s32, 4096
  v_mfma_f32_32x32x16_bf16 v[80:95], v[196:199], a[4:7], v[80:95]
  ds_read_b128 v[196:199], v2 offset:13312
  buffer_load_dwordx4 a[48:51], v2, s[4:7], s32 offen offset:0 sc1
  s_waitcnt lgkmcnt(6)
  v_mfma_f32_32x32x16_bf16 v[96:111], v[200:203], a[4:7], v[96:111]
  ds_read_b128 v[200:203], v2 offset:14336
  v_mfma_f32_32x32x16_bf16 v[112:127], v[204:207], a[4:7], v[112:127]
  ds_read_b128 v[204:207], v2 offset:15360
  s_waitcnt vmcnt(10)
  s_waitcnt lgkmcnt(6)
  v_mfma_f32_32x32x16_bf16 v[64:79], v[176:179], a[8:11], v[64:79]
  ds_read_b128 v[176:179], v2 offset:16384
  buffer_load_dwordx4 a[52:55], v2, s[4:7], s32 offen offset:1024 sc1
  v_mfma_f32_32x32x16_bf16 v[80:95], v[180:183], a[8:11], v[80:95]
  ds_read_b128 v[180:183], v2 offset:17408
  buffer_load_dwordx4 a[56:59], v2, s[4:7], s32 offen offset:2048 sc1
  s_waitcnt lgkmcnt(6)
  v_mfma_f32_32x32x16_bf16 v[96:111], v[184:187], a[8:11], v[96:111]
  ds_read_b128 v[184:187], v2 offset:18432
  v_mfma_f32_32x32x16_bf16 v[112:127], v[188:191], a[8:11], v[112:127]
  ds_read_b128 v[188:191], v2 offset:19456
  s_waitcnt vmcnt(11)
  s_waitcnt lgkmcnt(6)
  v_mfma_f32_32x32x16_bf16 v[64:79], v[192:195], a[12:15], v[64:79]
  ds_read_b128 v[192:195], v2 offset:20480
  buffer_load_dwordx4 a[60:63], v2, s[4:7], s32 offen offset:3072 sc1
  s_add_u32 s32, s32, 4096
  v_mfma_f32_32x32x16_bf16 v[80:95], v[196:199], a[12:15], v[80:95]
  ds_read_b128 v[196:199], v2 offset:21504
  buffer_load_dwordx4 a[64:67], v2, s[4:7], s32 offen offset:0 sc1
  s_waitcnt lgkmcnt(6)
  v_mfma_f32_32x32x16_bf16 v[96:111], v[200:203], a[12:15], v[96:111]
  ds_read_b128 v[200:203], v2 offset:22528
  v_mfma_f32_32x32x16_bf16 v[112:127], v[204:207], a[12:15], v[112:127]
  ds_read_b128 v[204:207], v2 offset:23552
  s_waitcnt vmcnt(12)
  s_waitcnt lgkmcnt(6)
  v_mfma_f32_32x32x16_bf16 v[64:79], v[176:179], a[16:19], v[64:79]
  ds_read_b128 v[176:179], v2 offset:24576
  buffer_load_dwordx4 a[68:71], v2, s[4:7], s32 offen offset:1024 sc1
  v_mfma_f32_32x32x16_bf16 v[80:95], v[180:183], a[16:19], v[80:95]
  ds_read_b128 v[180:183], v2 offset:25600
  buffer_load_dwordx4 a[72:75], v2, s[4:7], s32 offen offset:2048 sc1
  s_waitcnt lgkmcnt(6)
  v_mfma_f32_32x32x16_bf16 v[96:111], v[184:187], a[16:19], v[96:111]
  ds_read_b128 v[184:187], v2 offset:26624
  v_mfma_f32_32x32x16_bf16 v[112:127], v[188:191], a[16:19], v[112:127]
  ds_read_b128 v[188:191], v2 offset:27648
  s_barrier
  s_waitcnt vmcnt(13)
  s_waitcnt lgkmcnt(6)
  v_mfma_f32_32x32x16_bf16 v[64:79], v[192:195], a[20:23], v[64:79]
  ds_read_b128 v[192:195], v2 offset:28672
  buffer_load_dwordx4 a[76:79], v2, s[4:7], s32 offen offset:3072 sc1
  s_add_u32 s32, s32, 4096
  v_mfma_f32_32x32x16_bf16 v[80:95], v[196:199], a[20:23], v[80:95]
  ds_read_b128 v[196:199], v2 offset:29696
  buffer_load_dwordx4 a[80:83], v2, s[4:7], s32 offen offset:0 sc1
  s_waitcnt lgkmcnt(6)
  v_mfma_f32_32x32x16_bf16 v[96:111], v[200:203], a[20:23], v[96:111]
  ds_read_b128 v[200:203], v2 offset:30720
  v_mfma_f32_32x32x16_bf16 v[112:127], v[204:207], a[20:23], v[112:127]
  ds_read_b128 v[204:207], v2 offset:31744
  s_waitcnt vmcnt(14)
  s_waitcnt lgkmcnt(6)
  v_mfma_f32_32x32x16_bf16 v[64:79], v[176:179], a[24:27], v[64:79]
  ds_read_b128 v[176:179], v2 offset:32768
  s_mul_i32 s36, s22, 4096
  s_add_u32 s37, s36, s51
  s_add_u32 s37, s37, 98304
  s_add_u32 m0, s36, 98304
  v_mfma_f32_32x32x16_bf16 v[80:95], v[180:183], a[24:27], v[80:95]
  ds_read_b128 v[180:183], v2 offset:33792
  buffer_load_dwordx4 v2, s[4:7], s37 offen offset:0 sc1 lds
  s_waitcnt lgkmcnt(6)
  v_mfma_f32_32x32x16_bf16 v[96:111], v[184:187], a[24:27], v[96:111]
  ds_read_b128 v[184:187], v2 offset:34816
  v_mfma_f32_32x32x16_bf16 v[112:127], v[188:191], a[24:27], v[112:127]
  ds_read_b128 v[188:191], v2 offset:35840
  s_waitcnt vmcnt(14)
  s_waitcnt lgkmcnt(6)
  v_mfma_f32_32x32x16_bf16 v[64:79], v[192:195], a[28:31], v[64:79]
  ds_read_b128 v[192:195], v2 offset:36864
  buffer_load_dwordx4 v2, s[4:7], s37 offen offset:1024 sc1 lds
  v_mfma_f32_32x32x16_bf16 v[80:95], v[196:199], a[28:31], v[80:95]
  ds_read_b128 v[196:199], v2 offset:37888
  buffer_load_dwordx4 v2, s[4:7], s37 offen offset:2048 sc1 lds
  s_waitcnt lgkmcnt(6)
  v_mfma_f32_32x32x16_bf16 v[96:111], v[200:203], a[28:31], v[96:111]
  ds_read_b128 v[200:203], v2 offset:38912
  v_mfma_f32_32x32x16_bf16 v[112:127], v[204:207], a[28:31], v[112:127]
  ds_read_b128 v[204:207], v2 offset:39936
  s_waitcnt vmcnt(15)
  s_waitcnt lgkmcnt(6)
  v_mfma_f32_32x32x16_bf16 v[64:79], v[176:179], a[32:35], v[64:79]
  ds_read_b128 v[176:179], v2 offset:40960
  buffer_load_dwordx4 v2, s[4:7], s37 offen offset:3072 sc1 lds
  v_mfma_f32_32x32x16_bf16 v[80:95], v[180:183], a[32:35], v[80:95]
  ds_read_b128 v[180:183], v2 offset:41984
  buffer_load_dwordx4 a[84:87], v2, s[4:7], s32 offen offset:1024 sc1
  s_waitcnt lgkmcnt(6)
  v_mfma_f32_32x32x16_bf16 v[96:111], v[184:187], a[32:35], v[96:111]
  ds_read_b128 v[184:187], v2 offset:43008
  v_mfma_f32_32x32x16_bf16 v[112:127], v[188:191], a[32:35], v[112:127]
  ds_read_b128 v[188:191], v2 offset:44032
  s_waitcnt vmcnt(16)
  s_waitcnt lgkmcnt(6)
  v_mfma_f32_32x32x16_bf16 v[64:79], v[192:195], a[36:39], v[64:79]
  ds_read_b128 v[192:195], v2 offset:45056
  buffer_load_dwordx4 a[88:91], v2, s[4:7], s32 offen offset:2048 sc1
  v_mfma_f32_32x32x16_bf16 v[80:95], v[196:199], a[36:39], v[80:95]
  ds_read_b128 v[196:199], v2 offset:46080
  buffer_load_dwordx4 a[92:95], v2, s[4:7], s32 offen offset:3072 sc1
  s_waitcnt lgkmcnt(6)
  v_mfma_f32_32x32x16_bf16 v[96:111], v[200:203], a[36:39], v[96:111]
  ds_read_b128 v[200:203], v2 offset:47104
  v_mfma_f32_32x32x16_bf16 v[112:127], v[204:207], a[36:39], v[112:127]
  ds_read_b128 v[204:207], v2 offset:48128
  s_waitcnt vmcnt(17)
  s_waitcnt lgkmcnt(6)
  v_mfma_f32_32x32x16_bf16 v[64:79], v[176:179], a[40:43], v[64:79]
  ds_read_b128 v[176:179], v2 offset:49152
  s_add_u32 s32, s32, 4096
  buffer_load_dwordx4 a[96:99], v2, s[4:7], s32 offen offset:0 sc1
  v_mfma_f32_32x32x16_bf16 v[80:95], v[180:183], a[40:43], v[80:95]
  ds_read_b128 v[180:183], v2 offset:50176
  s_mul_i32 s36, s22, 4096
  s_add_u32 s37, s36, s51
  s_add_u32 s37, s37, 114688
  s_add_u32 m0, s36, 114688
  s_waitcnt lgkmcnt(6)
  v_mfma_f32_32x32x16_bf16 v[96:111], v[184:187], a[40:43], v[96:111]
  ds_read_b128 v[184:187], v2 offset:51200
  buffer_load_dwordx4 v2, s[4:7], s37 offen offset:0 sc1 lds
  v_mfma_f32_32x32x16_bf16 v[112:127], v[188:191], a[40:43], v[112:127]
  ds_read_b128 v[188:191], v2 offset:52224
  s_waitcnt vmcnt(18)
  s_waitcnt lgkmcnt(6)
  v_mfma_f32_32x32x16_bf16 v[64:79], v[192:195], a[44:47], v[64:79]
  ds_read_b128 v[192:195], v2 offset:53248
  buffer_load_dwordx4 v2, s[4:7], s37 offen offset:1024 sc1 lds
  v_mfma_f32_32x32x16_bf16 v[80:95], v[196:199], a[44:47], v[80:95]
  ds_read_b128 v[196:199], v2 offset:54272
  buffer_load_dwordx4 v2, s[4:7], s37 offen offset:2048 sc1 lds
  s_waitcnt lgkmcnt(6)
  v_mfma_f32_32x32x16_bf16 v[96:111], v[200:203], a[44:47], v[96:111]
  ds_read_b128 v[200:203], v2 offset:55296
  v_mfma_f32_32x32x16_bf16 v[112:127], v[204:207], a[44:47], v[112:127]
  ds_read_b128 v[204:207], v2 offset:56320
  s_waitcnt vmcnt(19)
  s_waitcnt lgkmcnt(6)
  v_mfma_f32_32x32x16_bf16 v[64:79], v[176:179], a[48:51], v[64:79]
  ds_read_b128 v[176:179], v2 offset:57344
  buffer_load_dwordx4 v2, s[4:7], s37 offen offset:3072 sc1 lds
  v_mfma_f32_32x32x16_bf16 v[80:95], v[180:183], a[48:51], v[80:95]
  ds_read_b128 v[180:183], v2 offset:58368
  buffer_load_dwordx4 a[100:103], v2, s[4:7], s32 offen offset:1024 sc1
  s_waitcnt lgkmcnt(6)
  v_mfma_f32_32x32x16_bf16 v[96:111], v[184:187], a[48:51], v[96:111]
  ds_read_b128 v[184:187], v2 offset:59392
  v_mfma_f32_32x32x16_bf16 v[112:127], v[188:191], a[48:51], v[112:127]
  ds_read_b128 v[188:191], v2 offset:60416
  s_barrier
  s_waitcnt vmcnt(20)
  s_waitcnt lgkmcnt(6)
  v_mfma_f32_32x32x16_bf16 v[64:79], v[192:195], a[52:55], v[64:79]
  ds_read_b128 v[192:195], v2 offset:61440
  buffer_load_dwordx4 a[104:107], v2, s[4:7], s32 offen offset:2048 sc1
  v_mfma_f32_32x32x16_bf16 v[80:95], v[196:199], a[52:55], v[80:95]
  ds_read_b128 v[196:199], v2 offset:62464
  s_waitcnt lgkmcnt(6)
  v_mfma_f32_32x32x16_bf16 v[96:111], v[200:203], a[52:55], v[96:111]
  ds_read_b128 v[200:203], v2 offset:63488
  v_mfma_f32_32x32x16_bf16 v[112:127], v[204:207], a[52:55], v[112:127]
  ds_read_b128 v[204:207], v2 offset:64512
  s_waitcnt vmcnt(20)
  s_waitcnt lgkmcnt(6)
  v_mfma_f32_32x32x16_bf16 v[64:79], v[176:179], a[56:59], v[64:79]
  ds_read_b128 v[176:179], v30 offset:0
  buffer_load_dwordx4 a[108:111], v2, s[4:7], s32 offen offset:3072 sc1
  s_add_u32 s32, s32, 4096
  v_mfma_f32_32x32x16_bf16 v[80:95], v[180:183], a[56:59], v[80:95]
  ds_read_b128 v[180:183], v30 offset:1024
  buffer_load_dwordx4 a[112:115], v2, s[4:7], s32 offen offset:0 sc1
  s_waitcnt lgkmcnt(6)
  v_mfma_f32_32x32x16_bf16 v[96:111], v[184:187], a[56:59], v[96:111]
  ds_read_b128 v[184:187], v30 offset:2048
  v_mfma_f32_32x32x16_bf16 v[112:127], v[188:191], a[56:59], v[112:127]
  ds_read_b128 v[188:191], v30 offset:3072
  s_waitcnt vmcnt(21)
  s_waitcnt lgkmcnt(6)
  v_mfma_f32_32x32x16_bf16 v[64:79], v[192:195], a[60:63], v[64:79]
  ds_read_b128 v[192:195], v30 offset:4096
  s_mul_i32 s36, s22, 4096
  s_add_u32 s37, s36, s51
  s_add_u32 s37, s37, 131072
  s_add_u32 m0, s36, 131072
  v_mfma_f32_32x32x16_bf16 v[80:95], v[196:199], a[60:63], v[80:95]
  ds_read_b128 v[196:199], v30 offset:5120
  buffer_load_dwordx4 v2, s[4:7], s37 offen offset:0 sc1 lds
  s_waitcnt lgkmcnt(6)
  v_mfma_f32_32x32x16_bf16 v[96:111], v[200:203], a[60:63], v[96:111]
  ds_read_b128 v[200:203], v30 offset:6144
  buffer_load_dwordx4 v2, s[4:7], s37 offen offset:1024 sc1 lds
  v_mfma_f32_32x32x16_bf16 v[112:127], v[204:207], a[60:63], v[112:127]
  ds_read_b128 v[204:207], v30 offset:7168
  s_waitcnt vmcnt(22)
  s_waitcnt lgkmcnt(6)
  v_mfma_f32_32x32x16_bf16 v[64:79], v[176:179], a[64:67], v[64:79]
  ds_read_b128 v[176:179], v30 offset:8192
  buffer_load_dwordx4 v2, s[4:7], s37 offen offset:2048 sc1 lds
  v_mfma_f32_32x32x16_bf16 v[80:95], v[180:183], a[64:67], v[80:95]
  ds_read_b128 v[180:183], v30 offset:9216
  buffer_load_dwordx4 v2, s[4:7], s37 offen offset:3072 sc1 lds
  s_waitcnt lgkmcnt(6)
  v_mfma_f32_32x32x16_bf16 v[96:111], v[184:187], a[64:67], v[96:111]
  ds_read_b128 v[184:187], v30 offset:10240
  v_mfma_f32_32x32x16_bf16 v[112:127], v[188:191], a[64:67], v[112:127]
  ds_read_b128 v[188:191], v30 offset:11264
  s_barrier
  s_waitcnt vmcnt(23)
  s_waitcnt lgkmcnt(6)
  v_mfma_f32_32x32x16_bf16 v[64:79], v[192:195], a[68:71], v[64:79]
  ds_read_b128 v[192:195], v30 offset:12288
  buffer_load_dwordx4 a[116:119], v2, s[4:7], s32 offen offset:1024 sc1
  v_mfma_f32_32x32x16_bf16 v[80:95], v[196:199], a[68:71], v[80:95]
  ds_read_b128 v[196:199], v30 offset:13312
  buffer_load_dwordx4 a[120:123], v2, s[4:7], s32 offen offset:2048 sc1
  s_waitcnt lgkmcnt(6)
  v_mfma_f32_32x32x16_bf16 v[96:111], v[200:203], a[68:71], v[96:111]
  ds_read_b128 v[200:203], v30 offset:14336
  v_mfma_f32_32x32x16_bf16 v[112:127], v[204:207], a[68:71], v[112:127]
  ds_read_b128 v[204:207], v30 offset:15360
  s_waitcnt vmcnt(24)
  s_waitcnt lgkmcnt(6)
  v_mfma_f32_32x32x16_bf16 v[64:79], v[176:179], a[72:75], v[64:79]
  ds_read_b128 v[176:179], v30 offset:16384
  buffer_load_dwordx4 a[124:127], v2, s[4:7], s32 offen offset:3072 sc1
  s_add_u32 s32, s32, 4096
  v_mfma_f32_32x32x16_bf16 v[80:95], v[180:183], a[72:75], v[80:95]
  ds_read_b128 v[180:183], v30 offset:17408
  buffer_load_dwordx4 a[128:131], v2, s[4:7], s32 offen offset:0 sc1
  s_waitcnt lgkmcnt(6)
  v_mfma_f32_32x32x16_bf16 v[96:111], v[184:187], a[72:75], v[96:111]
  ds_read_b128 v[184:187], v30 offset:18432
  v_mfma_f32_32x32x16_bf16 v[112:127], v[188:191], a[72:75], v[112:127]
  ds_read_b128 v[188:191], v30 offset:19456
  s_waitcnt vmcnt(25)
  s_waitcnt lgkmcnt(6)
  v_mfma_f32_32x32x16_bf16 v[64:79], v[192:195], a[76:79], v[64:79]
  ds_read_b128 v[192:195], v30 offset:20480
  s_mul_i32 s36, s22, 4096
  s_add_u32 s37, s36, s51
  s_add_u32 s37, s37, 147456
  s_add_u32 m0, s36, 0
  v_mfma_f32_32x32x16_bf16 v[80:95], v[196:199], a[76:79], v[80:95]
  ds_read_b128 v[196:199], v30 offset:21504
  buffer_load_dwordx4 v2, s[4:7], s37 offen offset:0 sc1 lds
  s_waitcnt lgkmcnt(6)
  v_mfma_f32_32x32x16_bf16 v[96:111], v[200:203], a[76:79], v[96:111]
  ds_read_b128 v[200:203], v30 offset:22528
  buffer_load_dwordx4 v2, s[4:7], s37 offen offset:1024 sc1 lds
  v_mfma_f32_32x32x16_bf16 v[112:127], v[204:207], a[76:79], v[112:127]
  ds_read_b128 v[204:207], v30 offset:23552
  s_waitcnt vmcnt(26)
  s_waitcnt lgkmcnt(6)
  v_mfma_f32_32x32x16_bf16 v[64:79], v[176:179], a[80:83], v[64:79]
  ds_read_b128 v[176:179], v30 offset:24576
  buffer_load_dwordx4 v2, s[4:7], s37 offen offset:2048 sc1 lds
  v_mfma_f32_32x32x16_bf16 v[80:95], v[180:183], a[80:83], v[80:95]
  ds_read_b128 v[180:183], v30 offset:25600
  s_waitcnt lgkmcnt(6)
  v_mfma_f32_32x32x16_bf16 v[96:111], v[184:187], a[80:83], v[96:111]
  ds_read_b128 v[184:187], v30 offset:26624
  v_mfma_f32_32x32x16_bf16 v[112:127], v[188:191], a[80:83], v[112:127]
  ds_read_b128 v[188:191], v30 offset:27648
  s_waitcnt vmcnt(23)
  s_barrier
  s_waitcnt vmcnt(22)
  s_waitcnt lgkmcnt(6)
  v_mfma_f32_32x32x16_bf16 v[64:79], v[192:195], a[84:87], v[64:79]
  ds_read_b128 v[192:195], v30 offset:28672
  buffer_load_dwordx4 v2, s[4:7], s37 offen offset:3072 sc1 lds
  v_mfma_f32_32x32x16_bf16 v[80:95], v[196:199], a[84:87], v[80:95]
  ds_read_b128 v[196:199], v30 offset:29696
  buffer_load_dwordx4 a[132:135], v2, s[4:7], s32 offen offset:1024 sc1
  s_waitcnt lgkmcnt(6)
  v_mfma_f32_32x32x16_bf16 v[96:111], v[200:203], a[84:87], v[96:111]
  ds_read_b128 v[200:203], v30 offset:30720
  v_mfma_f32_32x32x16_bf16 v[112:127], v[204:207], a[84:87], v[112:127]
  ds_read_b128 v[204:207], v30 offset:31744
  s_waitcnt vmcnt(23)
  s_waitcnt lgkmcnt(6)
  v_mfma_f32_32x32x16_bf16 v[64:79], v[176:179], a[88:91], v[64:79]
  ds_read_b128 v[176:179], v30 offset:32768
  buffer_load_dwordx4 a[136:139], v2, s[4:7], s32 offen offset:2048 sc1
  v_mfma_f32_32x32x16_bf16 v[80:95], v[180:183], a[88:91], v[80:95]
  ds_read_b128 v[180:183], v30 offset:33792
  buffer_load_dwordx4 a[140:143], v2, s[4:7], s32 offen offset:3072 sc1
  s_waitcnt lgkmcnt(6)
  v_mfma_f32_32x32x16_bf16 v[96:111], v[184:187], a[88:91], v[96:111]
  ds_read_b128 v[184:187], v30 offset:34816
  v_mfma_f32_32x32x16_bf16 v[112:127], v[188:191], a[88:91], v[112:127]
  ds_read_b128 v[188:191], v30 offset:35840
  s_waitcnt vmcnt(24)
  s_waitcnt lgkmcnt(6)
  v_mfma_f32_32x32x16_bf16 v[64:79], v[192:195], a[92:95], v[64:79]
  ds_read_b128 v[192:195], v30 offset:36864
  s_add_u32 s32, s32, 4096
  buffer_load_dwordx4 a[144:147], v2, s[4:7], s32 offen offset:0 sc1
  v_mfma_f32_32x32x16_bf16 v[80:95], v[196:199], a[92:95], v[80:95]
  ds_read_b128 v[196:199], v30 offset:37888
  s_mul_i32 s36, s22, 3072
  s_add_u32 s37, s36, s38
  s_add_u32 s37, s37, 163840
  s_add_u32 m0, s36, 24576
  s_waitcnt lgkmcnt(6)
  v_mfma_f32_32x32x16_bf16 v[96:111], v[200:203], a[92:95], v[96:111]
  ds_read_b128 v[200:203], v30 offset:38912
  buffer_load_dwordx4 v2, s[4:7], s37 offen offset:0 sc1 lds
  v_mfma_f32_32x32x16_bf16 v[112:127], v[204:207], a[92:95], v[112:127]
  ds_read_b128 v[204:207], v30 offset:39936
  s_waitcnt vmcnt(25)
  s_waitcnt lgkmcnt(6)
  v_mfma_f32_32x32x16_bf16 v[64:79], v[176:179], a[96:99], v[64:79]
  ds_read_b128 v[176:179], v30 offset:40960
  buffer_load_dwordx4 v2, s[4:7], s37 offen offset:1024 sc1 lds
  v_mfma_f32_32x32x16_bf16 v[80:95], v[180:183], a[96:99], v[80:95]
  ds_read_b128 v[180:183], v30 offset:41984
  buffer_load_dwordx4 v2, s[4:7], s37 offen offset:2048 sc1 lds
  s_waitcnt lgkmcnt(6)
  v_mfma_f32_32x32x16_bf16 v[96:111], v[184:187], a[96:99], v[96:111]
  ds_read_b128 v[184:187], v30 offset:43008
  v_mfma_f32_32x32x16_bf16 v[112:127], v[188:191], a[96:99], v[112:127]
  ds_read_b128 v[188:191], v30 offset:44032
  s_waitcnt vmcnt(23)
  s_barrier
  s_waitcnt vmcnt(22)
  s_waitcnt lgkmcnt(6)
  v_mfma_f32_32x32x16_bf16 v[64:79], v[192:195], a[100:103], v[64:79]
  ds_read_b128 v[192:195], v30 offset:45056
  buffer_load_dwordx4 a[148:151], v2, s[4:7], s32 offen offset:1024 sc1
  v_mfma_f32_32x32x16_bf16 v[80:95], v[196:199], a[100:103], v[80:95]
  ds_read_b128 v[196:199], v30 offset:46080
  buffer_load_dwordx4 a[152:155], v2, s[4:7], s32 offen offset:2048 sc1
  s_waitcnt lgkmcnt(6)
  v_mfma_f32_32x32x16_bf16 v[96:111], v[200:203], a[100:103], v[96:111]
  ds_read_b128 v[200:203], v30 offset:47104
  v_mfma_f32_32x32x16_bf16 v[112:127], v[204:207], a[100:103], v[112:127]
  ds_read_b128 v[204:207], v30 offset:48128
  s_waitcnt vmcnt(23)
  s_waitcnt lgkmcnt(6)
  v_mfma_f32_32x32x16_bf16 v[64:79], v[176:179], a[104:107], v[64:79]
  ds_read_b128 v[176:179], v30 offset:49152
  buffer_load_dwordx4 a[156:159], v2, s[4:7], s32 offen offset:3072 sc1
  v_mfma_f32_32x32x16_bf16 v[80:95], v[180:183], a[104:107], v[80:95]
  ds_read_b128 v[180:183], v30 offset:50176
  s_waitcnt lgkmcnt(6)
  v_mfma_f32_32x32x16_bf16 v[96:111], v[184:187], a[104:107], v[96:111]
  ds_read_b128 v[184:187], v30 offset:51200
  v_mfma_f32_32x32x16_bf16 v[112:127], v[188:191], a[104:107], v[112:127]
  ds_read_b128 v[188:191], v30 offset:52224
  s_waitcnt vmcnt(23)
  s_waitcnt lgkmcnt(6)
  v_mfma_f32_32x32x16_bf16 v[64:79], v[192:195], a[108:111], v[64:79]
  ds_read_b128 v[192:195], v30 offset:53248
  s_mul_i32 s36, s22, 3072
  s_add_u32 s37, s36, s38
  s_add_u32 s37, s37, 176128
  s_add_u32 m0, s36, 36864
  v_mfma_f32_32x32x16_bf16 v[80:95], v[196:199], a[108:111], v[80:95]
  ds_read_b128 v[196:199], v30 offset:54272
  buffer_load_dwordx4 v2, s[4:7], s37 offen offset:0 sc1 lds
  s_waitcnt lgkmcnt(6)
  v_mfma_f32_32x32x16_bf16 v[96:111], v[200:203], a[108:111], v[96:111]
  ds_read_b128 v[200:203], v30 offset:55296
  buffer_load_dwordx4 v2, s[4:7], s37 offen offset:1024 sc1 lds
  v_mfma_f32_32x32x16_bf16 v[112:127], v[204:207], a[108:111], v[112:127]
  ds_read_b128 v[204:207], v30 offset:56320
  s_waitcnt vmcnt(24)
  s_waitcnt lgkmcnt(6)
  v_mfma_f32_32x32x16_bf16 v[64:79], v[176:179], a[112:115], v[64:79]
  ds_read_b128 v[176:179], v30 offset:57344
  buffer_load_dwordx4 v2, s[4:7], s37 offen offset:2048 sc1 lds
  s_mul_i32 s36, s22, 3072
  v_mfma_f32_32x32x16_bf16 v[80:95], v[180:183], a[112:115], v[80:95]
  ds_read_b128 v[180:183], v30 offset:58368
  s_add_u32 s37, s36, s38
  s_add_u32 s37, s37, 188416
  s_add_u32 m0, s36, 49152
  s_waitcnt lgkmcnt(6)
  v_mfma_f32_32x32x16_bf16 v[96:111], v[184:187], a[112:115], v[96:111]
  ds_read_b128 v[184:187], v30 offset:59392
  buffer_load_dwordx4 v2, s[4:7], s37 offen offset:0 sc1 lds
  v_mfma_f32_32x32x16_bf16 v[112:127], v[188:191], a[112:115], v[112:127]
  ds_read_b128 v[188:191], v30 offset:60416
  v_add_f32 v224, v224, v226
  v_add_f32 v225, v225, v227
  v_add_f32 v228, v228, v230
  v_add_f32 v229, v229, v231
  s_waitcnt vmcnt(22)
  s_barrier
  s_waitcnt vmcnt(21)
  s_waitcnt lgkmcnt(6)
  v_mfma_f32_32x32x16_bf16 v[64:79], v[192:195], a[116:119], v[64:79]
  ds_read_b128 v[192:195], v30 offset:61440
  v_add_f32 v224, v224, v228
  v_add_f32 v225, v225, v229
  v_mov_b32 v226, v224
  v_mov_b32 v227, v225
  v_mfma_f32_32x32x16_bf16 v[80:95], v[196:199], a[116:119], v[80:95]
  ds_read_b128 v[196:199], v30 offset:62464
  v_permlane32_swap_b32 v224, v226
  v_permlane32_swap_b32 v225, v227
  v_add_f32 v224, v224, v226
  v_add_f32 v225, v225, v227
  s_waitcnt lgkmcnt(6)
  v_mfma_f32_32x32x16_bf16 v[96:111], v[200:203], a[116:119], v[96:111]
  ds_read_b128 v[200:203], v30 offset:63488
  v_mul_f32 v216, 0xbacccccd, v224
  v_mul_f32 v225, 0x3acccccd, v225
  v_fma_f32 v225, -v216, v216, v225
  v_max_f32 v225, 0, v225
  v_mfma_f32_32x32x16_bf16 v[112:127], v[204:207], a[116:119], v[112:127]
  ds_read_b128 v[204:207], v30 offset:64512
  v_add_f32 v225, 0x3727c5ac, v225
  v_rsq_f32 v217, v225
  s_nop 0
  v_mul_f32 v217, v217, v217
  s_waitcnt vmcnt(20)
  s_waitcnt lgkmcnt(6)
  v_mfma_f32_32x32x16_bf16 v[64:79], v[176:179], a[120:123], v[64:79]
  ds_read_b128 v[176:179], v31 offset:0
  v_and_b32 v224, 0xffff0000, v216
  v_sub_f32 v225, v216, v224
  v_and_b32 v220, 0xffff0000, v225
  v_sub_f32 v225, v225, v220
  v_mfma_f32_32x32x16_bf16 v[80:95], v[180:183], a[120:123], v[80:95]
  ds_read_b128 v[180:183], v31 offset:1024
  v_lshrrev_b32 v224, 16, v224
  v_and_b32 v221, 0xffff0000, v225
  v_or_b32 v220, v220, v224
  v_or_b32 v221, v221, v224
  s_waitcnt lgkmcnt(6)
  v_mfma_f32_32x32x16_bf16 v[96:111], v[184:187], a[120:123], v[96:111]
  ds_read_b128 v[184:187], v31 offset:2048
  v_mov_b32 v222, v220
  v_mov_b32 v223, 0
  v_mfma_f32_32x32x16_bf16 v[112:127], v[188:191], a[120:123], v[112:127]
  ds_read_b128 v[188:191], v31 offset:3072
  buffer_load_dwordx4 v2, s[4:7], s37 offen offset:1024 sc1 lds
  s_waitcnt vmcnt(20)
  s_waitcnt lgkmcnt(6)
  v_mfma_f32_32x32x16_bf16 v[64:79], v[192:195], a[124:127], v[64:79]
  ds_read_b128 v[192:195], v31 offset:4096
  buffer_load_dwordx4 v2, s[4:7], s37 offen offset:2048 sc1 lds
  s_mul_i32 s36, s22, 3072
  v_mfma_f32_32x32x16_bf16 v[80:95], v[196:199], a[124:127], v[80:95]
  ds_read_b128 v[196:199], v31 offset:5120
  s_add_u32 s37, s36, s38
  s_add_u32 s37, s37, 200704
  s_add_u32 m0, s36, 61440
  s_waitcnt lgkmcnt(6)
  v_mfma_f32_32x32x16_bf16 v[96:111], v[200:203], a[124:127], v[96:111]
  ds_read_b128 v[200:203], v31 offset:6144
  buffer_load_dwordx4 v2, s[4:7], s37 offen offset:0 sc1 lds
  v_mfma_f32_32x32x16_bf16 v[112:127], v[204:207], a[124:127], v[112:127]
  ds_read_b128 v[204:207], v31 offset:7168
  buffer_load_dwordx4 v2, s[4:7], s37 offen offset:1024 sc1 lds
  s_waitcnt vmcnt(22)
  s_waitcnt lgkmcnt(6)
  v_mfma_f32_32x32x16_bf16 v[64:79], v[176:179], a[128:131], v[64:79]
  ds_read_b128 v[176:179], v31 offset:8192
  buffer_load_dwordx4 v2, s[4:7], s37 offen offset:2048 sc1 lds
  s_mul_i32 s36, s22, 3072
  v_mfma_f32_32x32x16_bf16 v[80:95], v[180:183], a[128:131], v[80:95]
  ds_read_b128 v[180:183], v31 offset:9216
  s_add_u32 s37, s36, s38
  s_add_u32 s37, s37, 212992
  s_add_u32 m0, s36, 73728
  s_waitcnt lgkmcnt(6)
  v_mfma_f32_32x32x16_bf16 v[96:111], v[184:187], a[128:131], v[96:111]
  ds_read_b128 v[184:187], v31 offset:10240
  buffer_load_dwordx4 v2, s[4:7], s37 offen offset:0 sc1 lds
  v_mfma_f32_32x32x16_bf16 v[112:127], v[188:191], a[128:131], v[112:127]
  ds_read_b128 v[188:191], v31 offset:11264
  buffer_load_dwordx4 v2, s[4:7], s37 offen offset:1024 sc1 lds
  s_waitcnt vmcnt(21)
  s_barrier
  s_waitcnt vmcnt(20)
  s_waitcnt lgkmcnt(6)
  v_mfma_f32_32x32x16_bf16 v[64:79], v[192:195], a[132:135], v[64:79]
  ds_read_b128 v[192:195], v31 offset:12288
  buffer_load_dwordx4 v2, s[4:7], s37 offen offset:2048 sc1 lds
  s_mul_i32 s36, s22, 3072
  v_mfma_f32_32x32x16_bf16 v[80:95], v[196:199], a[132:135], v[80:95]
  ds_read_b128 v[196:199], v31 offset:13312
  s_add_u32 s37, s36, s38
  s_add_u32 s37, s37, 225280
  s_add_u32 m0, s36, 86016
  s_waitcnt lgkmcnt(6)
  v_mfma_f32_32x32x16_bf16 v[96:111], v[200:203], a[132:135], v[96:111]
  ds_read_b128 v[200:203], v31 offset:14336
  buffer_load_dwordx4 v2, s[4:7], s37 offen offset:0 sc1 lds
  v_mfma_f32_32x32x16_bf16 v[112:127], v[204:207], a[132:135], v[112:127]
  ds_read_b128 v[204:207], v31 offset:15360
  s_waitcnt vmcnt(21)
  s_waitcnt lgkmcnt(6)
  v_mfma_f32_32x32x16_bf16 v[64:79], v[176:179], a[136:139], v[64:79]
  ds_read_b128 v[176:179], v2 offset:0
  buffer_load_dwordx4 v2, s[4:7], s37 offen offset:1024 sc1 lds
  v_mfma_f32_32x32x16_bf16 v[80:95], v[180:183], a[136:139], v[80:95]
  ds_read_b128 v[180:183], v2 offset:1024
  buffer_load_dwordx4 v2, s[4:7], s37 offen offset:2048 sc1 lds
  s_waitcnt lgkmcnt(6)
  v_mfma_f32_32x32x16_bf16 v[96:111], v[184:187], a[136:139], v[96:111]
  ds_read_b128 v[184:187], v2 offset:2048
  v_mfma_f32_32x32x16_bf16 v[112:127], v[188:191], a[136:139], v[112:127]
  ds_read_b128 v[188:191], v2 offset:3072
  s_waitcnt vmcnt(22)
  s_waitcnt lgkmcnt(6)
  v_mfma_f32_32x32x16_bf16 v[64:79], v[192:195], a[140:143], v[64:79]
  ds_read_b128 v[192:195], v2 offset:4096
  s_mul_i32 s36, s22, 3072
  s_add_u32 s37, s36, s38
  s_add_u32 s37, s37, 237568
  s_add_u32 m0, s36, 98304
  v_mfma_f32_32x32x16_bf16 v[80:95], v[196:199], a[140:143], v[80:95]
  ds_read_b128 v[196:199], v2 offset:5120
  buffer_load_dwordx4 v2, s[4:7], s37 offen offset:0 sc1 lds
  s_waitcnt lgkmcnt(6)
  v_mfma_f32_32x32x16_bf16 v[96:111], v[200:203], a[140:143], v[96:111]
  ds_read_b128 v[200:203], v2 offset:6144
  buffer_load_dwordx4 v2, s[4:7], s37 offen offset:1024 sc1 lds
  v_mfma_f32_32x32x16_bf16 v[112:127], v[204:207], a[140:143], v[112:127]
  ds_read_b128 v[204:207], v2 offset:7168
  s_waitcnt vmcnt(23)
  s_waitcnt lgkmcnt(6)
  v_mfma_f32_32x32x16_bf16 v[64:79], v[176:179], a[144:147], v[64:79]
  ds_read_b128 v[176:179], v2 offset:8192
  buffer_load_dwordx4 v2, s[4:7], s37 offen offset:2048 sc1 lds
  s_mul_i32 s36, s22, 3072
  v_mfma_f32_32x32x16_bf16 v[80:95], v[180:183], a[144:147], v[80:95]
  ds_read_b128 v[180:183], v2 offset:9216
  s_add_u32 s37, s36, s38
  s_add_u32 s37, s37, 249856
  s_add_u32 m0, s36, 110592
  s_waitcnt lgkmcnt(6)
  v_mfma_f32_32x32x16_bf16 v[96:111], v[184:187], a[144:147], v[96:111]
  ds_read_b128 v[184:187], v2 offset:10240
  buffer_load_dwordx4 v2, s[4:7], s37 offen offset:0 sc1 lds
  v_mfma_f32_32x32x16_bf16 v[112:127], v[188:191], a[144:147], v[112:127]
  ds_read_b128 v[188:191], v2 offset:11264
  s_waitcnt vmcnt(22)
  s_barrier
  s_waitcnt vmcnt(21)
  s_waitcnt lgkmcnt(6)
  v_mfma_f32_32x32x16_bf16 v[64:79], v[192:195], a[148:151], v[64:79]
  ds_read_b128 v[192:195], v2 offset:12288
  buffer_load_dwordx4 v2, s[4:7], s37 offen offset:1024 sc1 lds
  v_mfma_f32_32x32x16_bf16 v[80:95], v[196:199], a[148:151], v[80:95]
  ds_read_b128 v[196:199], v2 offset:13312
  buffer_load_dwordx4 v2, s[4:7], s37 offen offset:2048 sc1 lds
  s_waitcnt lgkmcnt(6)
  v_mfma_f32_32x32x16_bf16 v[96:111], v[200:203], a[148:151], v[96:111]
  ds_read_b128 v[200:203], v2 offset:14336
  v_mfma_f32_32x32x16_bf16 v[112:127], v[204:207], a[148:151], v[112:127]
  ds_read_b128 v[204:207], v2 offset:15360
  s_waitcnt vmcnt(22)
  s_waitcnt lgkmcnt(6)
  v_mfma_f32_32x32x16_bf16 v[64:79], v[176:179], a[152:155], v[64:79]
  ds_read_b128 v[176:179], v31 offset:20480
  s_mul_i32 s36, s22, 3072
  s_add_u32 s37, s36, s38
  s_add_u32 s37, s37, 262144
  s_add_u32 m0, s36, 122880
  v_mfma_f32_32x32x16_bf16 v[80:95], v[180:183], a[152:155], v[80:95]
  ds_read_b128 v[180:183], v31 offset:21504
  buffer_load_dwordx4 v2, s[4:7], s37 offen offset:0 sc1 lds
  s_waitcnt lgkmcnt(6)
  v_mfma_f32_32x32x16_bf16 v[96:111], v[184:187], a[152:155], v[96:111]
  ds_read_b128 v[184:187], v31 offset:22528
  buffer_load_dwordx4 v2, s[4:7], s37 offen offset:1024 sc1 lds
  v_mfma_f32_32x32x16_bf16 v[112:127], v[188:191], a[152:155], v[112:127]
  ds_read_b128 v[188:191], v31 offset:23552
  s_waitcnt vmcnt(23)
  s_waitcnt lgkmcnt(6)
  v_mfma_f32_32x32x16_bf16 v[64:79], v[192:195], a[156:159], v[64:79]
  ds_read_b128 v[192:195], v2 offset:24576
  buffer_load_dwordx4 v2, s[4:7], s37 offen offset:2048 sc1 lds
  s_mul_i32 s36, s22, 3072
  v_mfma_f32_32x32x16_bf16 v[80:95], v[196:199], a[156:159], v[80:95]
  ds_read_b128 v[196:199], v2 offset:25600
  s_add_u32 s37, s36, s38
  s_add_u32 s37, s37, 274432
  s_add_u32 m0, s36, 135168
  s_waitcnt lgkmcnt(6)
  v_mfma_f32_32x32x16_bf16 v[96:111], v[200:203], a[156:159], v[96:111]
  ds_read_b128 v[200:203], v2 offset:26624
  buffer_load_dwordx4 v2, s[4:7], s37 offen offset:0 sc1 lds
  v_mfma_f32_32x32x16_bf16 v[112:127], v[204:207], a[156:159], v[112:127]
  ds_read_b128 v[204:207], v2 offset:27648
  s_waitcnt lgkmcnt(6)
  v_mfma_f32_32x32x16_bf16 v[64:79], v[176:179], v[220:223], v[64:79]
  ds_read_b128 v[176:179], v2 offset:28672
  v_mfma_f32_32x32x16_bf16 v[80:95], v[180:183], v[220:223], v[80:95]
  ds_read_b128 v[180:183], v2 offset:29696
  s_waitcnt lgkmcnt(6)
  v_mfma_f32_32x32x16_bf16 v[96:111], v[184:187], v[220:223], v[96:111]
  ds_read_b128 v[184:187], v2 offset:30720
  v_mfma_f32_32x32x16_bf16 v[112:127], v[188:191], v[220:223], v[112:127]
  ds_read_b128 v[188:191], v2 offset:31744
  s_waitcnt lgkmcnt(6)
  v_mfma_f32_32x32x16_bf16 v[128:143], v[192:195], a[0:3], 0
  ds_read_b128 v[192:195], v2 offset:32768
  v_mfma_f32_32x32x16_bf16 v[144:159], v[196:199], a[0:3], 0
  ds_read_b128 v[196:199], v2 offset:33792
  v_max_f32 v64, 0, v64
  v_mul_f32 v68, v217, v68
  v_max_f32 v65, 0, v65
  v_mul_f32 v69, v217, v69
  v_max_f32 v66, 0, v66
  s_waitcnt lgkmcnt(6)
  v_mfma_f32_32x32x16_bf16 v[160:175], v[200:203], a[0:3], 0
  ds_read_b128 v[200:203], v2 offset:34816
  v_mul_f32 v70, v217, v70
  v_max_f32 v67, 0, v67
  v_mul_f32 v71, v217, v71
  v_mul_f32 v64, v64, v68
  v_mul_f32 v65, v65, v69
  s_waitcnt vmcnt(22)
  s_barrier
  v_mfma_f32_32x32x16_bf16 v[128:143], v[204:207], a[4:7], v[128:143]
  ds_read_b128 v[204:207], v2 offset:35840
  v_mul_f32 v66, v66, v70
  v_mul_f32 v67, v67, v71
  v_cvt_pk_bf16_f32 v224, v64, v65
  v_cvt_pk_bf16_f32 v225, v66, v67
  v_max_f32 v72, 0, v72
  s_waitcnt lgkmcnt(6)
  v_mfma_f32_32x32x16_bf16 v[144:159], v[176:179], a[4:7], v[144:159]
  ds_read_b128 v[176:179], v2 offset:36864
  v_mul_f32 v76, v217, v76
  v_max_f32 v73, 0, v73
  v_mul_f32 v77, v217, v77
  v_max_f32 v74, 0, v74
  v_mul_f32 v78, v217, v78
  v_mfma_f32_32x32x16_bf16 v[160:175], v[180:183], a[4:7], v[160:175]
  ds_read_b128 v[180:183], v2 offset:37888
  v_max_f32 v75, 0, v75
  v_mul_f32 v79, v217, v79
  v_mul_f32 v72, v72, v76
  v_mul_f32 v73, v73, v77
  v_mul_f32 v74, v74, v78
  s_waitcnt lgkmcnt(6)
  v_mfma_f32_32x32x16_bf16 v[128:143], v[184:187], a[8:11], v[128:143]
  ds_read_b128 v[184:187], v2 offset:38912
  v_mul_f32 v75, v75, v79
  v_cvt_pk_bf16_f32 v226, v72, v73
  v_cvt_pk_bf16_f32 v227, v74, v75
  v_mfma_f32_32x32x16_bf16 v[144:159], v[188:191], a[8:11], v[144:159]
  ds_read_b128 v[188:191], v2 offset:39936
  buffer_store_dwordx4 v[224:227], v19, s[4:7], s28 offen offset:0 sc1
  s_waitcnt lgkmcnt(6)
  v_mfma_f32_32x32x16_bf16 v[160:175], v[192:195], a[8:11], v[160:175]
  ds_read_b128 v[192:195], v2 offset:40960
  v_max_f32 v80, 0, v80
  v_mul_f32 v84, v217, v84
  v_max_f32 v81, 0, v81
  v_mul_f32 v85, v217, v85
  v_max_f32 v82, 0, v82
  v_mfma_f32_32x32x16_bf16 v[128:143], v[196:199], a[12:15], v[128:143]
  ds_read_b128 v[196:199], v2 offset:41984
  v_mul_f32 v86, v217, v86
  v_max_f32 v83, 0, v83
  v_mul_f32 v87, v217, v87
  v_mul_f32 v80, v80, v84
  v_mul_f32 v81, v81, v85
  s_waitcnt lgkmcnt(6)
  v_mfma_f32_32x32x16_bf16 v[144:159], v[200:203], a[12:15], v[144:159]
  ds_read_b128 v[200:203], v2 offset:43008
  v_mul_f32 v82, v82, v86
  v_mul_f32 v83, v83, v87
  v_cvt_pk_bf16_f32 v228, v80, v81
  v_cvt_pk_bf16_f32 v229, v82, v83
  v_max_f32 v88, 0, v88
  v_mfma_f32_32x32x16_bf16 v[160:175], v[204:207], a[12:15], v[160:175]
  ds_read_b128 v[204:207], v2 offset:44032
  v_mul_f32 v92, v217, v92
  v_max_f32 v89, 0, v89
  v_mul_f32 v93, v217, v93
  v_max_f32 v90, 0, v90
  v_mul_f32 v94, v217, v94
  s_waitcnt lgkmcnt(6)
  v_mfma_f32_32x32x16_bf16 v[128:143], v[176:179], a[16:19], v[128:143]
  ds_read_b128 v[176:179], v2 offset:45056
  v_max_f32 v91, 0, v91
  v_mul_f32 v95, v217, v95
  v_mul_f32 v88, v88, v92
  v_mul_f32 v89, v89, v93
  v_mul_f32 v90, v90, v94
  v_mfma_f32_32x32x16_bf16 v[144:159], v[180:183], a[16:19], v[144:159]
  ds_read_b128 v[180:183], v2 offset:46080
  v_mul_f32 v91, v91, v95
  v_cvt_pk_bf16_f32 v230, v88, v89
  v_cvt_pk_bf16_f32 v231, v90, v91
  s_waitcnt lgkmcnt(6)
  v_mfma_f32_32x32x16_bf16 v[160:175], v[184:187], a[16:19], v[160:175]
  ds_read_b128 v[184:187], v2 offset:47104
  buffer_store_dwordx4 v[228:231], v19, s[4:7], s28 offen offset:512 sc1
  s_waitcnt vmcnt(21)
  s_barrier
  v_mfma_f32_32x32x16_bf16 v[128:143], v[188:191], a[20:23], v[128:143]
  ds_read_b128 v[188:191], v2 offset:48128
  v_max_f32 v96, 0, v96
  v_mul_f32 v100, v217, v100
  v_max_f32 v97, 0, v97
  v_mul_f32 v101, v217, v101
  v_max_f32 v98, 0, v98
  s_waitcnt lgkmcnt(6)
  v_mfma_f32_32x32x16_bf16 v[144:159], v[192:195], a[20:23], v[144:159]
  ds_read_b128 v[192:195], v2 offset:49152
  v_mul_f32 v102, v217, v102
  v_max_f32 v99, 0, v99
  v_mul_f32 v103, v217, v103
  v_mul_f32 v96, v96, v100
  v_mul_f32 v97, v97, v101
  v_mfma_f32_32x32x16_bf16 v[160:175], v[196:199], a[20:23], v[160:175]
  ds_read_b128 v[196:199], v2 offset:50176
  v_mul_f32 v98, v98, v102
  v_mul_f32 v99, v99, v103
  v_cvt_pk_bf16_f32 v232, v96, v97
  v_cvt_pk_bf16_f32 v233, v98, v99
  v_max_f32 v104, 0, v104
  s_waitcnt lgkmcnt(6)
  v_mfma_f32_32x32x16_bf16 v[128:143], v[200:203], a[24:27], v[128:143]
  ds_read_b128 v[200:203], v2 offset:51200
  v_mul_f32 v108, v217, v108
  v_max_f32 v105, 0, v105
  v_mul_f32 v109, v217, v109
  v_max_f32 v106, 0, v106
  v_mul_f32 v110, v217, v110
  v_mfma_f32_32x32x16_bf16 v[144:159], v[204:207], a[24:27], v[144:159]
  ds_read_b128 v[204:207], v2 offset:52224
  v_max_f32 v107, 0, v107
  v_mul_f32 v111, v217, v111
  v_mul_f32 v104, v104, v108
  v_mul_f32 v105, v105, v109
  v_mul_f32 v106, v106, v110
  s_waitcnt lgkmcnt(6)
  v_mfma_f32_32x32x16_bf16 v[160:175], v[176:179], a[24:27], v[160:175]
  ds_read_b128 v[176:179], v2 offset:53248
  v_mul_f32 v107, v107, v111
  v_cvt_pk_bf16_f32 v234, v104, v105
  v_cvt_pk_bf16_f32 v235, v106, v107
  v_mfma_f32_32x32x16_bf16 v[128:143], v[180:183], a[28:31], v[128:143]
  ds_read_b128 v[180:183], v2 offset:54272
  buffer_load_dwordx4 v2, s[4:7], s37 offen offset:1024 sc1 lds
  s_waitcnt lgkmcnt(6)
  v_mfma_f32_32x32x16_bf16 v[144:159], v[184:187], a[28:31], v[144:159]
  ds_read_b128 v[184:187], v2 offset:55296
  buffer_store_dwordx4 v[232:235], v19, s[4:7], s28 offen offset:1024 sc1
  v_mfma_f32_32x32x16_bf16 v[160:175], v[188:191], a[28:31], v[160:175]
  ds_read_b128 v[188:191], v2 offset:56320
  v_max_f32 v112, 0, v112
  v_mul_f32 v116, v217, v116
  v_max_f32 v113, 0, v113
  v_mul_f32 v117, v217, v117
  v_max_f32 v114, 0, v114
  s_waitcnt lgkmcnt(6)
  v_mfma_f32_32x32x16_bf16 v[128:143], v[192:195], a[32:35], v[128:143]
  ds_read_b128 v[192:195], v2 offset:57344
  buffer_load_dwordx4 v2, s[4:7], s37 offen offset:2048 sc1 lds
  v_mul_f32 v118, v217, v118
  v_max_f32 v115, 0, v115
  v_mfma_f32_32x32x16_bf16 v[144:159], v[196:199], a[32:35], v[144:159]
  ds_read_b128 v[196:199], v2 offset:58368
  v_mul_f32 v119, v217, v119
  v_mul_f32 v112, v112, v116
  v_mul_f32 v113, v113, v117
  v_mul_f32 v114, v114, v118
  v_mul_f32 v115, v115, v119
  s_waitcnt lgkmcnt(6)
  v_mfma_f32_32x32x16_bf16 v[160:175], v[200:203], a[32:35], v[160:175]
  ds_read_b128 v[200:203], v2 offset:59392
  v_cvt_pk_bf16_f32 v224, v112, v113
  v_cvt_pk_bf16_f32 v225, v114, v115
  v_max_f32 v120, 0, v120
  v_mul_f32 v124, v217, v124
  v_max_f32 v121, 0, v121
  s_waitcnt vmcnt(21)
  s_barrier
  v_mfma_f32_32x32x16_bf16 v[128:143], v[204:207], a[36:39], v[128:143]
  ds_read_b128 v[204:207], v2 offset:60416
  s_mul_i32 s36, s22, 5120
  s_add_u32 s37, s36, s52
  s_add_u32 s37, s37, 0
  s_add_u32 m0, s36, 0
  s_waitcnt lgkmcnt(6)
  v_mfma_f32_32x32x16_bf16 v[144:159], v[176:179], a[36:39], v[144:159]
  ds_read_b128 v[176:179], v2 offset:61440
  buffer_load_dwordx4 v2, s[4:7], s37 offen offset:0 sc1 lds
  v_mul_f32 v125, v217, v125
  v_max_f32 v122, 0, v122
  v_mfma_f32_32x32x16_bf16 v[160:175], v[180:183], a[36:39], v[160:175]
  ds_read_b128 v[180:183], v2 offset:62464
  v_mul_f32 v126, v217, v126
  v_max_f32 v123, 0, v123
  v_mul_f32 v127, v217, v127
  v_mul_f32 v120, v120, v124
  v_mul_f32 v121, v121, v125
  s_waitcnt lgkmcnt(6)
  v_mfma_f32_32x32x16_bf16 v[128:143], v[184:187], a[40:43], v[128:143]
  ds_read_b128 v[184:187], v2 offset:63488
  buffer_load_dwordx4 v2, s[4:7], s37 offen offset:1024 sc1 lds
  v_mfma_f32_32x32x16_bf16 v[144:159], v[188:191], a[40:43], v[144:159]
  ds_read_b128 v[188:191], v2 offset:64512
  buffer_load_dwordx4 v2, s[4:7], s37 offen offset:2048 sc1 lds
  v_mul_f32 v122, v122, v126
  v_mul_f32 v123, v123, v127
  s_waitcnt lgkmcnt(6)
  v_mfma_f32_32x32x16_bf16 v[160:175], v[192:195], a[40:43], v[160:175]
  ds_read_b128 v[192:195], v30 offset:0
  v_cvt_pk_bf16_f32 v226, v120, v121
  v_cvt_pk_bf16_f32 v227, v122, v123
  v_mfma_f32_32x32x16_bf16 v[128:143], v[196:199], a[44:47], v[128:143]
  ds_read_b128 v[196:199], v30 offset:1024
  buffer_load_dwordx4 v2, s[4:7], s37 offen offset:3072 sc1 lds
  s_waitcnt lgkmcnt(6)
  v_mfma_f32_32x32x16_bf16 v[144:159], v[200:203], a[44:47], v[144:159]
  ds_read_b128 v[200:203], v30 offset:2048
  buffer_store_dwordx4 v[224:227], v19, s[4:7], s29 offen offset:1536 sc1
  v_mfma_f32_32x32x16_bf16 v[160:175], v[204:207], a[44:47], v[160:175]
  ds_read_b128 v[204:207], v30 offset:3072
  s_waitcnt lgkmcnt(6)
  v_mfma_f32_32x32x16_bf16 v[128:143], v[176:179], a[48:51], v[128:143]
  ds_read_b128 v[176:179], v30 offset:4096
  s_add_u32 s37, s37, 4096
  s_add_u32 m0, m0, 4096
  v_mfma_f32_32x32x16_bf16 v[144:159], v[180:183], a[48:51], v[144:159]
  ds_read_b128 v[180:183], v30 offset:5120
  buffer_load_dwordx4 v2, s[4:7], s37 offen offset:0 sc1 lds
  s_waitcnt lgkmcnt(6)
  v_mfma_f32_32x32x16_bf16 v[160:175], v[184:187], a[48:51], v[160:175]
  ds_read_b128 v[184:187], v30 offset:6144
  s_waitcnt vmcnt(24)
  s_barrier
  v_mfma_f32_32x32x16_bf16 v[128:143], v[188:191], a[52:55], v[128:143]
  ds_read_b128 v[188:191], v30 offset:7168
  s_mul_i32 s36, s22, 5120
  s_add_u32 s37, s36, s52
  s_add_u32 s37, s37, 20480
  s_add_u32 m0, s36, 20480
  s_waitcnt lgkmcnt(6)
  v_mfma_f32_32x32x16_bf16 v[144:159], v[192:195], a[52:55], v[144:159]
  ds_read_b128 v[192:195], v30 offset:8192
  buffer_load_dwordx4 v2, s[4:7], s37 offen offset:0 sc1 lds
  v_mfma_f32_32x32x16_bf16 v[160:175], v[196:199], a[52:55], v[160:175]
  ds_read_b128 v[196:199], v30 offset:9216
  buffer_load_dwordx4 v2, s[4:7], s37 offen offset:1024 sc1 lds
  s_waitcnt lgkmcnt(6)
  v_mfma_f32_32x32x16_bf16 v[128:143], v[200:203], a[56:59], v[128:143]
  ds_read_b128 v[200:203], v30 offset:10240
  buffer_load_dwordx4 v2, s[4:7], s37 offen offset:2048 sc1 lds
  v_mfma_f32_32x32x16_bf16 v[144:159], v[204:207], a[56:59], v[144:159]
  ds_read_b128 v[204:207], v30 offset:11264
  s_waitcnt lgkmcnt(6)
  v_mfma_f32_32x32x16_bf16 v[160:175], v[176:179], a[56:59], v[160:175]
  ds_read_b128 v[176:179], v30 offset:12288
  v_mfma_f32_32x32x16_bf16 v[128:143], v[180:183], a[60:63], v[128:143]
  ds_read_b128 v[180:183], v30 offset:13312
  buffer_load_dwordx4 v2, s[4:7], s37 offen offset:3072 sc1 lds
  s_waitcnt lgkmcnt(6)
  v_mfma_f32_32x32x16_bf16 v[144:159], v[184:187], a[60:63], v[144:159]
  ds_read_b128 v[184:187], v30 offset:14336
  v_mfma_f32_32x32x16_bf16 v[160:175], v[188:191], a[60:63], v[160:175]
  ds_read_b128 v[188:191], v30 offset:15360
  s_waitcnt lgkmcnt(6)
  v_mfma_f32_32x32x16_bf16 v[128:143], v[192:195], a[64:67], v[128:143]
  ds_read_b128 v[192:195], v30 offset:16384
  s_add_u32 s37, s37, 4096
  s_add_u32 m0, m0, 4096
  v_mfma_f32_32x32x16_bf16 v[144:159], v[196:199], a[64:67], v[144:159]
  ds_read_b128 v[196:199], v30 offset:17408
  buffer_load_dwordx4 v2, s[4:7], s37 offen offset:0 sc1 lds
  s_mul_i32 s36, s22, 5120
  s_waitcnt lgkmcnt(6)
  v_mfma_f32_32x32x16_bf16 v[160:175], v[200:203], a[64:67], v[160:175]
  ds_read_b128 v[200:203], v30 offset:18432
  s_add_u32 s37, s36, s52
  s_add_u32 s37, s37, 40960
  s_add_u32 m0, s36, 40960
  s_waitcnt vmcnt(26)
  s_waitcnt vmcnt(6)
  s_barrier
  s_add_u32 s41, s41, 16
  s_cmp_lg_u32 s22, 0
  s_cbranch_scc1 sg_43
  s_mov_b64 exec, 1
  v_mov_b32 v252, 1
  s_and_b32 s3, s21, 0
  s_lshl_b32 s3, s3, 7
  buffer_atomic_add v252, v20, s[4:7], s3 offen sc1
  s_mov_b64 exec, -1
sg_43:
  v_mfma_f32_32x32x16_bf16 v[128:143], v[204:207], a[68:71], v[128:143]
  ds_read_b128 v[204:207], v30 offset:19456
  buffer_load_dwordx4 v2, s[4:7], s37 offen offset:0 sc1 lds
  s_waitcnt lgkmcnt(6)
  v_mfma_f32_32x32x16_bf16 v[144:159], v[176:179], a[68:71], v[144:159]
  ds_read_b128 v[176:179], v30 offset:20480
  buffer_load_dwordx4 v2, s[4:7], s37 offen offset:1024 sc1 lds
  v_mfma_f32_32x32x16_bf16 v[160:175], v[180:183], a[68:71], v[160:175]
  ds_read_b128 v[180:183], v30 offset:21504
  s_waitcnt lgkmcnt(6)
  v_mfma_f32_32x32x16_bf16 v[128:143], v[184:187], a[72:75], v[128:143]
  ds_read_b128 v[184:187], v30 offset:22528
  buffer_load_dwordx4 v2, s[4:7], s37 offen offset:2048 sc1 lds
  v_mfma_f32_32x32x16_bf16 v[144:159], v[188:191], a[72:75], v[144:159]
  ds_read_b128 v[188:191], v30 offset:23552
  s_waitcnt lgkmcnt(6)
  v_mfma_f32_32x32x16_bf16 v[160:175], v[192:195], a[72:75], v[160:175]
  ds_read_b128 v[192:195], v30 offset:24576
  v_mfma_f32_32x32x16_bf16 v[128:143], v[196:199], a[76:79], v[128:143]
  ds_read_b128 v[196:199], v30 offset:25600
  buffer_load_dwordx4 v2, s[4:7], s37 offen offset:3072 sc1 lds
  s_waitcnt lgkmcnt(6)
  v_mfma_f32_32x32x16_bf16 v[144:159], v[200:203], a[76:79], v[144:159]
  ds_read_b128 v[200:203], v30 offset:26624
  v_mfma_f32_32x32x16_bf16 v[160:175], v[204:207], a[76:79], v[160:175]
  ds_read_b128 v[204:207], v30 offset:27648
  s_waitcnt lgkmcnt(6)
  v_mfma_f32_32x32x16_bf16 v[128:143], v[176:179], a[80:83], v[128:143]
  ds_read_b128 v[176:179], v30 offset:28672
  s_add_u32 s37, s37, 4096
  s_add_u32 m0, m0, 4096
  v_mfma_f32_32x32x16_bf16 v[144:159], v[180:183], a[80:83], v[144:159]
  ds_read_b128 v[180:183], v30 offset:29696
  buffer_load_dwordx4 v2, s[4:7], s37 offen offset:0 sc1 lds
  s_waitcnt lgkmcnt(6)
  v_mfma_f32_32x32x16_bf16 v[160:175], v[184:187], a[80:83], v[160:175]
  ds_read_b128 v[184:187], v30 offset:30720
  s_barrier
  v_mfma_f32_32x32x16_bf16 v[128:143], v[188:191], a[84:87], v[128:143]
  ds_read_b128 v[188:191], v30 offset:31744
  s_mul_i32 s36, s22, 5120
  s_add_u32 s37, s36, s52
  s_add_u32 s37, s37, 61440
  s_add_u32 m0, s36, 61440
  s_waitcnt lgkmcnt(6)
  v_mfma_f32_32x32x16_bf16 v[144:159], v[192:195], a[84:87], v[144:159]
  ds_read_b128 v[192:195], v30 offset:32768
  buffer_load_dwordx4 v2, s[4:7], s37 offen offset:0 sc1 lds
  v_mfma_f32_32x32x16_bf16 v[160:175], v[196:199], a[84:87], v[160:175]
  ds_read_b128 v[196:199], v30 offset:33792
  buffer_load_dwordx4 v2, s[4:7], s37 offen offset:1024 sc1 lds
  s_waitcnt lgkmcnt(6)
  v_mfma_f32_32x32x16_bf16 v[128:143], v[200:203], a[88:91], v[128:143]
  ds_read_b128 v[200:203], v30 offset:34816
  buffer_load_dwordx4 v2, s[4:7], s37 offen offset:2048 sc1 lds
  v_mfma_f32_32x32x16_bf16 v[144:159], v[204:207], a[88:91], v[144:159]
  ds_read_b128 v[204:207], v30 offset:35840
  s_waitcnt lgkmcnt(6)
  v_mfma_f32_32x32x16_bf16 v[160:175], v[176:179], a[88:91], v[160:175]
  ds_read_b128 v[176:179], v30 offset:36864
  v_mfma_f32_32x32x16_bf16 v[128:143], v[180:183], a[92:95], v[128:143]
  ds_read_b128 v[180:183], v30 offset:37888
  buffer_load_dwordx4 v2, s[4:7], s37 offen offset:3072 sc1 lds
  s_waitcnt lgkmcnt(6)
  v_mfma_f32_32x32x16_bf16 v[144:159], v[184:187], a[92:95], v[144:159]
  ds_read_b128 v[184:187], v30 offset:38912
  v_mfma_f32_32x32x16_bf16 v[160:175], v[188:191], a[92:95], v[160:175]
  ds_read_b128 v[188:191], v30 offset:39936
  s_waitcnt lgkmcnt(6)
  v_mfma_f32_32x32x16_bf16 v[128:143], v[192:195], a[96:99], v[128:143]
  ds_read_b128 v[192:195], v30 offset:40960
  s_add_u32 s37, s37, 4096
  s_add_u32 m0, m0, 4096
  v_mfma_f32_32x32x16_bf16 v[144:159], v[196:199], a[96:99], v[144:159]
  ds_read_b128 v[196:199], v30 offset:41984
  buffer_load_dwordx4 v2, s[4:7], s37 offen offset:0 sc1 lds
  s_waitcnt lgkmcnt(6)
  v_mfma_f32_32x32x16_bf16 v[160:175], v[200:203], a[96:99], v[160:175]
  ds_read_b128 v[200:203], v30 offset:43008
  s_barrier
  v_mfma_f32_32x32x16_bf16 v[128:143], v[204:207], a[100:103], v[128:143]
  ds_read_b128 v[204:207], v30 offset:44032
  s_waitcnt lgkmcnt(6)
  v_mfma_f32_32x32x16_bf16 v[144:159], v[176:179], a[100:103], v[144:159]
  ds_read_b128 v[176:179], v30 offset:45056
  v_mfma_f32_32x32x16_bf16 v[160:175], v[180:183], a[100:103], v[160:175]
  ds_read_b128 v[180:183], v30 offset:46080
  s_waitcnt lgkmcnt(6)
  v_mfma_f32_32x32x16_bf16 v[128:143], v[184:187], a[104:107], v[128:143]
  ds_read_b128 v[184:187], v30 offset:47104
  v_mfma_f32_32x32x16_bf16 v[144:159], v[188:191], a[104:107], v[144:159]
  ds_read_b128 v[188:191], v30 offset:48128
  s_waitcnt lgkmcnt(6)
  v_mfma_f32_32x32x16_bf16 v[160:175], v[192:195], a[104:107], v[160:175]
  ds_read_b128 v[192:195], v30 offset:49152
  v_mfma_f32_32x32x16_bf16 v[128:143], v[196:199], a[108:111], v[128:143]
  ds_read_b128 v[196:199], v30 offset:50176
  s_waitcnt lgkmcnt(6)
  v_mfma_f32_32x32x16_bf16 v[144:159], v[200:203], a[108:111], v[144:159]
  ds_read_b128 v[200:203], v30 offset:51200
  v_mfma_f32_32x32x16_bf16 v[160:175], v[204:207], a[108:111], v[160:175]
  ds_read_b128 v[204:207], v30 offset:52224
  s_waitcnt lgkmcnt(6)
  v_mfma_f32_32x32x16_bf16 v[128:143], v[176:179], a[112:115], v[128:143]
  ds_read_b128 v[176:179], v30 offset:53248
  v_mfma_f32_32x32x16_bf16 v[144:159], v[180:183], a[112:115], v[144:159]
  ds_read_b128 v[180:183], v30 offset:54272
  s_waitcnt lgkmcnt(6)
  v_mfma_f32_32x32x16_bf16 v[160:175], v[184:187], a[112:115], v[160:175]
  ds_read_b128 v[184:187], v30 offset:55296
  s_barrier
  v_mfma_f32_32x32x16_bf16 v[128:143], v[188:191], a[116:119], v[128:143]
  ds_read_b128 v[188:191], v30 offset:56320
  s_mul_i32 s36, s22, 5120
  s_add_u32 s37, s36, s52
  s_add_u32 s37, s37, 81920
  s_add_u32 m0, s36, 81920
  s_waitcnt lgkmcnt(6)
  v_mfma_f32_32x32x16_bf16 v[144:159], v[192:195], a[116:119], v[144:159]
  ds_read_b128 v[192:195], v30 offset:57344
  buffer_load_dwordx4 v2, s[4:7], s37 offen offset:0 sc1 lds
  v_mfma_f32_32x32x16_bf16 v[160:175], v[196:199], a[116:119], v[160:175]
  ds_read_b128 v[196:199], v30 offset:58368
  buffer_load_dwordx4 v2, s[4:7], s37 offen offset:1024 sc1 lds
  s_waitcnt lgkmcnt(6)
  v_mfma_f32_32x32x16_bf16 v[128:143], v[200:203], a[120:123], v[128:143]
  ds_read_b128 v[200:203], v30 offset:59392
  buffer_load_dwordx4 v2, s[4:7], s37 offen offset:2048 sc1 lds
  v_mfma_f32_32x32x16_bf16 v[144:159], v[204:207], a[120:123], v[144:159]
  ds_read_b128 v[204:207], v30 offset:60416
  s_waitcnt lgkmcnt(6)
  v_mfma_f32_32x32x16_bf16 v[160:175], v[176:179], a[120:123], v[160:175]
  ds_read_b128 v[176:179], v30 offset:61440
  v_mfma_f32_32x32x16_bf16 v[128:143], v[180:183], a[124:127], v[128:143]
  ds_read_b128 v[180:183], v30 offset:62464
  buffer_load_dwordx4 v2, s[4:7], s37 offen offset:3072 sc1 lds
  s_waitcnt lgkmcnt(6)
  v_mfma_f32_32x32x16_bf16 v[144:159], v[184:187], a[124:127], v[144:159]
  ds_read_b128 v[184:187], v30 offset:63488
  v_mfma_f32_32x32x16_bf16 v[160:175], v[188:191], a[124:127], v[160:175]
  ds_read_b128 v[188:191], v30 offset:64512
  s_waitcnt lgkmcnt(6)
  v_mfma_f32_32x32x16_bf16 v[128:143], v[192:195], a[128:131], v[128:143]
  ds_read_b128 v[192:195], v31 offset:0
  s_add_u32 s37, s37, 4096
  s_add_u32 m0, m0, 4096
  v_mfma_f32_32x32x16_bf16 v[144:159], v[196:199], a[128:131], v[144:159]
  ds_read_b128 v[196:199], v31 offset:1024
  buffer_load_dwordx4 v2, s[4:7], s37 offen offset:0 sc1 lds
  s_waitcnt lgkmcnt(6)
  v_mfma_f32_32x32x16_bf16 v[160:175], v[200:203], a[128:131], v[160:175]
  ds_read_b128 v[200:203], v31 offset:2048
  s_barrier
  v_mfma_f32_32x32x16_bf16 v[128:143], v[204:207], a[132:135], v[128:143]
  ds_read_b128 v[204:207], v31 offset:3072
  s_mov_b64 exec, 1
  buffer_load_dword v253, v20, s[4:7], 0 offen sc1
  s_mov_b64 exec, -1
  s_waitcnt lgkmcnt(6)
  v_mfma_f32_32x32x16_bf16 v[144:159], v[176:179], a[132:135], v[144:159]
  ds_read_b128 v[176:179], v31 offset:4096
  s_mul_i32 s36, s22, 5120
  s_add_u32 s37, s36, s52
  s_add_u32 s37, s37, 102400
  s_add_u32 m0, s36, 102400
  v_mfma_f32_32x32x16_bf16 v[160:175], v[180:183], a[132:135], v[160:175]
  ds_read_b128 v[180:183], v31 offset:5120
  buffer_load_dwordx4 v2, s[4:7], s37 offen offset:0 sc1 lds
  s_waitcnt lgkmcnt(6)
  v_mfma_f32_32x32x16_bf16 v[128:143], v[184:187], a[136:139], v[128:143]
  ds_read_b128 v[184:187], v31 offset:6144
  buffer_load_dwordx4 v2, s[4:7], s37 offen offset:1024 sc1 lds
  v_mfma_f32_32x32x16_bf16 v[144:159], v[188:191], a[136:139], v[144:159]
  ds_read_b128 v[188:191], v31 offset:7168
  buffer_load_dwordx4 v2, s[4:7], s37 offen offset:2048 sc1 lds
  s_waitcnt lgkmcnt(6)
  v_mfma_f32_32x32x16_bf16 v[160:175], v[192:195], a[136:139], v[160:175]
  ds_read_b128 v[192:195], v31 offset:8192
  v_mfma_f32_32x32x16_bf16 v[128:143], v[196:199], a[140:143], v[128:143]
  ds_read_b128 v[196:199], v31 offset:9216
  buffer_load_dwordx4 v2, s[4:7], s37 offen offset:3072 sc1 lds
  s_waitcnt lgkmcnt(6)
  v_mfma_f32_32x32x16_bf16 v[144:159], v[200:203], a[140:143], v[144:159]
  ds_read_b128 v[200:203], v31 offset:10240
  v_mfma_f32_32x32x16_bf16 v[160:175], v[204:207], a[140:143], v[160:175]
  ds_read_b128 v[204:207], v31 offset:11264
  s_waitcnt lgkmcnt(6)
  v_mfma_f32_32x32x16_bf16 v[128:143], v[176:179], a[144:147], v[128:143]
  ds_read_b128 v[176:179], v31 offset:12288
  s_add_u32 s37, s37, 4096
  s_add_u32 m0, m0, 4096
  v_mfma_f32_32x32x16_bf16 v[144:159], v[180:183], a[144:147], v[144:159]
  ds_read_b128 v[180:183], v31 offset:13312
  buffer_load_dwordx4 v2, s[4:7], s37 offen offset:0 sc1 lds
  s_waitcnt lgkmcnt(6)
  v_mfma_f32_32x32x16_bf16 v[160:175], v[184:187], a[144:147], v[160:175]
  ds_read_b128 v[184:187], v31 offset:14336
  s_waitcnt vmcnt(5)
  s_mov_b64 exec, 1
  v_cmp_gt_u32 vcc, s41, v253
  s_cbranch_vccz fc_44
  s_mov_b32 s30, 20000
  buffer_load_dword v254, v20, s[4:7], 0 offen sc1
poll_45:
  s_sleep 5
  buffer_load_dword v255, v20, s[4:7], 0 offen sc1
  s_waitcnt vmcnt(1)
  v_cmp_gt_u32 vcc, s41, v254
  s_cbranch_vccz pdone_46
  s_sleep 5
  buffer_load_dword v254, v20, s[4:7], 0 offen sc1
  s_waitcnt vmcnt(1)
  v_cmp_gt_u32 vcc, s41, v255
  s_cbranch_vccz pdone_46
  s_sub_u32 s30, s30, 1
  s_cmp_lg_u32 s30, 0
  s_cbranch_scc1 poll_45
  s_waitcnt vmcnt(0)
  v_mov_b32 v254, 1024
  v_mov_b32 v255, 128
  buffer_store_dword v254, v255, s[16:19], 0 offen
pdone_46:
fc_44:
  s_mov_b64 exec, -1
  v_mfma_f32_32x32x16_bf16 v[128:143], v[188:191], a[148:151], v[128:143]
  ds_read_b128 v[188:191], v31 offset:15360
  s_mul_i32 s32, s45, 55296
  s_add_u32 s32, s32, s40
  s_lshl_b32 s3, s27, 10
  s_add_u32 s32, s32, s3
  s_add_u32 s32, s32, 7864320
  s_waitcnt lgkmcnt(6)
  v_mfma_f32_32x32x16_bf16 v[144:159], v[192:195], a[148:151], v[144:159]
  ds_read_b128 v[192:195], v31 offset:24576
  s_mul_i32 s33, s46, 55296
  s_add_u32 s33, s33, s40
  s_lshl_b32 s3, s27, 10
  s_add_u32 s33, s33, s3
  s_add_u32 s33, s33, 7864320
  v_mfma_f32_32x32x16_bf16 v[160:175], v[196:199], a[148:151], v[160:175]
  ds_read_b128 v[196:199], v31 offset:25600
  buffer_load_dwordx4 a[0:3], v2, s[4:7], s32 offen offset:0 sc1
  s_waitcnt lgkmcnt(6)
  v_mfma_f32_32x32x16_bf16 v[128:143], v[200:203], a[152:155], v[128:143]
  ds_read_b128 v[200:203], v31 offset:26624
  buffer_load_dwordx4 a[4:7], v2, s[4:7], s33 offen offset:0 sc1
  v_mfma_f32_32x32x16_bf16 v[144:159], v[204:207], a[152:155], v[144:159]
  buffer_load_dwordx4 a[8:11], v2, s[4:7], s32 offen offset:2048 sc1
  s_waitcnt lgkmcnt(5)
  v_mfma_f32_32x32x16_bf16 v[160:175], v[176:179], a[152:155], v[160:175]
  buffer_load_dwordx4 a[12:15], v2, s[4:7], s33 offen offset:2048 sc1
  s_add_u32 s32, s32, 4096
  v_mfma_f32_32x32x16_bf16 v[128:143], v[180:183], a[156:159], v[128:143]
  s_add_u32 s33, s33, 4096
  buffer_load_dwordx4 a[16:19], v2, s[4:7], s32 offen offset:0 sc1
  s_waitcnt lgkmcnt(3)
  v_mfma_f32_32x32x16_bf16 v[144:159], v[184:187], a[156:159], v[144:159]
  buffer_load_dwordx4 a[20:23], v2, s[4:7], s33 offen offset:0 sc1
  v_mfma_f32_32x32x16_bf16 v[160:175], v[188:191], a[156:159], v[160:175]
  buffer_load_dwordx4 a[24:27], v2, s[4:7], s32 offen offset:2048 sc1
  s_waitcnt lgkmcnt(1)
  v_mfma_f32_32x32x16_bf16 v[128:143], v[192:195], v[220:223], v[128:143]
  buffer_load_dwordx4 a[28:31], v2, s[4:7], s33 offen offset:2048 sc1
  v_mfma_f32_32x32x16_bf16 v[144:159], v[196:199], v[220:223], v[144:159]
  s_waitcnt lgkmcnt(0)
  v_mfma_f32_32x32x16_bf16 v[160:175], v[200:203], v[220:223], v[160:175]
  s_nop 7
  v_max_f32 v128, 0, v128
  v_mul_f32 v132, v217, v132
  v_max_f32 v129, 0, v129
  v_mul_f32 v133, v217, v133
  v_max_f32 v130, 0, v130
  v_mul_f32 v134, v217, v134
  v_max_f32 v131, 0, v131
  v_mul_f32 v135, v217, v135
  v_mul_f32 v128, v128, v132
  v_mul_f32 v129, v129, v133
  v_mul_f32 v130, v130, v134
  v_mul_f32 v131, v131, v135
  v_cvt_pk_bf16_f32 v228, v128, v129
  v_cvt_pk_bf16_f32 v229, v130, v131
  v_max_f32 v136, 0, v136
  v_mul_f32 v140, v217, v140
  v_max_f32 v137, 0, v137
  v_mul_f32 v141, v217, v141
  v_max_f32 v138, 0, v138
  v_mul_f32 v142, v217, v142
  v_max_f32 v139, 0, v139
  v_mul_f32 v143, v217, v143
  v_mul_f32 v136, v136, v140
  v_mul_f32 v137, v137, v141
  v_mul_f32 v138, v138, v142
  v_mul_f32 v139, v139, v143
  v_cvt_pk_bf16_f32 v230, v136, v137
  v_cvt_pk_bf16_f32 v231, v138, v139
  buffer_store_dwordx4 v[228:231], v19, s[4:7], s31 offen offset:0 sc1
  v_max_f32 v144, 0, v144
  v_mul_f32 v148, v217, v148
  v_max_f32 v145, 0, v145
  v_mul_f32 v149, v217, v149
  v_max_f32 v146, 0, v146
  v_mul_f32 v150, v217, v150
  v_max_f32 v147, 0, v147
  v_mul_f32 v151, v217, v151
  v_mul_f32 v144, v144, v148
  v_mul_f32 v145, v145, v149
  v_mul_f32 v146, v146, v150
  v_mul_f32 v147, v147, v151
  v_cvt_pk_bf16_f32 v232, v144, v145
  v_cvt_pk_bf16_f32 v233, v146, v147
  v_max_f32 v152, 0, v152
  v_mul_f32 v156, v217, v156
  v_max_f32 v153, 0, v153
  v_mul_f32 v157, v217, v157
  v_max_f32 v154, 0, v154
  v_mul_f32 v158, v217, v158
  v_max_f32 v155, 0, v155
  v_mul_f32 v159, v217, v159
  v_mul_f32 v152, v152, v156
  v_mul_f32 v153, v153, v157
  v_mul_f32 v154, v154, v158
  v_mul_f32 v155, v155, v159
  v_cvt_pk_bf16_f32 v234, v152, v153
  v_cvt_pk_bf16_f32 v235, v154, v155
  buffer_store_dwordx4 v[232:235], v19, s[4:7], s31 offen offset:512 sc1
  v_max_f32 v160, 0, v160
  v_mul_f32 v164, v217, v164
  v_max_f32 v161, 0, v161
  v_mul_f32 v165, v217, v165
  v_max_f32 v162, 0, v162
  v_mul_f32 v166, v217, v166
  v_max_f32 v163, 0, v163
  v_mul_f32 v167, v217, v167
  v_mul_f32 v160, v160, v164
  v_mul_f32 v161, v161, v165
  v_mul_f32 v162, v162, v166
  v_mul_f32 v163, v163, v167
  v_cvt_pk_bf16_f32 v224, v160, v161
  v_cvt_pk_bf16_f32 v225, v162, v163
  v_max_f32 v168, 0, v168
  v_mul_f32 v172, v217, v172
  v_max_f32 v169, 0, v169
  v_mul_f32 v173, v217, v173
  v_max_f32 v170, 0, v170
  v_mul_f32 v174, v217, v174
  v_max_f32 v171, 0, v171
  v_mul_f32 v175, v217, v175
  v_mul_f32 v168, v168, v172
  v_mul_f32 v169, v169, v173
  v_mul_f32 v170, v170, v174
  v_mul_f32 v171, v171, v175
  v_cvt_pk_bf16_f32 v226, v168, v169
  v_cvt_pk_bf16_f32 v227, v170, v171
  buffer_store_dwordx4 v[224:227], v19, s[4:7], s31 offen offset:1024 sc1
  s_mul_i32 s35, s27, 10240
  v_add_u32 v124, s35, v2
  v_add_u32 v125, s35, v30
  v_add_u32 v126, s35, v31
  v_lshlrev_b32 v64, 16, v4
  v_and_b32 v65, 0xffff0000, v4
  v_lshlrev_b32 v66, 16, v5
  v_and_b32 v67, 0xffff0000, v5
  v_lshlrev_b32 v68, 16, v6
  v_and_b32 v69, 0xffff0000, v6
  v_lshlrev_b32 v70, 16, v7
  v_and_b32 v71, 0xffff0000, v7
  v_lshlrev_b32 v72, 16, v8
  v_and_b32 v73, 0xffff0000, v8
  v_lshlrev_b32 v74, 16, v9
  v_and_b32 v75, 0xffff0000, v9
  v_lshlrev_b32 v76, 16, v10
  v_and_b32 v77, 0xffff0000, v10
  v_lshlrev_b32 v78, 16, v11
  v_and_b32 v79, 0xffff0000, v11
  v_lshlrev_b32 v80, 16, v12
  v_and_b32 v81, 0xffff0000, v12
  v_lshlrev_b32 v82, 16, v13
  v_and_b32 v83, 0xffff0000, v13
  s_waitcnt vmcnt(9)
  s_barrier
  ds_read_b128 v[104:107], v124 offset:0
  ds_read_b128 v[108:111], v124 offset:1024
  ds_read_b128 v[112:115], v124 offset:2048
  ds_read_b128 v[116:119], v124 offset:3072
  ds_read_b128 v[120:123], v124 offset:4096
  s_waitcnt lgkmcnt(0)
  v_mfma_f32_16x16x32_bf16 v[64:67], v[104:107], a[0:3], v[64:67]
  ds_read_b128 v[176:179], v124 offset:5120
  v_mfma_f32_16x16x32_bf16 v[84:87], v[104:107], a[4:7], 0
  ds_read_b128 v[180:183], v124 offset:6144
  v_mfma_f32_16x16x32_bf16 v[68:71], v[108:111], a[0:3], v[68:71]
  ds_read_b128 v[184:187], v124 offset:7168
  v_mfma_f32_16x16x32_bf16 v[88:91], v[108:111], a[4:7], 0
  ds_read_b128 v[188:191], v124 offset:8192
  v_mfma_f32_16x16x32_bf16 v[72:75], v[112:115], a[0:3], v[72:75]
  ds_read_b128 v[192:195], v124 offset:9216
  s_add_u32 s32, s32, 4096
  s_add_u32 s33, s33, 4096
  v_mfma_f32_16x16x32_bf16 v[92:95], v[112:115], a[4:7], 0
  buffer_load_dwordx4 a[32:35], v2, s[4:7], s32 offen offset:0 sc1
  v_mfma_f32_16x16x32_bf16 v[76:79], v[116:119], a[0:3], v[76:79]
  buffer_load_dwordx4 a[36:39], v2, s[4:7], s33 offen offset:0 sc1
  v_mfma_f32_16x16x32_bf16 v[96:99], v[116:119], a[4:7], 0
  buffer_load_dwordx4 a[40:43], v2, s[4:7], s32 offen offset:2048 sc1
  v_mfma_f32_16x16x32_bf16 v[80:83], v[120:123], a[0:3], v[80:83]
  buffer_load_dwordx4 a[44:47], v2, s[4:7], s33 offen offset:2048 sc1
  v_mfma_f32_16x16x32_bf16 v[100:103], v[120:123], a[4:7], 0
  s_barrier
  s_waitcnt vmcnt(11)
  s_waitcnt lgkmcnt(0)
  v_mfma_f32_16x16x32_bf16 v[64:67], v[176:179], a[8:11], v[64:67]
  ds_read_b128 v[104:107], v124 offset:20480
  v_mfma_f32_16x16x32_bf16 v[84:87], v[176:179], a[12:15], v[84:87]
  ds_read_b128 v[108:111], v124 offset:21504
  v_mfma_f32_16x16x32_bf16 v[68:71], v[180:183], a[8:11], v[68:71]
  ds_read_b128 v[112:115], v124 offset:22528
  v_mfma_f32_16x16x32_bf16 v[88:91], v[180:183], a[12:15], v[88:91]
  ds_read_b128 v[116:119], v124 offset:23552
  v_mfma_f32_16x16x32_bf16 v[72:75], v[184:187], a[8:11], v[72:75]
  ds_read_b128 v[120:123], v124 offset:24576
  s_add_u32 s32, s32, 4096
  s_add_u32 s33, s33, 4096
  v_mfma_f32_16x16x32_bf16 v[92:95], v[184:187], a[12:15], v[92:95]
  buffer_load_dwordx4 a[48:51], v2, s[4:7], s32 offen offset:0 sc1
  v_mfma_f32_16x16x32_bf16 v[76:79], v[188:191], a[8:11], v[76:79]
  buffer_load_dwordx4 a[52:55], v2, s[4:7], s33 offen offset:0 sc1
  v_mfma_f32_16x16x32_bf16 v[96:99], v[188:191], a[12:15], v[96:99]
  buffer_load_dwordx4 a[56:59], v2, s[4:7], s32 offen offset:2048 sc1
  v_mfma_f32_16x16x32_bf16 v[80:83], v[192:195], a[8:11], v[80:83]
  v_mfma_f32_16x16x32_bf16 v[100:103], v[192:195], a[12:15], v[100:103]
  s_waitcnt vmcnt(12)
  s_waitcnt lgkmcnt(0)
  v_mfma_f32_16x16x32_bf16 v[64:67], v[104:107], a[16:19], v[64:67]
  ds_read_b128 v[176:179], v124 offset:25600
  v_mfma_f32_16x16x32_bf16 v[84:87], v[104:107], a[20:23], v[84:87]
  ds_read_b128 v[180:183], v124 offset:26624
  v_mfma_f32_16x16x32_bf16 v[68:71], v[108:111], a[16:19], v[68:71]
  ds_read_b128 v[184:187], v124 offset:27648
  v_mfma_f32_16x16x32_bf16 v[88:91], v[108:111], a[20:23], v[88:91]
  ds_read_b128 v[188:191], v124 offset:28672
  v_mfma_f32_16x16x32_bf16 v[72:75], v[112:115], a[16:19], v[72:75]
  ds_read_b128 v[192:195], v124 offset:29696
  buffer_load_dwordx4 a[60:63], v2, s[4:7], s33 offen offset:2048 sc1
  s_add_u32 s32, s32, 4096
  v_mfma_f32_16x16x32_bf16 v[92:95], v[112:115], a[20:23], v[92:95]
  s_add_u32 s33, s33, 4096
  buffer_load_dwordx4 a[64:67], v2, s[4:7], s32 offen offset:0 sc1
  v_mfma_f32_16x16x32_bf16 v[76:79], v[116:119], a[16:19], v[76:79]
  buffer_load_dwordx4 a[68:71], v2, s[4:7], s33 offen offset:0 sc1
  v_mfma_f32_16x16x32_bf16 v[96:99], v[116:119], a[20:23], v[96:99]
  buffer_load_dwordx4 a[72:75], v2, s[4:7], s32 offen offset:2048 sc1
  v_mfma_f32_16x16x32_bf16 v[80:83], v[120:123], a[16:19], v[80:83]
  v_mfma_f32_16x16x32_bf16 v[100:103], v[120:123], a[20:23], v[100:103]
  s_waitcnt vmcnt(11)
  s_barrier
  s_add_u32 s41, s41, 16
  s_cmp_lg_u32 s22, 0
  s_cbranch_scc1 sg_47
  s_mov_b64 exec, 1
  v_mov_b32 v252, 1
  s_and_b32 s3, s21, 0
  s_lshl_b32 s3, s3, 7
  buffer_atomic_add v252, v20, s[4:7], s3 offen sc1
  s_mov_b64 exec, -1
sg_47:
  s_waitcnt lgkmcnt(0)
  v_mfma_f32_16x16x32_bf16 v[64:67], v[176:179], a[24:27], v[64:67]
  ds_read_b128 v[104:107], v124 offset:40960
  v_mfma_f32_16x16x32_bf16 v[84:87], v[176:179], a[28:31], v[84:87]
  ds_read_b128 v[108:111], v124 offset:41984
  v_mfma_f32_16x16x32_bf16 v[68:71], v[180:183], a[24:27], v[68:71]
  ds_read_b128 v[112:115], v124 offset:43008
  v_mfma_f32_16x16x32_bf16 v[88:91], v[180:183], a[28:31], v[88:91]
  ds_read_b128 v[116:119], v124 offset:44032
  v_mfma_f32_16x16x32_bf16 v[72:75], v[184:187], a[24:27], v[72:75]
  ds_read_b128 v[120:123], v124 offset:45056
  buffer_load_dwordx4 a[76:79], v2, s[4:7], s33 offen offset:2048 sc1
  s_add_u32 s32, s32, 4096
  v_mfma_f32_16x16x32_bf16 v[92:95], v[184:187], a[28:31], v[92:95]
  s_add_u32 s33, s33, 4096
  buffer_load_dwordx4 a[80:83], v2, s[4:7], s32 offen offset:0 sc1
  v_mfma_f32_16x16x32_bf16 v[76:79], v[188:191], a[24:27], v[76:79]
  buffer_load_dwordx4 a[84:87], v2, s[4:7], s33 offen offset:0 sc1
  v_mfma_f32_16x16x32_bf16 v[96:99], v[188:191], a[28:31], v[96:99]
  v_mfma_f32_16x16x32_bf16 v[80:83], v[192:195], a[24:27], v[80:83]
  v_mfma_f32_16x16x32_bf16 v[100:103], v[192:195], a[28:31], v[100:103]
  s_waitcnt vmcnt(12)
  s_waitcnt lgkmcnt(0)
  v_mfma_f32_16x16x32_bf16 v[64:67], v[104:107], a[32:35], v[64:67]
  ds_read_b128 v[176:179], v124 offset:46080
  v_mfma_f32_16x16x32_bf16 v[84:87], v[104:107], a[36:39], v[84:87]
  ds_read_b128 v[180:183], v124 offset:47104
  v_mfma_f32_16x16x32_bf16 v[68:71], v[108:111], a[32:35], v[68:71]
  ds_read_b128 v[184:187], v124 offset:48128
  v_mfma_f32_16x16x32_bf16 v[88:91], v[108:111], a[36:39], v[88:91]
  ds_read_b128 v[188:191], v124 offset:49152
  v_mfma_f32_16x16x32_bf16 v[72:75], v[112:115], a[32:35], v[72:75]
  ds_read_b128 v[192:195], v124 offset:50176
  buffer_load_dwordx4 a[88:91], v2, s[4:7], s32 offen offset:2048 sc1
  v_mfma_f32_16x16x32_bf16 v[92:95], v[112:115], a[36:39], v[92:95]
  buffer_load_dwordx4 a[92:95], v2, s[4:7], s33 offen offset:2048 sc1
  s_mul_i32 s36, s22, 5120
  v_mfma_f32_16x16x32_bf16 v[76:79], v[116:119], a[32:35], v[76:79]
  s_add_u32 s37, s36, s52
  s_add_u32 s37, s37, 122880
  v_mfma_f32_16x16x32_bf16 v[96:99], v[116:119], a[36:39], v[96:99]
  s_add_u32 m0, s36, 122880
  s_nop 0
  buffer_load_dwordx4 v2, s[4:7], s37 offen offset:0 sc1 lds
  v_mfma_f32_16x16x32_bf16 v[80:83], v[120:123], a[32:35], v[80:83]
  buffer_load_dwordx4 v2, s[4:7], s37 offen offset:1024 sc1 lds
  v_mfma_f32_16x16x32_bf16 v[100:103], v[120:123], a[36:39], v[100:103]
  s_barrier
  s_waitcnt vmcnt(14)
  s_waitcnt lgkmcnt(0)
  v_mfma_f32_16x16x32_bf16 v[64:67], v[176:179], a[40:43], v[64:67]
  ds_read_b128 v[104:107], v124 offset:61440
  v_mfma_f32_16x16x32_bf16 v[84:87], v[176:179], a[44:47], v[84:87]
  ds_read_b128 v[108:111], v124 offset:62464
  v_mfma_f32_16x16x32_bf16 v[68:71], v[180:183], a[40:43], v[68:71]
  ds_read_b128 v[112:115], v124 offset:63488
  v_mfma_f32_16x16x32_bf16 v[88:91], v[180:183], a[44:47], v[88:91]
  ds_read_b128 v[116:119], v124 offset:64512
  v_mfma_f32_16x16x32_bf16 v[72:75], v[184:187], a[40:43], v[72:75]
  ds_read_b128 v[120:123], v125 offset:0
  buffer_load_dwordx4 v2, s[4:7], s37 offen offset:2048 sc1 lds
  v_mfma_f32_16x16x32_bf16 v[92:95], v[184:187], a[44:47], v[92:95]
  buffer_load_dwordx4 v2, s[4:7], s37 offen offset:3072 sc1 lds
  s_add_u32 s37, s37, 4096
  v_mfma_f32_16x16x32_bf16 v[76:79], v[188:191], a[40:43], v[76:79]
  s_add_u32 m0, m0, 4096
  s_nop 0
  buffer_load_dwordx4 v2, s[4:7], s37 offen offset:0 sc1 lds
  v_mfma_f32_16x16x32_bf16 v[96:99], v[188:191], a[44:47], v[96:99]
  v_mfma_f32_16x16x32_bf16 v[80:83], v[192:195], a[40:43], v[80:83]
  v_mfma_f32_16x16x32_bf16 v[100:103], v[192:195], a[44:47], v[100:103]
  s_waitcnt vmcnt(15)
  s_waitcnt lgkmcnt(0)
  v_mfma_f32_16x16x32_bf16 v[64:67], v[104:107], a[48:51], v[64:67]
  ds_read_b128 v[176:179], v125 offset:1024
  v_mfma_f32_16x16x32_bf16 v[84:87], v[104:107], a[52:55], v[84:87]
  ds_read_b128 v[180:183], v125 offset:2048
  v_mfma_f32_16x16x32_bf16 v[68:71], v[108:111], a[48:51], v[68:71]
  ds_read_b128 v[184:187], v125 offset:3072
  v_mfma_f32_16x16x32_bf16 v[88:91], v[108:111], a[52:55], v[88:91]
  ds_read_b128 v[188:191], v125 offset:4096
  v_mfma_f32_16x16x32_bf16 v[72:75], v[112:115], a[48:51], v[72:75]
  ds_read_b128 v[192:195], v125 offset:5120
  s_add_u32 s32, s32, 4096
  s_add_u32 s33, s33, 4096
  v_mfma_f32_16x16x32_bf16 v[92:95], v[112:115], a[52:55], v[92:95]
  buffer_load_dwordx4 a[96:99], v2, s[4:7], s32 offen offset:0 sc1
  v_mfma_f32_16x16x32_bf16 v[76:79], v[116:119], a[48:51], v[76:79]
  buffer_load_dwordx4 a[100:103], v2, s[4:7], s33 offen offset:0 sc1
  v_mfma_f32_16x16x32_bf16 v[96:99], v[116:119], a[52:55], v[96:99]
  buffer_load_dwordx4 a[104:107], v2, s[4:7], s32 offen offset:2048 sc1
  v_mfma_f32_16x16x32_bf16 v[80:83], v[120:123], a[48:51], v[80:83]
  buffer_load_dwordx4 a[108:111], v2, s[4:7], s33 offen offset:2048 sc1
  v_mfma_f32_16x16x32_bf16 v[100:103], v[120:123], a[52:55], v[100:103]
  s_barrier
  s_waitcnt vmcnt(17)
  s_waitcnt lgkmcnt(0)
  v_mfma_f32_16x16x32_bf16 v[64:67], v[176:179], a[56:59], v[64:67]
  ds_read_b128 v[104:107], v125 offset:16384
  v_mfma_f32_16x16x32_bf16 v[84:87], v[176:179], a[60:63], v[84:87]
  ds_read_b128 v[108:111], v125 offset:17408
  v_mfma_f32_16x16x32_bf16 v[68:71], v[180:183], a[56:59], v[68:71]
  ds_read_b128 v[112:115], v125 offset:18432
  v_mfma_f32_16x16x32_bf16 v[88:91], v[180:183], a[60:63], v[88:91]
  ds_read_b128 v[116:119], v125 offset:19456
  v_mfma_f32_16x16x32_bf16 v[72:75], v[184:187], a[56:59], v[72:75]
  ds_read_b128 v[120:123], v125 offset:20480
  s_mul_i32 s36, s22, 5120
  s_add_u32 s37, s36, s52
  v_mfma_f32_16x16x32_bf16 v[92:95], v[184:187], a[60:63], v[92:95]
  s_add_u32 s37, s37, 143360
  s_add_u32 m0, s36, 0
  v_mfma_f32_16x16x32_bf16 v[76:79], v[188:191], a[56:59], v[76:79]
  buffer_load_dwordx4 v2, s[4:7], s37 offen offset:0 sc1 lds
  v_mfma_f32_16x16x32_bf16 v[96:99], v[188:191], a[60:63], v[96:99]
  buffer_load_dwordx4 v2, s[4:7], s37 offen offset:1024 sc1 lds
  v_mfma_f32_16x16x32_bf16 v[80:83], v[192:195], a[56:59], v[80:83]
  buffer_load_dwordx4 v2, s[4:7], s37 offen offset:2048 sc1 lds
  v_mfma_f32_16x16x32_bf16 v[100:103], v[192:195], a[60:63], v[100:103]
  s_waitcnt vmcnt(18)
  s_waitcnt lgkmcnt(0)
  v_mfma_f32_16x16x32_bf16 v[64:67], v[104:107], a[64:67], v[64:67]
  ds_read_b128 v[176:179], v125 offset:21504
  v_mfma_f32_16x16x32_bf16 v[84:87], v[104:107], a[68:71], v[84:87]
  ds_read_b128 v[180:183], v125 offset:22528
  v_mfma_f32_16x16x32_bf16 v[68:71], v[108:111], a[64:67], v[68:71]
  ds_read_b128 v[184:187], v125 offset:23552
  v_mfma_f32_16x16x32_bf16 v[88:91], v[108:111], a[68:71], v[88:91]
  ds_read_b128 v[188:191], v125 offset:24576
  v_mfma_f32_16x16x32_bf16 v[72:75], v[112:115], a[64:67], v[72:75]
  ds_read_b128 v[192:195], v125 offset:25600
  s_mov_b64 exec, 1
  buffer_load_dword v253, v20, s[4:7], 0 offen sc1
  s_mov_b64 exec, -1
  v_mfma_f32_16x16x32_bf16 v[92:95], v[112:115], a[68:71], v[92:95]
  buffer_load_dwordx4 v2, s[4:7], s37 offen offset:3072 sc1 lds
  s_add_u32 s37, s37, 4096
  v_mfma_f32_16x16x32_bf16 v[76:79], v[116:119], a[64:67], v[76:79]
  s_add_u32 m0, m0, 4096
  s_nop 0
  buffer_load_dwordx4 v2, s[4:7], s37 offen offset:0 sc1 lds
  v_mfma_f32_16x16x32_bf16 v[96:99], v[116:119], a[68:71], v[96:99]
  s_add_u32 s32, s32, 4096
  s_add_u32 s33, s33, 4096
  v_mfma_f32_16x16x32_bf16 v[80:83], v[120:123], a[64:67], v[80:83]
  buffer_load_dwordx4 a[112:115], v2, s[4:7], s32 offen offset:0 sc1
  v_mfma_f32_16x16x32_bf16 v[100:103], v[120:123], a[68:71], v[100:103]
  buffer_load_dwordx4 a[116:119], v2, s[4:7], s33 offen offset:0 sc1
  s_barrier
  s_waitcnt vmcnt(21)
  s_waitcnt lgkmcnt(0)
  v_mfma_f32_16x16x32_bf16 v[64:67], v[176:179], a[72:75], v[64:67]
  ds_read_b128 v[104:107], v125 offset:36864
  v_mfma_f32_16x16x32_bf16 v[84:87], v[176:179], a[76:79], v[84:87]
  ds_read_b128 v[108:111], v125 offset:37888
  v_mfma_f32_16x16x32_bf16 v[68:71], v[180:183], a[72:75], v[68:71]
  ds_read_b128 v[112:115], v125 offset:38912
  v_mfma_f32_16x16x32_bf16 v[88:91], v[180:183], a[76:79], v[88:91]
  ds_read_b128 v[116:119], v125 offset:39936
  v_mfma_f32_16x16x32_bf16 v[72:75], v[184:187], a[72:75], v[72:75]
  ds_read_b128 v[120:123], v125 offset:40960
  s_mul_i32 s36, s22, 5120
  s_add_u32 s37, s36, s52
  v_mfma_f32_16x16x32_bf16 v[92:95], v[184:187], a[76:79], v[92:95]
  s_add_u32 s37, s37, 163840
  s_add_u32 m0, s36, 20480
  v_mfma_f32_16x16x32_bf16 v[76:79], v[188:191], a[72:75], v[76:79]
  buffer_load_dwordx4 v2, s[4:7], s37 offen offset:0 sc1 lds
  v_mfma_f32_16x16x32_bf16 v[96:99], v[188:191], a[76:79], v[96:99]
  buffer_load_dwordx4 v2, s[4:7], s37 offen offset:1024 sc1 lds
  v_mfma_f32_16x16x32_bf16 v[80:83], v[192:195], a[72:75], v[80:83]
  buffer_load_dwordx4 v2, s[4:7], s37 offen offset:2048 sc1 lds
  v_mfma_f32_16x16x32_bf16 v[100:103], v[192:195], a[76:79], v[100:103]
  s_waitcnt vmcnt(7)
  s_mov_b64 exec, 1
  v_cmp_gt_u32 vcc, s41, v253
  s_cbranch_vccz fc_48
  s_mov_b32 s30, 20000
  buffer_load_dword v254, v20, s[4:7], 0 offen sc1
poll_49:
  s_sleep 5
  buffer_load_dword v255, v20, s[4:7], 0 offen sc1
  s_waitcnt vmcnt(1)
  v_cmp_gt_u32 vcc, s41, v254
  s_cbranch_vccz pdone_50
  s_sleep 5
  buffer_load_dword v254, v20, s[4:7], 0 offen sc1
  s_waitcnt vmcnt(1)
  v_cmp_gt_u32 vcc, s41, v255
  s_cbranch_vccz pdone_50
  s_sub_u32 s30, s30, 1
  s_cmp_lg_u32 s30, 0
  s_cbranch_scc1 poll_49
  s_waitcnt vmcnt(0)
  v_mov_b32 v254, 1152
  v_mov_b32 v255, 128
  buffer_store_dword v254, v255, s[16:19], 0 offen
pdone_50:
fc_48:
  s_mov_b64 exec, -1
  s_waitcnt lgkmcnt(0)
  v_mfma_f32_16x16x32_bf16 v[64:67], v[104:107], a[80:83], v[64:67]
  ds_read_b128 v[176:179], v125 offset:41984
  v_mfma_f32_16x16x32_bf16 v[84:87], v[104:107], a[84:87], v[84:87]
  ds_read_b128 v[180:183], v125 offset:43008
  v_mfma_f32_16x16x32_bf16 v[68:71], v[108:111], a[80:83], v[68:71]
  ds_read_b128 v[184:187], v125 offset:44032
  v_mfma_f32_16x16x32_bf16 v[88:91], v[108:111], a[84:87], v[88:91]
  ds_read_b128 v[188:191], v125 offset:45056
  v_mfma_f32_16x16x32_bf16 v[72:75], v[112:115], a[80:83], v[72:75]
  ds_read_b128 v[192:195], v125 offset:46080
  buffer_load_dwordx4 a[120:123], v2, s[4:7], s32 offen offset:2048 sc1
  v_mfma_f32_16x16x32_bf16 v[92:95], v[112:115], a[84:87], v[92:95]
  buffer_load_dwordx4 a[124:127], v2, s[4:7], s33 offen offset:2048 sc1
  v_mfma_f32_16x16x32_bf16 v[76:79], v[116:119], a[80:83], v[76:79]
  buffer_load_dwordx4 v2, s[4:7], s37 offen offset:3072 sc1 lds
  s_add_u32 s37, s37, 4096
  v_mfma_f32_16x16x32_bf16 v[96:99], v[116:119], a[84:87], v[96:99]
  s_add_u32 m0, m0, 4096
  s_nop 0
  buffer_load_dwordx4 v2, s[4:7], s37 offen offset:0 sc1 lds
  v_mfma_f32_16x16x32_bf16 v[80:83], v[120:123], a[80:83], v[80:83]
  v_mfma_f32_16x16x32_bf16 v[100:103], v[120:123], a[84:87], v[100:103]
  s_barrier
  s_waitcnt lgkmcnt(0)
  v_mfma_f32_16x16x32_bf16 v[64:67], v[176:179], a[88:91], v[64:67]
  ds_read_b128 v[104:107], v125 offset:57344
  v_mfma_f32_16x16x32_bf16 v[84:87], v[176:179], a[92:95], v[84:87]
  ds_read_b128 v[108:111], v125 offset:58368
  v_mfma_f32_16x16x32_bf16 v[68:71], v[180:183], a[88:91], v[68:71]
  ds_read_b128 v[112:115], v125 offset:59392
  v_mfma_f32_16x16x32_bf16 v[88:91], v[180:183], a[92:95], v[88:91]
  ds_read_b128 v[116:119], v125 offset:60416
  v_mfma_f32_16x16x32_bf16 v[72:75], v[184:187], a[88:91], v[72:75]
  ds_read_b128 v[120:123], v125 offset:61440
  s_add_u32 s32, s32, 4096
  s_add_u32 s33, s33, 4096
  v_mfma_f32_16x16x32_bf16 v[92:95], v[184:187], a[92:95], v[92:95]
  buffer_load_dwordx4 a[128:131], v2, s[4:7], s32 offen offset:0 sc1
  v_mfma_f32_16x16x32_bf16 v[76:79], v[188:191], a[88:91], v[76:79]
  buffer_load_dwordx4 a[132:135], v2, s[4:7], s33 offen offset:0 sc1
  v_mfma_f32_16x16x32_bf16 v[96:99], v[188:191], a[92:95], v[96:99]
  buffer_load_dwordx4 a[136:139], v2, s[4:7], s32 offen offset:2048 sc1
  v_mfma_f32_16x16x32_bf16 v[80:83], v[192:195], a[88:91], v[80:83]
  v_mfma_f32_16x16x32_bf16 v[100:103], v[192:195], a[92:95], v[100:103]
  s_waitcnt lgkmcnt(0)
  v_mfma_f32_16x16x32_bf16 v[64:67], v[104:107], a[96:99], v[64:67]
  ds_read_b128 v[176:179], v125 offset:62464
  v_mfma_f32_16x16x32_bf16 v[84:87], v[104:107], a[100:103], v[84:87]
  ds_read_b128 v[180:183], v125 offset:63488
  v_mfma_f32_16x16x32_bf16 v[68:71], v[108:111], a[96:99], v[68:71]
  ds_read_b128 v[184:187], v125 offset:64512
  v_mfma_f32_16x16x32_bf16 v[88:91], v[108:111], a[100:103], v[88:91]
  ds_read_b128 v[188:191], v126 offset:0
  v_mfma_f32_16x16x32_bf16 v[72:75], v[112:115], a[96:99], v[72:75]
  ds_read_b128 v[192:195], v126 offset:1024
  buffer_load_dwordx4 a[140:143], v2, s[4:7], s33 offen offset:2048 sc1
  s_mul_i32 s36, s22, 5120
  v_mfma_f32_16x16x32_bf16 v[92:95], v[112:115], a[100:103], v[92:95]
  s_add_u32 s37, s36, s52
  s_add_u32 s37, s37, 184320
  v_mfma_f32_16x16x32_bf16 v[76:79], v[116:119], a[96:99], v[76:79]
  s_add_u32 m0, s36, 40960
  s_nop 0
  buffer_load_dwordx4 v2, s[4:7], s37 offen offset:0 sc1 lds
  v_mfma_f32_16x16x32_bf16 v[96:99], v[116:119], a[100:103], v[96:99]
  buffer_load_dwordx4 v2, s[4:7], s37 offen offset:1024 sc1 lds
  v_mfma_f32_16x16x32_bf16 v[80:83], v[120:123], a[96:99], v[80:83]
  buffer_load_dwordx4 v2, s[4:7], s37 offen offset:2048 sc1 lds
  v_mfma_f32_16x16x32_bf16 v[100:103], v[120:123], a[100:103], v[100:103]
  s_waitcnt vmcnt(16)
  s_barrier
  s_waitcnt lgkmcnt(0)
  v_mfma_f32_16x16x32_bf16 v[64:67], v[176:179], a[104:107], v[64:67]
  ds_read_b128 v[104:107], v124 offset:0
  v_mfma_f32_16x16x32_bf16 v[84:87], v[176:179], a[108:111], v[84:87]
  ds_read_b128 v[108:111], v124 offset:1024
  v_mfma_f32_16x16x32_bf16 v[68:71], v[180:183], a[104:107], v[68:71]
  ds_read_b128 v[112:115], v124 offset:2048
  v_mfma_f32_16x16x32_bf16 v[88:91], v[180:183], a[108:111], v[88:91]
  ds_read_b128 v[116:119], v124 offset:3072
  v_mfma_f32_16x16x32_bf16 v[72:75], v[184:187], a[104:107], v[72:75]
  ds_read_b128 v[120:123], v124 offset:4096
  buffer_load_dwordx4 v2, s[4:7], s37 offen offset:3072 sc1 lds
  s_add_u32 s37, s37, 4096
  v_mfma_f32_16x16x32_bf16 v[92:95], v[184:187], a[108:111], v[92:95]
  s_add_u32 m0, m0, 4096
  s_nop 0
  buffer_load_dwordx4 v2, s[4:7], s37 offen offset:0 sc1 lds
  v_mfma_f32_16x16x32_bf16 v[76:79], v[188:191], a[104:107], v[76:79]
  s_add_u32 s32, s32, 4096
  s_add_u32 s33, s33, 4096
  v_mfma_f32_16x16x32_bf16 v[96:99], v[188:191], a[108:111], v[96:99]
  buffer_load_dwordx4 a[144:147], v2, s[4:7], s32 offen offset:0 sc1
  v_mfma_f32_16x16x32_bf16 v[80:83], v[192:195], a[104:107], v[80:83]
  v_mfma_f32_16x16x32_bf16 v[100:103], v[192:195], a[108:111], v[100:103]
  s_waitcnt vmcnt(17)
  s_waitcnt lgkmcnt(0)
  v_mfma_f32_16x16x32_bf16 v[64:67], v[104:107], a[112:115], v[64:67]
  ds_read_b128 v[176:179], v124 offset:5120
  v_mfma_f32_16x16x32_bf16 v[84:87], v[104:107], a[116:119], v[84:87]
  ds_read_b128 v[180:183], v124 offset:6144
  v_mfma_f32_16x16x32_bf16 v[68:71], v[108:111], a[112:115], v[68:71]
  ds_read_b128 v[184:187], v124 offset:7168
  v_mfma_f32_16x16x32_bf16 v[88:91], v[108:111], a[116:119], v[88:91]
  ds_read_b128 v[188:191], v124 offset:8192
  v_mfma_f32_16x16x32_bf16 v[72:75], v[112:115], a[112:115], v[72:75]
  ds_read_b128 v[192:195], v124 offset:9216
  buffer_load_dwordx4 a[148:151], v2, s[4:7], s33 offen offset:0 sc1
  v_mfma_f32_16x16x32_bf16 v[92:95], v[112:115], a[116:119], v[92:95]
  buffer_load_dwordx4 a[152:155], v2, s[4:7], s32 offen offset:2048 sc1
  v_mfma_f32_16x16x32_bf16 v[76:79], v[116:119], a[112:115], v[76:79]
  buffer_load_dwordx4 a[156:159], v2, s[4:7], s33 offen offset:2048 sc1
  s_add_u32 s32, s32, 4096
  v_mfma_f32_16x16x32_bf16 v[96:99], v[116:119], a[116:119], v[96:99]
  s_add_u32 s33, s33, 4096
  buffer_load_dwordx4 a[0:3], v2, s[4:7], s32 offen offset:0 sc1
  v_mfma_f32_16x16x32_bf16 v[80:83], v[120:123], a[112:115], v[80:83]
  v_mfma_f32_16x16x32_bf16 v[100:103], v[120:123], a[116:119], v[100:103]
  s_waitcnt vmcnt(14)
  s_barrier
  s_waitcnt lgkmcnt(0)
  v_mfma_f32_16x16x32_bf16 v[64:67], v[176:179], a[120:123], v[64:67]
  ds_read_b128 v[104:107], v124 offset:20480
  v_mfma_f32_16x16x32_bf16 v[84:87], v[176:179], a[124:127], v[84:87]
  ds_read_b128 v[108:111], v124 offset:21504
  v_mfma_f32_16x16x32_bf16 v[68:71], v[180:183], a[120:123], v[68:71]
  ds_read_b128 v[112:115], v124 offset:22528
  v_mfma_f32_16x16x32_bf16 v[88:91], v[180:183], a[124:127], v[88:91]
  ds_read_b128 v[116:119], v124 offset:23552
  v_mfma_f32_16x16x32_bf16 v[72:75], v[184:187], a[120:123], v[72:75]
  ds_read_b128 v[120:123], v124 offset:24576
  buffer_load_dwordx4 a[4:7], v2, s[4:7], s33 offen offset:0 sc1
  v_mfma_f32_16x16x32_bf16 v[92:95], v[184:187], a[124:127], v[92:95]
  buffer_load_dwordx4 a[8:11], v2, s[4:7], s32 offen offset:2048 sc1
  v_mfma_f32_16x16x32_bf16 v[76:79], v[188:191], a[120:123], v[76:79]
  buffer_load_dwordx4 a[12:15], v2, s[4:7], s33 offen offset:2048 sc1
  v_mfma_f32_16x16x32_bf16 v[96:99], v[188:191], a[124:127], v[96:99]
  v_mfma_f32_16x16x32_bf16 v[80:83], v[192:195], a[120:123], v[80:83]
  v_mfma_f32_16x16x32_bf16 v[100:103], v[192:195], a[124:127], v[100:103]
  s_waitcnt vmcnt(15)
  s_waitcnt lgkmcnt(0)
  v_mfma_f32_16x16x32_bf16 v[64:67], v[104:107], a[128:131], v[64:67]
  ds_read_b128 v[176:179], v124 offset:25600
  v_mfma_f32_16x16x32_bf16 v[84:87], v[104:107], a[132:135], v[84:87]
  ds_read_b128 v[180:183], v124 offset:26624
  v_mfma_f32_16x16x32_bf16 v[68:71], v[108:111], a[128:131], v[68:71]
  ds_read_b128 v[184:187], v124 offset:27648
  v_mfma_f32_16x16x32_bf16 v[88:91], v[108:111], a[132:135], v[88:91]
  ds_read_b128 v[188:191], v124 offset:28672
  v_mfma_f32_16x16x32_bf16 v[72:75], v[112:115], a[128:131], v[72:75]
  ds_read_b128 v[192:195], v124 offset:29696
  s_add_u32 s32, s32, 4096
  s_add_u32 s33, s33, 4096
  v_mfma_f32_16x16x32_bf16 v[92:95], v[112:115], a[132:135], v[92:95]
  buffer_load_dwordx4 a[16:19], v2, s[4:7], s32 offen offset:0 sc1
  v_mfma_f32_16x16x32_bf16 v[76:79], v[116:119], a[128:131], v[76:79]
  buffer_load_dwordx4 a[20:23], v2, s[4:7], s33 offen offset:0 sc1
  v_mfma_f32_16x16x32_bf16 v[96:99], v[116:119], a[132:135], v[96:99]
  buffer_load_dwordx4 a[24:27], v2, s[4:7], s32 offen offset:2048 sc1
  v_mfma_f32_16x16x32_bf16 v[80:83], v[120:123], a[128:131], v[80:83]
  buffer_load_dwordx4 a[28:31], v2, s[4:7], s33 offen offset:2048 sc1
  v_mfma_f32_16x16x32_bf16 v[100:103], v[120:123], a[132:135], v[100:103]
  s_waitcnt vmcnt(12)
  s_barrier
  s_waitcnt lgkmcnt(0)
  v_mfma_f32_16x16x32_bf16 v[64:67], v[176:179], a[136:139], v[64:67]
  ds_read_b128 v[104:107], v124 offset:40960
  v_mfma_f32_16x16x32_bf16 v[84:87], v[176:179], a[140:143], v[84:87]
  ds_read_b128 v[108:111], v124 offset:41984
  v_mfma_f32_16x16x32_bf16 v[68:71], v[180:183], a[136:139], v[68:71]
  ds_read_b128 v[112:115], v124 offset:43008
  v_mfma_f32_16x16x32_bf16 v[88:91], v[180:183], a[140:143], v[88:91]
  ds_read_b128 v[116:119], v124 offset:44032
  v_mfma_f32_16x16x32_bf16 v[72:75], v[184:187], a[136:139], v[72:75]
  ds_read_b128 v[120:123], v124 offset:45056
  s_add_u32 s32, s32, 4096
  s_add_u32 s33, s33, 4096
  v_mfma_f32_16x16x32_bf16 v[92:95], v[184:187], a[140:143], v[92:95]
  buffer_load_dwordx4 a[32:35], v2, s[4:7], s32 offen offset:0 sc1
  v_mfma_f32_16x16x32_bf16 v[76:79], v[188:191], a[136:139], v[76:79]
  buffer_load_dwordx4 a[36:39], v2, s[4:7], s33 offen offset:0 sc1
  v_mfma_f32_16x16x32_bf16 v[96:99], v[188:191], a[140:143], v[96:99]
  buffer_load_dwordx4 a[40:43], v2, s[4:7], s32 offen offset:2048 sc1
  v_mfma_f32_16x16x32_bf16 v[80:83], v[192:195], a[136:139], v[80:83]
  v_mfma_f32_16x16x32_bf16 v[100:103], v[192:195], a[140:143], v[100:103]
  s_waitcnt vmcnt(13)
  s_waitcnt lgkmcnt(0)
  v_mfma_f32_16x16x32_bf16 v[64:67], v[104:107], a[144:147], v[64:67]
  ds_read_b128 v[176:179], v124 offset:46080
  v_mfma_f32_16x16x32_bf16 v[84:87], v[104:107], a[148:151], v[84:87]
  ds_read_b128 v[180:183], v124 offset:47104
  v_mfma_f32_16x16x32_bf16 v[68:71], v[108:111], a[144:147], v[68:71]
  ds_read_b128 v[184:187], v124 offset:48128
  v_mfma_f32_16x16x32_bf16 v[88:91], v[108:111], a[148:151], v[88:91]
  ds_read_b128 v[188:191], v124 offset:49152
  v_mfma_f32_16x16x32_bf16 v[72:75], v[112:115], a[144:147], v[72:75]
  ds_read_b128 v[192:195], v124 offset:50176
  buffer_load_dwordx4 a[44:47], v2, s[4:7], s33 offen offset:2048 sc1
  s_add_u32 s32, s32, 4096
  v_mfma_f32_16x16x32_bf16 v[92:95], v[112:115], a[148:151], v[92:95]
  s_add_u32 s33, s33, 4096
  buffer_load_dwordx4 a[48:51], v2, s[4:7], s32 offen offset:0 sc1
  v_mfma_f32_16x16x32_bf16 v[76:79], v[116:119], a[144:147], v[76:79]
  buffer_load_dwordx4 a[52:55], v2, s[4:7], s33 offen offset:0 sc1
  v_mfma_f32_16x16x32_bf16 v[96:99], v[116:119], a[148:151], v[96:99]
  v_mfma_f32_16x16x32_bf16 v[80:83], v[120:123], a[144:147], v[80:83]
  v_mfma_f32_16x16x32_bf16 v[100:103], v[120:123], a[148:151], v[100:103]
  s_waitcnt vmcnt(14)
  s_waitcnt lgkmcnt(0)
  v_mfma_f32_16x16x32_bf16 v[64:67], v[176:179], a[152:155], v[64:67]
  v_mfma_f32_16x16x32_bf16 v[84:87], v[176:179], a[156:159], v[84:87]
  v_mfma_f32_16x16x32_bf16 v[68:71], v[180:183], a[152:155], v[68:71]
  v_mfma_f32_16x16x32_bf16 v[88:91], v[180:183], a[156:159], v[88:91]
  v_mfma_f32_16x16x32_bf16 v[72:75], v[184:187], a[152:155], v[72:75]
  v_mfma_f32_16x16x32_bf16 v[92:95], v[184:187], a[156:159], v[92:95]
  v_mfma_f32_16x16x32_bf16 v[76:79], v[188:191], a[152:155], v[76:79]
  v_mfma_f32_16x16x32_bf16 v[96:99], v[188:191], a[156:159], v[96:99]
  v_mfma_f32_16x16x32_bf16 v[80:83], v[192:195], a[152:155], v[80:83]
  v_mfma_f32_16x16x32_bf16 v[100:103], v[192:195], a[156:159], v[100:103]
  s_waitcnt vmcnt(12)
  v_mfma_f32_16x16x32_bf16 v[64:67], v[44:47], a[0:3], v[64:67]
  v_mfma_f32_16x16x32_bf16 v[84:87], v[44:47], a[4:7], v[84:87]
  v_mfma_f32_16x16x32_bf16 v[68:71], v[48:51], a[0:3], v[68:71]
  v_mfma_f32_16x16x32_bf16 v[88:91], v[48:51], a[4:7], v[88:91]
  v_mfma_f32_16x16x32_bf16 v[72:75], v[52:55], a[0:3], v[72:75]
  v_mfma_f32_16x16x32_bf16 v[92:95], v[52:55], a[4:7], v[92:95]
  v_mfma_f32_16x16x32_bf16 v[76:79], v[56:59], a[0:3], v[76:79]
  v_mfma_f32_16x16x32_bf16 v[96:99], v[56:59], a[4:7], v[96:99]
  v_mfma_f32_16x16x32_bf16 v[80:83], v[60:63], a[0:3], v[80:83]
  v_mfma_f32_16x16x32_bf16 v[100:103], v[60:63], a[4:7], v[100:103]
  s_waitcnt vmcnt(10)
  v_mfma_f32_16x16x32_bf16 v[64:67], v[236:239], a[8:11], v[64:67]
  v_mfma_f32_16x16x32_bf16 v[84:87], v[236:239], a[12:15], v[84:87]
  v_mfma_f32_16x16x32_bf16 v[68:71], v[244:247], a[8:11], v[68:71]
  v_mfma_f32_16x16x32_bf16 v[88:91], v[244:247], a[12:15], v[88:91]
  v_mfma_f32_16x16x32_bf16 v[72:75], v[248:251], a[8:11], v[72:75]
  v_mfma_f32_16x16x32_bf16 v[92:95], v[248:251], a[12:15], v[92:95]
  v_mfma_f32_16x16x32_bf16 v[76:79], v[208:211], a[8:11], v[76:79]
  v_mfma_f32_16x16x32_bf16 v[96:99], v[208:211], a[12:15], v[96:99]
  v_mfma_f32_16x16x32_bf16 v[80:83], v[212:215], a[8:11], v[80:83]
  v_mfma_f32_16x16x32_bf16 v[100:103], v[212:215], a[12:15], v[100:103]
  s_waitcnt vmcnt(8)
  v_mfma_f32_16x16x32_bf16 v[64:67], a[160:163], a[16:19], v[64:67]
  v_mfma_f32_16x16x32_bf16 v[84:87], a[160:163], a[20:23], v[84:87]
  v_mfma_f32_16x16x32_bf16 v[68:71], a[164:167], a[16:19], v[68:71]
  v_mfma_f32_16x16x32_bf16 v[88:91], a[164:167], a[20:23], v[88:91]
  v_mfma_f32_16x16x32_bf16 v[72:75], a[168:171], a[16:19], v[72:75]
  v_mfma_f32_16x16x32_bf16 v[92:95], a[168:171], a[20:23], v[92:95]
  v_mfma_f32_16x16x32_bf16 v[76:79], a[172:175], a[16:19], v[76:79]
  v_mfma_f32_16x16x32_bf16 v[96:99], a[172:175], a[20:23], v[96:99]
  v_mfma_f32_16x16x32_bf16 v[80:83], a[176:179], a[16:19], v[80:83]
  v_mfma_f32_16x16x32_bf16 v[100:103], a[176:179], a[20:23], v[100:103]
  s_waitcnt vmcnt(6)
  v_mfma_f32_16x16x32_bf16 v[64:67], a[180:183], a[24:27], v[64:67]
  v_mfma_f32_16x16x32_bf16 v[84:87], a[180:183], a[28:31], v[84:87]
  v_mfma_f32_16x16x32_bf16 v[68:71], a[184:187], a[24:27], v[68:71]
  v_mfma_f32_16x16x32_bf16 v[88:91], a[184:187], a[28:31], v[88:91]
  v_mfma_f32_16x16x32_bf16 v[72:75], a[188:191], a[24:27], v[72:75]
  v_mfma_f32_16x16x32_bf16 v[92:95], a[188:191], a[28:31], v[92:95]
  v_mfma_f32_16x16x32_bf16 v[76:79], a[192:195], a[24:27], v[76:79]
  v_mfma_f32_16x16x32_bf16 v[96:99], a[192:195], a[28:31], v[96:99]
  v_mfma_f32_16x16x32_bf16 v[80:83], a[196:199], a[24:27], v[80:83]
  v_mfma_f32_16x16x32_bf16 v[100:103], a[196:199], a[28:31], v[100:103]
  s_waitcnt vmcnt(4)
  v_mfma_f32_16x16x32_bf16 v[64:67], a[200:203], a[32:35], v[64:67]
  v_mfma_f32_16x16x32_bf16 v[84:87], a[200:203], a[36:39], v[84:87]
  v_mfma_f32_16x16x32_bf16 v[68:71], a[204:207], a[32:35], v[68:71]
  v_mfma_f32_16x16x32_bf16 v[88:91], a[204:207], a[36:39], v[88:91]
  v_mfma_f32_16x16x32_bf16 v[72:75], a[208:211], a[32:35], v[72:75]
  v_mfma_f32_16x16x32_bf16 v[92:95], a[208:211], a[36:39], v[92:95]
  v_mfma_f32_16x16x32_bf16 v[76:79], a[212:215], a[32:35], v[76:79]
  v_mfma_f32_16x16x32_bf16 v[96:99], a[212:215], a[36:39], v[96:99]
  v_mfma_f32_16x16x32_bf16 v[80:83], a[216:219], a[32:35], v[80:83]
  v_mfma_f32_16x16x32_bf16 v[100:103], a[216:219], a[36:39], v[100:103]
  s_waitcnt vmcnt(2)
  v_mfma_f32_16x16x32_bf16 v[64:67], a[220:223], a[40:43], v[64:67]
  v_mfma_f32_16x16x32_bf16 v[84:87], a[220:223], a[44:47], v[84:87]
  v_mfma_f32_16x16x32_bf16 v[68:71], a[224:227], a[40:43], v[68:71]
  v_mfma_f32_16x16x32_bf16 v[88:91], a[224:227], a[44:47], v[88:91]
  v_mfma_f32_16x16x32_bf16 v[72:75], a[228:231], a[40:43], v[72:75]
  v_mfma_f32_16x16x32_bf16 v[92:95], a[228:231], a[44:47], v[92:95]
  v_mfma_f32_16x16x32_bf16 v[76:79], a[232:235], a[40:43], v[76:79]
  v_mfma_f32_16x16x32_bf16 v[96:99], a[232:235], a[44:47], v[96:99]
  v_mfma_f32_16x16x32_bf16 v[80:83], a[236:239], a[40:43], v[80:83]
  v_mfma_f32_16x16x32_bf16 v[100:103], a[236:239], a[44:47], v[100:103]
  s_waitcnt vmcnt(0)
  v_mfma_f32_16x16x32_bf16 v[64:67], a[240:243], a[48:51], v[64:67]
  v_mfma_f32_16x16x32_bf16 v[84:87], a[240:243], a[52:55], v[84:87]
  v_mfma_f32_16x16x32_bf16 v[68:71], a[244:247], a[48:51], v[68:71]
  v_mfma_f32_16x16x32_bf16 v[88:91], a[244:247], a[52:55], v[88:91]
  v_mfma_f32_16x16x32_bf16 v[72:75], a[248:251], a[48:51], v[72:75]
  v_mfma_f32_16x16x32_bf16 v[92:95], a[248:251], a[52:55], v[92:95]
  v_mfma_f32_16x16x32_bf16 v[76:79], a[252:255], a[48:51], v[76:79]
  v_mfma_f32_16x16x32_bf16 v[96:99], a[252:255], a[52:55], v[96:99]
  v_mfma_f32_16x16x32_bf16 v[80:83], v[240:243], a[48:51], v[80:83]
  v_mfma_f32_16x16x32_bf16 v[100:103], v[240:243], a[52:55], v[100:103]
  v_add_u32 v136, 0, v28
  v_add_u32 v137, 0, v29
  ds_write_b128 v136, v[84:87] offset:0
  ds_write_b128 v136, v[88:91] offset:1024
  ds_write_b128 v136, v[92:95] offset:2048
  s_nop 0
  ds_write_b128 v136, v[96:99] offset:3072
  s_nop 0
  ds_write_b128 v136, v[100:103] offset:4096
  s_waitcnt lgkmcnt(0)
  s_barrier
  ds_read_b128 v[84:87], v137 offset:0
  ds_read_b128 v[88:91], v137 offset:1024
  ds_read_b128 v[92:95], v137 offset:2048
  ds_read_b128 v[96:99], v137 offset:3072
  ds_read_b128 v[100:103], v137 offset:4096
  s_cmp_lg_u32 s23, 0
  s_cbranch_scc1 main_final
  s_add_u32 s32, s40, s47
  s_add_u32 s32, s32, 22020096
  s_add_u32 s33, s32, 4096
  s_add_u32 s34, s40, s48
  s_add_u32 s34, s34, 43122688
  s_waitcnt lgkmcnt(4)
  v_pk_add_f32 v[64:65], v[64:65], v[84:85]
  v_pk_add_f32 v[66:67], v[66:67], v[86:87]
  v_cvt_pk_bf16_f32 v4, v64, v65
  v_cvt_pk_bf16_f32 v5, v66, v67
  s_waitcnt lgkmcnt(3)
  v_pk_add_f32 v[68:69], v[68:69], v[88:89]
  v_pk_add_f32 v[70:71], v[70:71], v[90:91]
  v_cvt_pk_bf16_f32 v6, v68, v69
  v_cvt_pk_bf16_f32 v7, v70, v71
  s_waitcnt lgkmcnt(2)
  v_pk_add_f32 v[72:73], v[72:73], v[92:93]
  v_pk_add_f32 v[74:75], v[74:75], v[94:95]
  v_cvt_pk_bf16_f32 v8, v72, v73
  v_cvt_pk_bf16_f32 v9, v74, v75
  s_waitcnt lgkmcnt(1)
  v_pk_add_f32 v[76:77], v[76:77], v[96:97]
  v_pk_add_f32 v[78:79], v[78:79], v[98:99]
  v_cvt_pk_bf16_f32 v10, v76, v77
  v_cvt_pk_bf16_f32 v11, v78, v79
  s_waitcnt lgkmcnt(0)
  v_pk_add_f32 v[80:81], v[80:81], v[100:101]
  v_pk_add_f32 v[82:83], v[82:83], v[102:103]
  v_cvt_pk_bf16_f32 v12, v80, v81
  v_cvt_pk_bf16_f32 v13, v82, v83
  buffer_store_dwordx4 v[4:7], v17, s[4:7], s32 offen sc1
  buffer_store_dwordx4 v[8:11], v17, s[4:7], s32 offen offset:2048 sc1
  v_mov_b32 v112, v12
  v_mov_b32 v113, v13
  v_mov_b32 v114, v12
  v_mov_b32 v115, v13
  v_mov_b32 v116, v12
  v_mov_b32 v117, v13
  s_nop 0
  v_permlane32_swap_b32 v116, v114
  v_permlane32_swap_b32 v117, v115
  s_mov_b32 exec_hi, 0
  buffer_store_dwordx4 v[112:115], v17, s[4:7], s33 offen sc1
  s_mov_b32 exec_hi, -1
  v_pk_add_f32 v[124:125], v[64:65], v[66:67]
  v_pk_mul_f32 v[126:127], v[64:65], v[64:65]
  v_pk_fma_f32 v[126:127], v[66:67], v[66:67], v[126:127]
  v_pk_add_f32 v[124:125], v[124:125], v[68:69]
  v_pk_fma_f32 v[126:127], v[68:69], v[68:69], v[126:127]
  v_pk_add_f32 v[124:125], v[124:125], v[70:71]
  v_pk_fma_f32 v[126:127], v[70:71], v[70:71], v[126:127]
  v_pk_add_f32 v[124:125], v[124:125], v[72:73]
  v_pk_fma_f32 v[126:127], v[72:73], v[72:73], v[126:127]
  v_pk_add_f32 v[124:125], v[124:125], v[74:75]
  v_pk_fma_f32 v[126:127], v[74:75], v[74:75], v[126:127]
  v_pk_add_f32 v[124:125], v[124:125], v[76:77]
  v_pk_fma_f32 v[126:127], v[76:77], v[76:77], v[126:127]
  v_pk_add_f32 v[124:125], v[124:125], v[78:79]
  v_pk_fma_f32 v[126:127], v[78:79], v[78:79], v[126:127]
  v_pk_add_f32 v[124:125], v[124:125], v[80:81]
  v_pk_fma_f32 v[126:127], v[80:81], v[80:81], v[126:127]
  v_pk_add_f32 v[124:125], v[124:125], v[82:83]
  v_pk_fma_f32 v[126:127], v[82:83], v[82:83], v[126:127]
  v_add_f32 v120, v124, v125
  v_add_f32 v121, v126, v127
  v_mov_b32 v122, v120
  v_mov_b32 v123, v121
  s_nop 0
  v_permlane16_swap_b32 v120, v122
  v_permlane16_swap_b32 v121, v123
  v_add_f32 v120, v120, v122
  v_add_f32 v121, v121, v123
  v_mov_b32 v122, v120
  v_mov_b32 v123, v121
  s_nop 0
  v_permlane32_swap_b32 v120, v122
  v_permlane32_swap_b32 v121, v123
  v_add_f32 v120, v120, v122
  v_add_f32 v121, v121, v123
  s_mov_b64 exec, 0xffff
  buffer_store_dwordx2 v[120:121], v18, s[4:7], s34 offen sc1
  s_mov_b64 exec, -1
  s_cmp_eq_u32 s22, 0
  s_cbranch_scc1 p0_53
  s_mul_i32 s36, s55, 12288
  s_add_u32 s37, s36, s49
  s_add_u32 s37, s37, 0
  s_add_u32 m0, s36, 20480
  s_nop 0
  buffer_load_dwordx4 v2, s[4:7], s37 offen offset:0 sc1 lds
  buffer_load_dwordx4 v2, s[4:7], s37 offen offset:1024 sc1 lds
  buffer_load_dwordx4 v2, s[4:7], s37 offen offset:2048 sc1 lds
  buffer_load_dwordx4 v2, s[4:7], s37 offen offset:3072 sc1 lds
  s_add_u32 s37, s37, 4096
  s_add_u32 m0, m0, 4096
  s_nop 0
  buffer_load_dwordx4 v2, s[4:7], s37 offen offset:0 sc1 lds
  buffer_load_dwordx4 v2, s[4:7], s37 offen offset:1024 sc1 lds
  buffer_load_dwordx4 v2, s[4:7], s37 offen offset:2048 sc1 lds
  buffer_load_dwordx4 v2, s[4:7], s37 offen offset:3072 sc1 lds
  s_add_u32 s37, s37, 4096
  s_add_u32 m0, m0, 4096
  s_nop 0
  buffer_load_dwordx4 v2, s[4:7], s37 offen offset:0 sc1 lds
  buffer_load_dwordx4 v2, s[4:7], s37 offen offset:1024 sc1 lds
  buffer_load_dwordx4 v2, s[4:7], s37 offen offset:2048 sc1 lds
  buffer_load_dwordx4 v2, s[4:7], s37 offen offset:3072 sc1 lds
  s_waitcnt vmcnt(12) lgkmcnt(0)
  s_branch pe_54
p0_53:
  s_waitcnt vmcnt(0) lgkmcnt(0)
pe_54:
  s_barrier
  s_add_u32 s41, s41, 16
  s_cmp_lg_u32 s22, 0
  s_cbranch_scc1 nw0_51
  s_mov_b64 exec, 1
  v_mov_b32 v252, 1
  s_and_b32 s3, s21, 0
  s_lshl_b32 s3, s3, 7
  buffer_atomic_add v252, v20, s[4:7], s3 offen sc0 sc1
  s_mov_b64 exec, 1
  s_waitcnt vmcnt(0)
  v_readfirstlane_b32 s3, v252
  s_nop 0
  s_sub_u32 s3, s41, s3
  s_cmp_le_u32 s3, 1
  s_cbranch_scc1 rk_55
  s_cmp_le_u32 s3, 6
  s_cbranch_scc1 rk_55a
  s_sleep 1
rk_55a:
  s_mov_b32 s30, 20000
  buffer_load_dword v254, v20, s[4:7], 0 offen sc1
poll_56:
  s_sleep 5
  buffer_load_dword v255, v20, s[4:7], 0 offen sc1
  s_waitcnt vmcnt(1)
  v_cmp_gt_u32 vcc, s41, v254
  s_cbranch_vccz pdone_57
  s_sleep 5
  buffer_load_dword v254, v20, s[4:7], 0 offen sc1
  s_waitcnt vmcnt(1)
  v_cmp_gt_u32 vcc, s41, v255
  s_cbranch_vccz pdone_57
  s_sub_u32 s30, s30, 1
  s_cmp_lg_u32 s30, 0
  s_cbranch_scc1 poll_56
  s_waitcnt vmcnt(0)
  v_mov_b32 v254, 1280
  v_mov_b32 v255, 128
  buffer_store_dword v254, v255, s[16:19], 0 offen
pdone_57:
rk_55:
  s_mov_b64 exec, -1
  s_branch syn_52
nw0_51:
  s_lshl_b32 s3, s23, 2
  s_add_u32 s3, s3, s22
  s_cmp_lg_u32 s3, 3
  s_cbranch_scc1 ct_58
  s_getpc_b64 s[28:29]
pc_59:
  s_sub_u32 s28, s28, pc_59 - interleave_layers__sliding_block__glu_gated_reglu__prompt_kernel
  s_subb_u32 s29, s29, 0
  s_mov_b32 s30, main_last - interleave_layers__sliding_block__glu_gated_reglu__prompt_kernel
  s_mov_b32 s31, 0x20000
  s_and_b32 s3, s21, 7
  s_lshl_b32 s3, s3, 13
  v_lshlrev_b32 v252, 3, v2
  buffer_load_dword v43, v252, s[28:31], s3 offen
ct_58:
  s_mul_i32 s36, s55, 15360
  s_add_u32 s37, s36, s49
  s_add_u32 s37, s37, 36864
  s_add_u32 m0, s36, 57344
  s_nop 0
  buffer_load_dwordx4 v2, s[4:7], s37 offen offset:0 sc1 lds
  buffer_load_dwordx4 v2, s[4:7], s37 offen offset:1024 sc1 lds
  buffer_load_dwordx4 v2, s[4:7], s37 offen offset:2048 sc1 lds
  buffer_load_dwordx4 v2, s[4:7], s37 offen offset:3072 sc1 lds
  s_add_u32 s37, s37, 4096
  s_add_u32 m0, m0, 4096
  s_nop 0
  buffer_load_dwordx4 v2, s[4:7], s37 offen offset:0 sc1 lds
  buffer_load_dwordx4 v2, s[4:7], s37 offen offset:1024 sc1 lds
  buffer_load_dwordx4 v2, s[4:7], s37 offen offset:2048 sc1 lds
  buffer_load_dwordx4 v2, s[4:7], s37 offen offset:3072 sc1 lds
  s_add_u32 s37, s37, 4096
  s_add_u32 m0, m0, 4096
  s_nop 0
  buffer_load_dwordx4 v2, s[4:7], s37 offen offset:0 sc1 lds
  buffer_load_dwordx4 v2, s[4:7], s37 offen offset:1024 sc1 lds
  buffer_load_dwordx4 v2, s[4:7], s37 offen offset:2048 sc1 lds
  buffer_load_dwordx4 v2, s[4:7], s37 offen offset:3072 sc1 lds
  s_add_u32 s37, s37, 4096
  s_add_u32 m0, m0, 4096
  s_nop 0
  buffer_load_dwordx4 v2, s[4:7], s37 offen offset:0 sc1 lds
  buffer_load_dwordx4 v2, s[4:7], s37 offen offset:1024 sc1 lds
  buffer_load_dwordx4 v2, s[4:7], s37 offen offset:2048 sc1 lds
syn_52:
  s_barrier
  s_mov_b32 s23, 1
  s_add_u32 s40, s40, 22020096
  s_mov_b32 s54, 32
  s_add_u32 s32, s40, s42
  s_add_u32 s31, s40, s43
  s_add_u32 s31, s31, 21102592
  buffer_load_dwordx2 v[160:161], v3, s[4:7], s31 offen offset:0 sc1
  buffer_load_dwordx2 v[162:163], v3, s[4:7], s31 offen offset:512 sc1
  buffer_load_dwordx2 v[164:165], v3, s[4:7], s31 offen offset:1024 sc1
  buffer_load_dwordx2 v[166:167], v3, s[4:7], s31 offen offset:1536 sc1
  buffer_load_dwordx4 a[0:3], v2, s[4:7], s32 offen offset:0 sc1
  buffer_load_dwordx4 a[4:7], v2, s[4:7], s32 offen offset:1024 sc1
  buffer_load_dwordx4 a[8:11], v2, s[4:7], s32 offen offset:2048 sc1
  buffer_load_dwordx4 a[12:15], v2, s[4:7], s32 offen offset:3072 sc1
  s_add_u32 s32, s32, 4096
  buffer_load_dwordx4 a[16:19], v2, s[4:7], s32 offen offset:0 sc1
  buffer_load_dwordx4 a[20:23], v2, s[4:7], s32 offen offset:1024 sc1
  buffer_load_dwordx4 a[24:27], v2, s[4:7], s32 offen offset:2048 sc1
  buffer_load_dwordx4 a[28:31], v2, s[4:7], s32 offen offset:3072 sc1
  s_add_u32 s32, s32, 4096
  buffer_load_dwordx4 a[32:35], v2, s[4:7], s32 offen offset:0 sc1
  buffer_load_dwordx4 a[36:39], v2, s[4:7], s32 offen offset:1024 sc1
  buffer_load_dwordx4 a[40:43], v2, s[4:7], s32 offen offset:2048 sc1
  buffer_load_dwordx4 a[44:47], v2, s[4:7], s32 offen offset:3072 sc1
  s_waitcnt vmcnt(11)
  s_barrier
  ds_read_b128 v[128:131], v2 offset:20480
  ds_read_b128 v[132:135], v2 offset:21504
  ds_read_b128 v[136:139], v2 offset:22528
  ds_read_b128 v[140:143], v2 offset:23552
  ds_read_b128 v[144:147], v2 offset:24576
  ds_read_b128 v[148:151], v2 offset:25600
  ds_read_b128 v[152:155], v2 offset:26624
  ds_read_b128 v[156:159], v2 offset:27648
  s_waitcnt lgkmcnt(6)
  v_mfma_f32_32x32x16_bf16 v[64:79], v[128:131], a[0:3], 0
  ds_read_b128 v[128:131], v2 offset:28672
  s_add_u32 s32, s32, 4096
  buffer_load_dwordx4 a[48:51], v2, s[4:7], s32 offen offset:0 sc1
  v_mfma_f32_32x32x16_bf16 v[80:95], v[132:135], a[0:3], 0
  ds_read_b128 v[132:135], v2 offset:29696
  s_waitcnt vmcnt(11)
  s_waitcnt lgkmcnt(6)
  v_mfma_f32_32x32x16_bf16 v[64:79], v[136:139], a[4:7], v[64:79]
  ds_read_b128 v[136:139], v2 offset:30720
  buffer_load_dwordx4 a[52:55], v2, s[4:7], s32 offen offset:1024 sc1
  v_mfma_f32_32x32x16_bf16 v[80:95], v[140:143], a[4:7], v[80:95]
  ds_read_b128 v[140:143], v2 offset:31744
  s_waitcnt vmcnt(11)
  s_waitcnt lgkmcnt(6)
  v_mfma_f32_32x32x16_bf16 v[64:79], v[144:147], a[8:11], v[64:79]
  ds_read_b128 v[144:147], v2 offset:32768
  buffer_load_dwordx4 a[56:59], v2, s[4:7], s32 offen offset:2048 sc1
  v_mfma_f32_32x32x16_bf16 v[80:95], v[148:151], a[8:11], v[80:95]
  ds_read_b128 v[148:151], v2 offset:33792
  s_waitcnt vmcnt(11)
  s_waitcnt lgkmcnt(6)
  v_mfma_f32_32x32x16_bf16 v[64:79], v[152:155], a[12:15], v[64:79]
  ds_read_b128 v[152:155], v2 offset:34816
  buffer_load_dwordx4 a[60:63], v2, s[4:7], s32 offen offset:3072 sc1
  v_mfma_f32_32x32x16_bf16 v[80:95], v[156:159], a[12:15], v[80:95]
  ds_read_b128 v[156:159], v2 offset:35840
  s_barrier
  s_waitcnt vmcnt(11)
  s_waitcnt lgkmcnt(6)
  v_mfma_f32_32x32x16_bf16 v[64:79], v[128:131], a[16:19], v[64:79]
  ds_read_b128 v[128:131], v2 offset:36864
  s_add_u32 s32, s32, 4096
  buffer_load_dwordx4 a[64:67], v2, s[4:7], s32 offen offset:0 sc1
  v_mfma_f32_32x32x16_bf16 v[80:95], v[132:135], a[16:19], v[80:95]
  ds_read_b128 v[132:135], v2 offset:37888
  s_waitcnt vmcnt(11)
  s_waitcnt lgkmcnt(6)
  v_mfma_f32_32x32x16_bf16 v[64:79], v[136:139], a[20:23], v[64:79]
  ds_read_b128 v[136:139], v2 offset:38912
  buffer_load_dwordx4 a[68:71], v2, s[4:7], s32 offen offset:1024 sc1
  v_mfma_f32_32x32x16_bf16 v[80:95], v[140:143], a[20:23], v[80:95]
  ds_read_b128 v[140:143], v2 offset:39936
  s_waitcnt vmcnt(11)
  s_waitcnt lgkmcnt(6)
  v_mfma_f32_32x32x16_bf16 v[64:79], v[144:147], a[24:27], v[64:79]
  ds_read_b128 v[144:147], v2 offset:40960
  buffer_load_dwordx4 a[72:75], v2, s[4:7], s32 offen offset:2048 sc1
  v_mfma_f32_32x32x16_bf16 v[80:95], v[148:151], a[24:27], v[80:95]
  ds_read_b128 v[148:151], v2 offset:41984
  s_waitcnt vmcnt(11)
  s_waitcnt lgkmcnt(6)
  v_mfma_f32_32x32x16_bf16 v[64:79], v[152:155], a[28:31], v[64:79]
  ds_read_b128 v[152:155], v2 offset:43008
  buffer_load_dwordx4 a[76:79], v2, s[4:7], s32 offen offset:3072 sc1
  v_mfma_f32_32x32x16_bf16 v[80:95], v[156:159], a[28:31], v[80:95]
  ds_read_b128 v[156:159], v2 offset:44032
  s_barrier
  s_waitcnt vmcnt(11)
  s_waitcnt lgkmcnt(6)
  v_mfma_f32_32x32x16_bf16 v[64:79], v[128:131], a[32:35], v[64:79]
  ds_read_b128 v[128:131], v2 offset:45056
  s_add_u32 s32, s32, 4096
  buffer_load_dwordx4 a[80:83], v2, s[4:7], s32 offen offset:0 sc1
  v_mfma_f32_32x32x16_bf16 v[80:95], v[132:135], a[32:35], v[80:95]
  ds_read_b128 v[132:135], v2 offset:46080
  s_waitcnt vmcnt(11)
  s_waitcnt lgkmcnt(6)
  v_mfma_f32_32x32x16_bf16 v[64:79], v[136:139], a[36:39], v[64:79]
  ds_read_b128 v[136:139], v2 offset:47104
  buffer_load_dwordx4 a[84:87], v2, s[4:7], s32 offen offset:1024 sc1
  v_mfma_f32_32x32x16_bf16 v[80:95], v[140:143], a[36:39], v[80:95]
  ds_read_b128 v[140:143], v2 offset:48128
  buffer_load_dwordx4 a[88:91], v2, s[4:7], s32 offen offset:2048 sc1
  s_waitcnt vmcnt(12)
  s_waitcnt lgkmcnt(6)
  v_mfma_f32_32x32x16_bf16 v[64:79], v[144:147], a[40:43], v[64:79]
  ds_read_b128 v[144:147], v2 offset:49152
  buffer_load_dwordx4 a[92:95], v2, s[4:7], s32 offen offset:3072 sc1
  v_mfma_f32_32x32x16_bf16 v[80:95], v[148:151], a[40:43], v[80:95]
  ds_read_b128 v[148:151], v2 offset:50176
  s_waitcnt vmcnt(12)
  s_waitcnt lgkmcnt(6)
  v_mfma_f32_32x32x16_bf16 v[64:79], v[152:155], a[44:47], v[64:79]
  ds_read_b128 v[152:155], v2 offset:51200
  s_add_u32 s32, s32, 4096
  buffer_load_dwordx4 a[96:99], v2, s[4:7], s32 offen offset:0 sc1
  v_mfma_f32_32x32x16_bf16 v[80:95], v[156:159], a[44:47], v[80:95]
  ds_read_b128 v[156:159], v2 offset:52224
  s_barrier
  s_waitcnt vmcnt(12)
  s_waitcnt lgkmcnt(6)
  v_mfma_f32_32x32x16_bf16 v[64:79], v[128:131], a[48:51], v[64:79]
  ds_read_b128 v[128:131], v2 offset:53248
  buffer_load_dwordx4 a[100:103], v2, s[4:7], s32 offen offset:1024 sc1
  v_mfma_f32_32x32x16_bf16 v[80:95], v[132:135], a[48:51], v[80:95]
  ds_read_b128 v[132:135], v2 offset:54272
  s_waitcnt vmcnt(12)
  s_waitcnt lgkmcnt(6)
  v_mfma_f32_32x32x16_bf16 v[64:79], v[136:139], a[52:55], v[64:79]
  ds_read_b128 v[136:139], v2 offset:55296
  buffer_load_dwordx4 a[104:107], v2, s[4:7], s32 offen offset:2048 sc1
  v_mfma_f32_32x32x16_bf16 v[80:95], v[140:143], a[52:55], v[80:95]
  ds_read_b128 v[140:143], v2 offset:56320
  s_waitcnt vmcnt(12)
  s_waitcnt lgkmcnt(6)
  v_mfma_f32_32x32x16_bf16 v[64:79], v[144:147], a[56:59], v[64:79]
  ds_read_b128 v[144:147], v2 offset:57344
  buffer_load_dwordx4 a[108:111], v2, s[4:7], s32 offen offset:3072 sc1
  v_mfma_f32_32x32x16_bf16 v[80:95], v[148:151], a[56:59], v[80:95]
  ds_read_b128 v[148:151], v2 offset:58368
  s_waitcnt vmcnt(12)
  s_waitcnt lgkmcnt(6)
  v_mfma_f32_32x32x16_bf16 v[64:79], v[152:155], a[60:63], v[64:79]
  ds_read_b128 v[152:155], v2 offset:59392
  s_add_u32 s32, s32, 4096
  buffer_load_dwordx4 a[112:115], v2, s[4:7], s32 offen offset:0 sc1
  v_mfma_f32_32x32x16_bf16 v[80:95], v[156:159], a[60:63], v[80:95]
  ds_read_b128 v[156:159], v2 offset:60416
  s_barrier
  s_waitcnt vmcnt(12)
  s_waitcnt lgkmcnt(6)
  v_mfma_f32_32x32x16_bf16 v[64:79], v[128:131], a[64:67], v[64:79]
  ds_read_b128 v[128:131], v2 offset:61440
  buffer_load_dwordx4 a[116:119], v2, s[4:7], s32 offen offset:1024 sc1
  v_mfma_f32_32x32x16_bf16 v[80:95], v[132:135], a[64:67], v[80:95]
  ds_read_b128 v[132:135], v2 offset:62464
  s_waitcnt vmcnt(12)
  s_waitcnt lgkmcnt(6)
  v_mfma_f32_32x32x16_bf16 v[64:79], v[136:139], a[68:71], v[64:79]
  ds_read_b128 v[136:139], v2 offset:63488
  buffer_load_dwordx4 a[120:123], v2, s[4:7], s32 offen offset:2048 sc1
  v_mfma_f32_32x32x16_bf16 v[80:95], v[140:143], a[68:71], v[80:95]
  ds_read_b128 v[140:143], v2 offset:64512
  s_waitcnt vmcnt(12)
  s_waitcnt lgkmcnt(6)
  v_mfma_f32_32x32x16_bf16 v[64:79], v[144:147], a[72:75], v[64:79]
  ds_read_b128 v[144:147], v30 offset:0
  buffer_load_dwordx4 a[124:127], v2, s[4:7], s32 offen offset:3072 sc1
  v_mfma_f32_32x32x16_bf16 v[80:95], v[148:151], a[72:75], v[80:95]
  ds_read_b128 v[148:151], v30 offset:1024
  s_waitcnt vmcnt(12)
  s_waitcnt lgkmcnt(6)
  v_mfma_f32_32x32x16_bf16 v[64:79], v[152:155], a[76:79], v[64:79]
  ds_read_b128 v[152:155], v30 offset:2048
  s_add_u32 s32, s32, 4096
  buffer_load_dwordx4 a[128:131], v2, s[4:7], s32 offen offset:0 sc1
  v_mfma_f32_32x32x16_bf16 v[80:95], v[156:159], a[76:79], v[80:95]
  ds_read_b128 v[156:159], v30 offset:3072
  buffer_load_dwordx4 a[132:135], v2, s[4:7], s32 offen offset:1024 sc1
  s_waitcnt vmcnt(13)
  s_waitcnt lgkmcnt(6)
  v_mfma_f32_32x32x16_bf16 v[64:79], v[128:131], a[80:83], v[64:79]
  ds_read_b128 v[128:131], v30 offset:4096
  buffer_load_dwordx4 a[136:139], v2, s[4:7], s32 offen offset:2048 sc1
  v_mfma_f32_32x32x16_bf16 v[80:95], v[132:135], a[80:83], v[80:95]
  ds_read_b128 v[132:135], v30 offset:5120
  s_waitcnt vmcnt(13)
  s_waitcnt lgkmcnt(6)
  v_mfma_f32_32x32x16_bf16 v[64:79], v[136:139], a[84:87], v[64:79]
  ds_read_b128 v[136:139], v30 offset:6144
  buffer_load_dwordx4 a[140:143], v2, s[4:7], s32 offen offset:3072 sc1
  v_mfma_f32_32x32x16_bf16 v[80:95], v[140:143], a[84:87], v[80:95]
  ds_read_b128 v[140:143], v30 offset:7168
  s_waitcnt vmcnt(13)
  s_waitcnt lgkmcnt(6)
  v_mfma_f32_32x32x16_bf16 v[64:79], v[144:147], a[88:91], v[64:79]
  ds_read_b128 v[144:147], v30 offset:8192
  s_mul_i32 s36, s22, 2048
  s_add_u32 s37, s36, s49
  s_add_u32 s37, s37, 81920
  s_add_u32 m0, s36, 110592
  v_mfma_f32_32x32x16_bf16 v[80:95], v[148:151], a[88:91], v[80:95]
  ds_read_b128 v[148:151], v30 offset:9216
  buffer_load_dwordx4 v2, s[4:7], s37 offen offset:0 sc1 lds
  s_waitcnt vmcnt(13)
  s_waitcnt lgkmcnt(6)
  v_mfma_f32_32x32x16_bf16 v[64:79], v[152:155], a[92:95], v[64:79]
  ds_read_b128 v[152:155], v30 offset:10240
  buffer_load_dwordx4 v2, s[4:7], s37 offen offset:1024 sc1 lds
  v_mfma_f32_32x32x16_bf16 v[80:95], v[156:159], a[92:95], v[80:95]
  ds_read_b128 v[156:159], v30 offset:11264
  s_waitcnt vmcnt(13)
  s_waitcnt lgkmcnt(6)
  v_mfma_f32_32x32x16_bf16 v[64:79], v[128:131], a[96:99], v[64:79]
  ds_read_b128 v[128:131], v30 offset:12288
  s_add_u32 s32, s32, 4096
  buffer_load_dwordx4 a[144:147], v2, s[4:7], s32 offen offset:0 sc1
  v_mfma_f32_32x32x16_bf16 v[80:95], v[132:135], a[96:99], v[80:95]
  ds_read_b128 v[132:135], v30 offset:13312
  s_waitcnt vmcnt(13)
  s_waitcnt lgkmcnt(6)
  v_mfma_f32_32x32x16_bf16 v[64:79], v[136:139], a[100:103], v[64:79]
  ds_read_b128 v[136:139], v30 offset:14336
  buffer_load_dwordx4 a[148:151], v2, s[4:7], s32 offen offset:1024 sc1
  v_mfma_f32_32x32x16_bf16 v[80:95], v[140:143], a[100:103], v[80:95]
  ds_read_b128 v[140:143], v30 offset:15360
  s_waitcnt vmcnt(13)
  s_waitcnt lgkmcnt(6)
  v_mfma_f32_32x32x16_bf16 v[64:79], v[144:147], a[104:107], v[64:79]
  ds_read_b128 v[144:147], v30 offset:16384
  buffer_load_dwordx4 a[152:155], v2, s[4:7], s32 offen offset:2048 sc1
  v_mfma_f32_32x32x16_bf16 v[80:95], v[148:151], a[104:107], v[80:95]
  ds_read_b128 v[148:151], v30 offset:17408
  v_add_f32 v160, v160, v162
  v_add_f32 v161, v161, v163
  v_add_f32 v164, v164, v166
  v_add_f32 v165, v165, v167
  s_waitcnt vmcnt(13)
  s_waitcnt lgkmcnt(6)
  v_mfma_f32_32x32x16_bf16 v[64:79], v[152:155], a[108:111], v[64:79]
  ds_read_b128 v[152:155], v30 offset:18432
  v_add_f32 v160, v160, v164
  v_add_f32 v161, v161, v165
  v_mov_b32 v162, v160
  v_mov_b32 v163, v161
  v_mfma_f32_32x32x16_bf16 v[80:95], v[156:159], a[108:111], v[80:95]
  ds_read_b128 v[156:159], v30 offset:19456
  v_permlane32_swap_b32 v160, v162
  v_permlane32_swap_b32 v161, v163
  v_add_f32 v160, v160, v162
  v_add_f32 v161, v161, v163
  s_waitcnt vmcnt(12)
  s_waitcnt lgkmcnt(6)
  v_mfma_f32_32x32x16_bf16 v[64:79], v[128:131], a[112:115], v[64:79]
  ds_read_b128 v[128:131], v30 offset:20480
  v_mul_f32 v168, 0xbacccccd, v160
  v_mul_f32 v161, 0x3acccccd, v161
  v_fma_f32 v161, -v168, v168, v161
  v_max_f32 v161, 0, v161
  v_mfma_f32_32x32x16_bf16 v[80:95], v[132:135], a[112:115], v[80:95]
  ds_read_b128 v[132:135], v30 offset:21504
  v_add_f32 v161, 0x3727c5ac, v161
  v_rsq_f32 v169, v161
  v_and_b32 v160, 0xffff0000, v168
  s_waitcnt vmcnt(11)
  s_waitcnt lgkmcnt(6)
  v_mfma_f32_32x32x16_bf16 v[64:79], v[136:139], a[116:119], v[64:79]
  ds_read_b128 v[136:139], v30 offset:22528
  v_sub_f32 v161, v168, v160
  v_and_b32 v172, 0xffff0000, v161
  v_sub_f32 v161, v161, v172
  v_lshrrev_b32 v160, 16, v160
  v_mfma_f32_32x32x16_bf16 v[80:95], v[140:143], a[116:119], v[80:95]
  ds_read_b128 v[140:143], v30 offset:23552
  v_and_b32 v173, 0xffff0000, v161
  v_or_b32 v172, v172, v160
  v_or_b32 v173, v173, v160
  v_mov_b32 v174, v172
  s_waitcnt vmcnt(10)
  s_waitcnt lgkmcnt(6)
  v_mfma_f32_32x32x16_bf16 v[64:79], v[144:147], a[120:123], v[64:79]
  ds_read_b128 v[144:147], v30 offset:24576
  v_mov_b32 v175, 0
  buffer_load_dwordx4 a[156:159], v2, s[4:7], s32 offen offset:3072 sc1
  v_mfma_f32_32x32x16_bf16 v[80:95], v[148:151], a[120:123], v[80:95]
  ds_read_b128 v[148:151], v30 offset:25600
  s_mul_i32 s36, s22, 2048
  s_add_u32 s37, s36, s49
  s_add_u32 s37, s37, 90112
  s_add_u32 m0, s36, 118784
  s_waitcnt vmcnt(10)
  s_waitcnt lgkmcnt(6)
  v_mfma_f32_32x32x16_bf16 v[64:79], v[152:155], a[124:127], v[64:79]
  ds_read_b128 v[152:155], v30 offset:26624
  buffer_load_dwordx4 v2, s[4:7], s37 offen offset:0 sc1 lds
  v_mfma_f32_32x32x16_bf16 v[80:95], v[156:159], a[124:127], v[80:95]
  ds_read_b128 v[156:159], v30 offset:27648
  buffer_load_dwordx4 v2, s[4:7], s37 offen offset:1024 sc1 lds
  s_mul_i32 s36, s22, 2048
  s_waitcnt vmcnt(11)
  s_waitcnt lgkmcnt(6)
  v_mfma_f32_32x32x16_bf16 v[64:79], v[128:131], a[128:131], v[64:79]
  ds_read_b128 v[128:131], v30 offset:28672
  s_add_u32 s37, s36, s49
  s_add_u32 s37, s37, 98304
  s_add_u32 m0, s36, 126976
  v_mfma_f32_32x32x16_bf16 v[80:95], v[132:135], a[128:131], v[80:95]
  ds_read_b128 v[132:135], v30 offset:29696
  buffer_load_dwordx4 v2, s[4:7], s37 offen offset:0 sc1 lds
  s_waitcnt vmcnt(11)
  s_waitcnt lgkmcnt(6)
  v_mfma_f32_32x32x16_bf16 v[64:79], v[136:139], a[132:135], v[64:79]
  ds_read_b128 v[136:139], v30 offset:30720
  buffer_load_dwordx4 v2, s[4:7], s37 offen offset:1024 sc1 lds
  s_mul_i32 s36, s22, 2048
  v_mfma_f32_32x32x16_bf16 v[80:95], v[140:143], a[132:135], v[80:95]
  ds_read_b128 v[140:143], v30 offset:31744
  s_add_u32 s37, s36, s49
  s_add_u32 s37, s37, 106496
  s_add_u32 m0, s36, 135168
  s_waitcnt vmcnt(11)
  s_waitcnt lgkmcnt(6)
  v_mfma_f32_32x32x16_bf16 v[64:79], v[144:147], a[136:139], v[64:79]
  ds_read_b128 v[144:147], v30 offset:32768
  buffer_load_dwordx4 v2, s[4:7], s37 offen offset:0 sc1 lds
  v_mfma_f32_32x32x16_bf16 v[80:95], v[148:151], a[136:139], v[80:95]
  ds_read_b128 v[148:151], v30 offset:33792
  buffer_load_dwordx4 v2, s[4:7], s37 offen offset:1024 sc1 lds
  s_mul_i32 s36, s22, 2048
  s_waitcnt vmcnt(12)
  s_waitcnt lgkmcnt(6)
  v_mfma_f32_32x32x16_bf16 v[64:79], v[152:155], a[140:143], v[64:79]
  ds_read_b128 v[152:155], v30 offset:34816
  s_add_u32 s37, s36, s49
  s_add_u32 s37, s37, 114688
  s_add_u32 m0, s36, 45056
  v_mfma_f32_32x32x16_bf16 v[80:95], v[156:159], a[140:143], v[80:95]
  ds_read_b128 v[156:159], v30 offset:35840
  buffer_load_dwordx4 v2, s[4:7], s37 offen offset:0 sc1 lds
  s_waitcnt vmcnt(11)
  s_barrier
  s_waitcnt vmcnt(10)
  s_waitcnt lgkmcnt(6)
  v_mfma_f32_32x32x16_bf16 v[64:79], v[128:131], a[144:147], v[64:79]
  ds_read_b128 v[128:131], v30 offset:45056
  buffer_load_dwordx4 v2, s[4:7], s37 offen offset:1024 sc1 lds
  s_mul_i32 s36, s22, 2048
  v_mfma_f32_32x32x16_bf16 v[80:95], v[132:135], a[144:147], v[80:95]
  ds_read_b128 v[132:135], v30 offset:46080
  s_add_u32 s37, s36, s49
  s_add_u32 s37, s37, 122880
  s_add_u32 m0, s36, 0
  s_waitcnt vmcnt(10)
  s_waitcnt lgkmcnt(6)
  v_mfma_f32_32x32x16_bf16 v[64:79], v[136:139], a[148:151], v[64:79]
  ds_read_b128 v[136:139], v30 offset:47104
  buffer_load_dwordx4 v2, s[4:7], s37 offen offset:0 sc1 lds
  v_mfma_f32_32x32x16_bf16 v[80:95], v[140:143], a[148:151], v[80:95]
  ds_read_b128 v[140:143], v30 offset:48128
  buffer_load_dwordx4 v2, s[4:7], s37 offen offset:1024 sc1 lds
  s_mul_i32 s36, s22, 2048
  s_waitcnt vmcnt(11)
  s_waitcnt lgkmcnt(6)
  v_mfma_f32_32x32x16_bf16 v[64:79], v[144:147], a[152:155], v[64:79]
  ds_read_b128 v[144:147], v30 offset:49152
  s_add_u32 s37, s36, s49
  s_add_u32 s37, s37, 131072
  s_add_u32 m0, s36, 8192
  v_mfma_f32_32x32x16_bf16 v[80:95], v[148:151], a[152:155], v[80:95]
  ds_read_b128 v[148:151], v31 offset:16384
  buffer_load_dwordx4 v2, s[4:7], s37 offen offset:0 sc1 lds
  s_waitcnt vmcnt(11)
  s_waitcnt lgkmcnt(6)
  v_mfma_f32_32x32x16_bf16 v[64:79], v[152:155], a[156:159], v[64:79]
  ds_read_b128 v[152:155], v31 offset:17408
  buffer_load_dwordx4 v2, s[4:7], s37 offen offset:1024 sc1 lds
  s_mul_i32 s36, s22, 2048
  v_mfma_f32_32x32x16_bf16 v[80:95], v[156:159], a[156:159], v[80:95]
  ds_read_b128 v[156:159], v30 offset:50176
  s_add_u32 s37, s36, s49
  s_add_u32 s37, s37, 139264
  s_add_u32 m0, s36, 20480
  s_nop 0
  buffer_load_dwordx4 v2, s[4:7], s37 offen offset:0 sc1 lds
  buffer_load_dwordx4 v2, s[4:7], s37 offen offset:1024 sc1 lds
  s_waitcnt vmcnt(12)
  s_barrier
  s_waitcnt lgkmcnt(6)
  v_mfma_f32_32x32x16_bf16 v[96:111], v[128:131], a[0:3], 0
  ds_read_b128 v[128:131], v30 offset:51200
  v_mfma_f32_32x32x16_bf16 v[96:111], v[132:135], a[4:7], v[96:111]
  ds_read_b128 v[132:135], v30 offset:52224
  s_waitcnt lgkmcnt(6)
  v_mfma_f32_32x32x16_bf16 v[96:111], v[136:139], a[8:11], v[96:111]
  ds_read_b128 v[136:139], v30 offset:53248
  s_mul_i32 s36, s22, 2048
  s_add_u32 s37, s36, s49
  s_add_u32 s37, s37, 147456
  s_add_u32 m0, s36, 28672
  v_mfma_f32_32x32x16_bf16 v[96:111], v[140:143], a[12:15], v[96:111]
  ds_read_b128 v[140:143], v30 offset:54272
  buffer_load_dwordx4 v2, s[4:7], s37 offen offset:0 sc1 lds
  s_waitcnt lgkmcnt(6)
  v_mfma_f32_32x32x16_bf16 v[96:111], v[144:147], a[16:19], v[96:111]
  ds_read_b128 v[144:147], v30 offset:55296
  buffer_load_dwordx4 v2, s[4:7], s37 offen offset:1024 sc1 lds
  v_mfma_f32_32x32x16_bf16 v[64:79], v[148:151], v[172:175], v[64:79]
  ds_read_b128 v[148:151], v30 offset:56320
  s_waitcnt lgkmcnt(6)
  v_mfma_f32_32x32x16_bf16 v[80:95], v[152:155], v[172:175], v[80:95]
  ds_read_b128 v[152:155], v30 offset:57344
  v_mfma_f32_32x32x16_bf16 v[96:111], v[156:159], a[20:23], v[96:111]
  ds_read_b128 v[156:159], v30 offset:58368
  s_waitcnt lgkmcnt(6)
  v_mfma_f32_32x32x16_bf16 v[96:111], v[128:131], a[24:27], v[96:111]
  ds_read_b128 v[128:131], v30 offset:59392
  s_add_u32 s32, s40, s44
  s_mul_i32 s33, s22, 2560
  s_add_u32 s33, s33, s32
  s_mul_i32 s34, s22, 3328
  s_add_u32 s35, s34, 94208
  v_mfma_f32_32x32x16_bf16 v[96:111], v[132:135], a[28:31], v[96:111]
  ds_read_b128 v[132:135], v30 offset:60416
  s_mul_i32 s36, s22, 2048
  s_add_u32 s37, s36, s49
  s_add_u32 s37, s37, 155648
  s_add_u32 m0, s36, 36864
  s_waitcnt vmcnt(12)
  s_barrier
  s_waitcnt lgkmcnt(6)
  v_mfma_f32_32x32x16_bf16 v[96:111], v[136:139], a[32:35], v[96:111]
  ds_read_b128 v[136:139], v30 offset:61440
  buffer_load_dwordx4 v2, s[4:7], s37 offen offset:0 sc1 lds
  s_add_u32 s34, s34, s32
  s_add_u32 s34, s34, 10240
  v_mfma_f32_32x32x16_bf16 v[96:111], v[140:143], a[36:39], v[96:111]
  ds_read_b128 v[140:143], v30 offset:62464
  buffer_load_dwordx4 v2, s[4:7], s37 offen offset:1024 sc1 lds
  v_add_u32 v187, s35, v2
  v_lshlrev_b32 v186, 3, v1
  s_waitcnt lgkmcnt(6)
  v_mfma_f32_32x32x16_bf16 v[96:111], v[144:147], a[40:43], v[96:111]
  ds_read_b128 v[144:147], v30 offset:63488
  v_mov_b32 v218, 0x3f803f80
  v_mov_b32 v219, 0x3f803f80
  ds_write_b64 v27, v[218:219] offset:160
  v_mfma_f32_32x32x16_bf16 v[96:111], v[148:151], a[44:47], v[96:111]
  ds_read_b128 v[148:151], v30 offset:64512
  v_mul_f32 v170, 0x3ea52b5c, v169
  v_mul_f32 v64, v169, v64
  v_mul_f32 v65, v169, v65
  v_mul_f32 v66, v169, v66
  v_mul_f32 v67, v169, v67
  s_waitcnt lgkmcnt(7)
  v_mfma_f32_32x32x16_bf16 v[96:111], v[152:155], a[48:51], v[96:111]
  ds_read_b128 v[152:155], v31 offset:0
  v_cvt_pk_bf16_f32 v208, v64, v65
  v_cvt_pk_bf16_f32 v209, v66, v67
  ds_write_b64 v25, v[208:209] offset:32
  v_mfma_f32_32x32x16_bf16 v[96:111], v[156:159], a[52:55], v[96:111]
  ds_read_b128 v[156:159], v31 offset:1024
  v_mul_f32 v68, v169, v68
  v_mul_f32 v69, v169, v69
  v_mul_f32 v70, v169, v70
  v_mul_f32 v71, v169, v71
  v_cvt_pk_bf16_f32 v210, v68, v69
  s_waitcnt lgkmcnt(8)
  v_mfma_f32_32x32x16_bf16 v[96:111], v[128:131], a[56:59], v[96:111]
  ds_read_b128 v[128:131], v31 offset:2048
  v_cvt_pk_bf16_f32 v211, v70, v71
  ds_write_b64 v25, v[210:211] offset:64
  v_mul_f32 v72, v169, v72
  v_mfma_f32_32x32x16_bf16 v[96:111], v[132:135], a[60:63], v[96:111]
  ds_read_b128 v[132:135], v31 offset:3072
  v_mul_f32 v73, v169, v73
  v_mul_f32 v74, v169, v74
  v_mul_f32 v75, v169, v75
  v_cvt_pk_bf16_f32 v212, v72, v73
  v_cvt_pk_bf16_f32 v213, v74, v75
  s_waitcnt vmcnt(12)
  s_barrier
  s_waitcnt lgkmcnt(9)
  v_mfma_f32_32x32x16_bf16 v[96:111], v[136:139], a[64:67], v[96:111]
  ds_read_b128 v[136:139], v31 offset:4096
  ds_write_b64 v26, v[212:213] offset:0
  v_mul_f32 v76, v169, v76
  v_mul_f32 v77, v169, v77
  v_mfma_f32_32x32x16_bf16 v[96:111], v[140:143], a[68:71], v[96:111]
  ds_read_b128 v[140:143], v31 offset:5120
  v_mul_f32 v78, v169, v78
  v_mul_f32 v79, v169, v79
  v_cvt_pk_bf16_f32 v214, v76, v77
  v_cvt_pk_bf16_f32 v215, v78, v79
  s_waitcnt lgkmcnt(9)
  v_mfma_f32_32x32x16_bf16 v[96:111], v[144:147], a[72:75], v[96:111]
  ds_read_b128 v[144:147], v31 offset:6144
  ds_write_b64 v25, v[214:215] offset:224
  v_mul_f32 v80, v169, v80
  v_mul_f32 v81, v169, v81
  v_mfma_f32_32x32x16_bf16 v[96:111], v[148:151], a[76:79], v[96:111]
  ds_read_b128 v[148:151], v31 offset:7168
  v_mul_f32 v82, v169, v82
  v_mul_f32 v83, v169, v83
  v_cvt_pk_bf16_f32 v216, v80, v81
  v_cvt_pk_bf16_f32 v217, v82, v83
  s_waitcnt lgkmcnt(9)
  v_mfma_f32_32x32x16_bf16 v[96:111], v[152:155], a[80:83], v[96:111]
  ds_read_b128 v[152:155], v31 offset:8192
  ds_write_b64 v25, v[216:217] offset:256
  v_mul_f32 v88, v169, v88
  v_mul_f32 v89, v169, v89
  v_mfma_f32_32x32x16_bf16 v[96:111], v[156:159], a[84:87], v[96:111]
  ds_read_b128 v[156:159], v31 offset:9216
  v_mul_f32 v90, v169, v90
  v_mul_f32 v91, v169, v91
  v_cvt_pk_bf16_f32 v176, v88, v89
  v_cvt_pk_bf16_f32 v177, v90, v91
  s_waitcnt lgkmcnt(1)
  v_mfma_f32_32x32x16_bf16 v[96:111], v[128:131], a[88:91], v[96:111]
  ds_read_b128 v[128:131], v31 offset:10240
  ds_read_b128 v[192:195], v187 offset:0
  ds_read_b128 v[196:199], v187 offset:1024
  ds_read_b128 v[200:203], v187 offset:2048
  ds_read_b128 v[204:207], v187 offset:3072
  v_mul_f32 v92, v169, v92
  v_mfma_f32_32x32x16_bf16 v[96:111], v[132:135], a[92:95], v[96:111]
  ds_read_b128 v[132:135], v31 offset:11264
  v_mul_f32 v93, v169, v93
  v_mul_f32 v94, v169, v94
  v_mul_f32 v95, v169, v95
  v_cvt_pk_bf16_f32 v178, v92, v93
  v_cvt_pk_bf16_f32 v179, v94, v95
  s_waitcnt vmcnt(10)
  s_barrier
  v_mfma_f32_32x32x16_bf16 v[96:111], v[136:139], a[96:99], v[96:111]
  ds_read_b128 v[136:139], v2 offset:45056
  buffer_store_dwordx4 v[176:179], v2, s[4:7], s33 offen sc1
  v_mfma_f32_32x32x16_bf16 v[96:111], v[140:143], a[100:103], v[96:111]
  ds_read_b128 v[140:143], v2 offset:46080
  ds_write_b128 v22, v[176:179] offset:20480
  s_waitcnt lgkmcnt(7)
  v_mfma_f32_32x32x16_bf16 v[96:111], v[144:147], a[104:107], v[96:111]
  ds_read_b128 v[144:147], v2 offset:47104
  buffer_store_dwordx4 v[192:195], v2, s[4:7], s34 offen offset:0 sc1
  v_mfma_f32_32x32x16_bf16 v[96:111], v[148:151], a[108:111], v[96:111]
  ds_read_b128 v[148:151], v2 offset:48128
  s_waitcnt lgkmcnt(8)
  v_mfma_f32_32x32x16_bf16 v[96:111], v[152:155], a[112:115], v[96:111]
  ds_read_b128 v[152:155], v2 offset:49152
  buffer_store_dwordx4 v[196:199], v2, s[4:7], s34 offen offset:1024 sc1
  v_mfma_f32_32x32x16_bf16 v[96:111], v[156:159], a[116:119], v[96:111]
  ds_read_b128 v[156:159], v2 offset:50176
  s_waitcnt lgkmcnt(9)
  s_waitcnt lgkmcnt(7)
  v_mfma_f32_32x32x16_bf16 v[96:111], v[128:131], a[120:123], v[96:111]
  ds_read_b128 v[128:131], v2 offset:51200
  buffer_store_dwordx4 v[200:203], v2, s[4:7], s34 offen offset:2048 sc1
  v_mfma_f32_32x32x16_bf16 v[96:111], v[132:135], a[124:127], v[96:111]
  ds_read_b128 v[132:135], v2 offset:52224
  s_waitcnt vmcnt(12)
  s_barrier
  s_waitcnt lgkmcnt(7)
  v_mfma_f32_32x32x16_bf16 v[96:111], v[136:139], a[128:131], v[96:111]
  ds_read_b128 v[136:139], v31 offset:18432
  s_mov_b64 exec, 0xffff
  buffer_store_dwordx4 v[204:207], v2, s[4:7], s34 offen offset:3072 sc1
  s_mov_b64 exec, -1
  v_mfma_f32_32x32x16_bf16 v[96:111], v[140:143], a[132:135], v[96:111]
  ds_read_b128 v[140:143], v2 offset:0
  s_waitcnt lgkmcnt(6)
  v_mfma_f32_32x32x16_bf16 v[96:111], v[144:147], a[136:139], v[96:111]
  ds_read_b128 v[144:147], v2 offset:1024
  v_mfma_f32_32x32x16_bf16 v[96:111], v[148:151], a[140:143], v[96:111]
  ds_read_b128 v[148:151], v2 offset:2048
  s_waitcnt lgkmcnt(6)
  v_mfma_f32_32x32x16_bf16 v[96:111], v[152:155], a[144:147], v[96:111]
  ds_read_b128 v[152:155], v2 offset:3072
  v_mfma_f32_32x32x16_bf16 v[96:111], v[156:159], a[148:151], v[96:111]
  ds_read_b128 v[156:159], v2 offset:4096
  s_waitcnt lgkmcnt(6)
  v_mfma_f32_32x32x16_bf16 v[96:111], v[128:131], a[152:155], v[96:111]
  ds_read_b128 v[128:131], v2 offset:5120
  v_mfma_f32_32x32x16_bf16 v[96:111], v[132:135], a[156:159], v[96:111]
  ds_read_b128 v[132:135], v2 offset:6144
  s_waitcnt lgkmcnt(6)
  v_mfma_f32_32x32x16_bf16 v[96:111], v[136:139], v[172:175], v[96:111]
  ds_read_b128 v[136:139], v2 offset:7168
  s_waitcnt vmcnt(11)
  s_barrier
  v_mfma_f32_32x32x16_bf16 v[112:127], v[140:143], a[0:3], 0
  ds_read_b128 v[140:143], v2 offset:8192
  s_waitcnt lgkmcnt(6)
  v_mfma_f32_32x32x16_bf16 v[112:127], v[144:147], a[4:7], v[112:127]
  ds_read_b128 v[144:147], v2 offset:9216
  v_mfma_f32_32x32x16_bf16 v[112:127], v[148:151], a[8:11], v[112:127]
  ds_read_b128 v[148:151], v2 offset:10240
  s_nop 1
  v_mul_f32 v100, v169, v100
  v_mul_f32 v101, v169, v101
  v_mul_f32 v102, v169, v102
  v_mul_f32 v103, v169, v103
  v_cvt_pk_bf16_f32 v180, v100, v101
  v_cvt_pk_bf16_f32 v181, v102, v103
  s_waitcnt lgkmcnt(6)
  v_mfma_f32_32x32x16_bf16 v[112:127], v[152:155], a[12:15], v[112:127]
  ds_read_b128 v[152:155], v2 offset:11264
  v_mul_f32 v104, v169, v104
  v_mul_f32 v105, v169, v105
  v_mul_f32 v106, v169, v106
  v_mul_f32 v107, v169, v107
  v_cvt_pk_bf16_f32 v182, v104, v105
  v_cvt_pk_bf16_f32 v183, v106, v107
  v_mfma_f32_32x32x16_bf16 v[112:127], v[156:159], a[16:19], v[112:127]
  ds_read_b128 v[156:159], v2 offset:12288
  buffer_store_dwordx4 v[180:183], v2, s[4:7], s33 offen offset:1024 sc1
  v_mul_f32 v96, v169, v96
  s_waitcnt lgkmcnt(6)
  v_mfma_f32_32x32x16_bf16 v[112:127], v[128:131], a[20:23], v[112:127]
  ds_read_b128 v[128:131], v2 offset:13312
  v_mul_f32 v97, v169, v97
  v_mul_f32 v98, v169, v98
  v_mul_f32 v99, v169, v99
  v_cvt_pk_bf16_f32 v184, v96, v97
  v_cvt_pk_bf16_f32 v185, v98, v99
  v_mfma_f32_32x32x16_bf16 v[112:127], v[132:135], a[24:27], v[112:127]
  ds_read_b128 v[132:135], v2 offset:14336
  buffer_store_dwordx2 v[184:185], v186, s[4:7], s33 offen offset:2048 sc1
  s_waitcnt lgkmcnt(6)
  v_mfma_f32_32x32x16_bf16 v[112:127], v[136:139], a[28:31], v[112:127]
  ds_read_b128 v[136:139], v2 offset:15360
  ds_write_b128 v22, v[180:183] offset:21504
  s_waitcnt vmcnt(11)
  s_barrier
  v_mfma_f32_32x32x16_bf16 v[112:127], v[140:143], a[32:35], v[112:127]
  ds_read_b128 v[140:143], v2 offset:20480
  ds_write_b64 v23, v[184:185] offset:20480
  v_mul_f32 v108, v170, v108
  v_mul_f32 v109, v170, v109
  v_mul_f32 v110, v170, v110
  s_waitcnt lgkmcnt(8)
  v_mfma_f32_32x32x16_bf16 v[112:127], v[144:147], a[36:39], v[112:127]
  ds_read_b128 v[144:147], v2 offset:21504
  v_mul_f32 v111, v170, v111
  v_cvt_pk_bf16_f32 v224, v108, v109
  v_cvt_pk_bf16_f32 v225, v110, v111
  v_mov_b32 v234, 0
  v_mov_b32 v235, 0
  v_mov_b32 v238, 0
  v_mfma_f32_32x32x16_bf16 v[112:127], v[148:151], a[40:43], v[112:127]
  ds_read_b128 v[148:151], v2 offset:22528
  v_mov_b32 v239, 0
  s_waitcnt lgkmcnt(8)
  v_mfma_f32_32x32x16_bf16 v[112:127], v[152:155], a[44:47], v[112:127]
  ds_read_b128 v[152:155], v2 offset:23552
  v_mfma_f32_32x32x16_bf16 v[112:127], v[156:159], a[48:51], v[112:127]
  ds_read_b128 v[156:159], v2 offset:24576
  s_waitcnt lgkmcnt(8)
  v_mfma_f32_32x32x16_bf16 v[112:127], v[128:131], a[52:55], v[112:127]
  ds_read_b128 v[128:131], v2 offset:25600
  v_mfma_f32_32x32x16_bf16 v[112:127], v[132:135], a[56:59], v[112:127]
  ds_read_b128 v[132:135], v2 offset:26624
  s_waitcnt lgkmcnt(7)
  v_mfma_f32_32x32x16_bf16 v[112:127], v[136:139], a[60:63], v[112:127]
  ds_read_b128 v[136:139], v2 offset:27648
  s_waitcnt vmcnt(9)
  s_barrier
  v_mfma_f32_32x32x16_bf16 v[112:127], v[140:143], a[64:67], v[112:127]
  ds_read_b128 v[140:143], v2 offset:28672
  s_mul_i32 s36, s22, 8192
  s_add_u32 s37, s36, s50
  s_add_u32 s37, s37, 30720
  s_add_u32 m0, s36, 107520
  s_waitcnt lgkmcnt(6)
  v_mfma_f32_32x32x16_bf16 v[112:127], v[144:147], a[68:71], v[112:127]
  ds_read_b128 v[144:147], v2 offset:29696
  buffer_load_dwordx4 v2, s[4:7], s37 offen offset:0 sc1 lds
  v_mfma_f32_32x32x16_bf16 v[112:127], v[148:151], a[72:75], v[112:127]
  ds_read_b128 v[148:151], v2 offset:30720
  buffer_load_dwordx4 v2, s[4:7], s37 offen offset:1024 sc1 lds
  s_waitcnt lgkmcnt(6)
  v_mfma_f32_32x32x16_bf16 v[112:127], v[152:155], a[76:79], v[112:127]
  ds_read_b128 v[152:155], v2 offset:31744
  v_mfma_f32_32x32x16_bf16 v[112:127], v[156:159], a[80:83], v[112:127]
  ds_read_b128 v[156:159], v2 offset:32768
  buffer_load_dwordx4 v2, s[4:7], s37 offen offset:2048 sc1 lds
  s_waitcnt lgkmcnt(6)
  v_mfma_f32_32x32x16_bf16 v[112:127], v[128:131], a[84:87], v[112:127]
  ds_read_b128 v[128:131], v2 offset:33792
  v_mfma_f32_32x32x16_bf16 v[112:127], v[132:135], a[88:91], v[112:127]
  ds_read_b128 v[132:135], v2 offset:34816
  s_waitcnt lgkmcnt(6)
  v_mfma_f32_32x32x16_bf16 v[112:127], v[136:139], a[92:95], v[112:127]
  ds_read_b128 v[136:139], v2 offset:35840
  buffer_load_dwordx4 v2, s[4:7], s37 offen offset:3072 sc1 lds
  s_waitcnt vmcnt(11)
  s_barrier
  v_mfma_f32_32x32x16_bf16 v[112:127], v[140:143], a[96:99], v[112:127]
  ds_read_b128 v[140:143], v2 offset:36864
  s_waitcnt lgkmcnt(6)
  v_mfma_f32_32x32x16_bf16 v[112:127], v[144:147], a[100:103], v[112:127]
  ds_read_b128 v[144:147], v2 offset:37888
  s_add_u32 s37, s37, 4096
  s_add_u32 m0, m0, 4096
  v_mfma_f32_32x32x16_bf16 v[112:127], v[148:151], a[104:107], v[112:127]
  ds_read_b128 v[148:151], v2 offset:38912
  buffer_load_dwordx4 v2, s[4:7], s37 offen offset:0 sc1 lds
  s_waitcnt lgkmcnt(6)
  v_mfma_f32_32x32x16_bf16 v[112:127], v[152:155], a[108:111], v[112:127]
  ds_read_b128 v[152:155], v2 offset:39936
  v_mfma_f32_32x32x16_bf16 v[112:127], v[156:159], a[112:115], v[112:127]
  ds_read_b128 v[156:159], v2 offset:40960
  buffer_load_dwordx4 v2, s[4:7], s37 offen offset:1024 sc1 lds
  s_waitcnt lgkmcnt(6)
  v_mfma_f32_32x32x16_bf16 v[112:127], v[128:131], a[116:119], v[112:127]
  ds_read_b128 v[128:131], v2 offset:41984
  v_mfma_f32_32x32x16_bf16 v[112:127], v[132:135], a[120:123], v[112:127]
  ds_read_b128 v[132:135], v2 offset:43008
  buffer_load_dwordx4 v2, s[4:7], s37 offen offset:2048 sc1 lds
  s_waitcnt lgkmcnt(6)
  v_mfma_f32_32x32x16_bf16 v[112:127], v[136:139], a[124:127], v[112:127]
  ds_read_b128 v[136:139], v2 offset:44032
  v_mfma_f32_32x32x16_bf16 v[112:127], v[140:143], a[128:131], v[112:127]
  ds_read_b128 v[140:143], v31 offset:19456
  s_waitcnt lgkmcnt(6)
  v_mfma_f32_32x32x16_bf16 v[112:127], v[144:147], a[132:135], v[112:127]
  buffer_load_dwordx4 v2, s[4:7], s37 offen offset:3072 sc1 lds
  v_mfma_f32_32x32x16_bf16 v[112:127], v[148:151], a[136:139], v[112:127]
  s_waitcnt lgkmcnt(4)
  v_mfma_f32_32x32x16_bf16 v[112:127], v[152:155], a[140:143], v[112:127]
  v_mfma_f32_32x32x16_bf16 v[112:127], v[156:159], a[144:147], v[112:127]
  s_waitcnt lgkmcnt(2)
  v_mfma_f32_32x32x16_bf16 v[112:127], v[128:131], a[148:151], v[112:127]
  v_mfma_f32_32x32x16_bf16 v[112:127], v[132:135], a[152:155], v[112:127]
  s_waitcnt lgkmcnt(0)
  v_mfma_f32_32x32x16_bf16 v[112:127], v[136:139], a[156:159], v[112:127]
  v_mfma_f32_32x32x16_bf16 v[112:127], v[140:143], v[172:175], v[112:127]
  s_waitcnt vmcnt(8)
  s_waitcnt lgkmcnt(0)
  s_branch main_layer
main_final:
  s_xor_b32 s3, s22, 1
  s_mul_i32 s3, s3, 5120
  s_add_u32 s3, s3, 0
  v_and_b32 v44, 15, v1
  v_mul_u32_u24 v44, 176, v44
  v_lshrrev_b32 v45, 4, v1
  v_lshl_add_u32 v44, v45, 3, v44
  v_add_u32 v44, s3, v44
  v_add_u32 v45, 0, v1
  v_mul_u32_u24 v46, 6554, v45
  v_lshrrev_b32 v46, 16, v46
  v_mul_u32_u24 v47, 10, v46
  v_sub_u32 v47, v45, v47
  v_lshlrev_b32 v47, 4, v47
  v_mul_u32_u24 v48, 176, v46
  v_add3_u32 v48, v48, v47, s3
  v_mul_u32_u24 v52, 1280, v46
  v_add_u32 v52, v52, v47
  v_add_u32 v45, 64, v1
  v_mul_u32_u24 v46, 6554, v45
  v_lshrrev_b32 v46, 16, v46
  v_mul_u32_u24 v47, 10, v46
  v_sub_u32 v47, v45, v47
  v_lshlrev_b32 v47, 4, v47
  v_mul_u32_u24 v49, 176, v46
  v_add3_u32 v49, v49, v47, s3
  v_mul_u32_u24 v53, 1280, v46
  v_add_u32 v53, v53, v47
  v_add_u32 v45, 128, v1
  v_mul_u32_u24 v46, 6554, v45
  v_lshrrev_b32 v46, 16, v46
  v_mul_u32_u24 v47, 10, v46
  v_sub_u32 v47, v45, v47
  v_lshlrev_b32 v47, 4, v47
  v_mul_u32_u24 v50, 176, v46
  v_add3_u32 v50, v50, v47, s3
  v_mul_u32_u24 v54, 1280, v46
  v_add_u32 v54, v54, v47
  s_lshl_b32 s32, s45, 4
  s_mul_i32 s32, s32, 1280
  s_mul_i32 s33, s25, 160
  s_add_u32 s32, s32, s33
  s_waitcnt lgkmcnt(0)
  v_pk_add_f32 v[64:65], v[64:65], v[84:85]
  v_pk_add_f32 v[66:67], v[66:67], v[86:87]
  v_cvt_pk_bf16_f32 v4, v64, v65
  v_cvt_pk_bf16_f32 v5, v66, v67
  ds_write_b64 v44, v[4:5] offset:0
  v_pk_add_f32 v[68:69], v[68:69], v[88:89]
  v_pk_add_f32 v[70:71], v[70:71], v[90:91]
  v_cvt_pk_bf16_f32 v6, v68, v69
  v_cvt_pk_bf16_f32 v7, v70, v71
  ds_write_b64 v44, v[6:7] offset:32
  v_pk_add_f32 v[72:73], v[72:73], v[92:93]
  v_pk_add_f32 v[74:75], v[74:75], v[94:95]
  v_cvt_pk_bf16_f32 v8, v72, v73
  v_cvt_pk_bf16_f32 v9, v74, v75
  ds_write_b64 v44, v[8:9] offset:64
  v_pk_add_f32 v[76:77], v[76:77], v[96:97]
  v_pk_add_f32 v[78:79], v[78:79], v[98:99]
  v_cvt_pk_bf16_f32 v10, v76, v77
  v_cvt_pk_bf16_f32 v11, v78, v79
  ds_write_b64 v44, v[10:11] offset:96
  v_pk_add_f32 v[80:81], v[80:81], v[100:101]
  v_pk_add_f32 v[82:83], v[82:83], v[102:103]
  v_cvt_pk_bf16_f32 v12, v80, v81
  v_cvt_pk_bf16_f32 v13, v82, v83
  ds_write_b64 v44, v[12:13] offset:128
  s_waitcnt lgkmcnt(0)
  ds_read_b128 v[112:115], v48
  ds_read_b128 v[116:119], v49
  ds_read_b128 v[120:123], v50
  s_waitcnt lgkmcnt(2)
  buffer_store_dwordx4 v[112:115], v52, s[12:15], s32 offen nt
  s_waitcnt lgkmcnt(1)
  buffer_store_dwordx4 v[116:119], v53, s[12:15], s32 offen nt
  s_waitcnt lgkmcnt(0)
  s_mov_b32 exec_hi, 0
  buffer_store_dwordx4 v[120:123], v54, s[12:15], s32 offen nt
  s_mov_b32 exec_hi, -1
main_done:
main_end:
  s_endpgm
main_slow:
  s_lshl_b32 s29, s20, 2
  s_add_u32 s29, s29, s22
  s_min_u32 s29, s29, 8
  s_sub_u32 s29, 8, s29
  v_mov_b32 v68, 0xff800000
  v_mov_b32 v64, v68
  s_mov_b32 s28, s29
main_max0:
  s_mul_i32 s3, s28, 2560
  v_add_u32 v65, s3, v22
  v_add_u32 v66, s3, v23
  s_mul_i32 s3, s28, 3328
  v_add_u32 v67, s3, v24
  ds_read_b64 v[162:163], v66
  ds_read_b128 v[164:167], v65
  ds_read_b128 v[168:171], v65 offset:1024
  s_waitcnt lgkmcnt(0)
  v_mfma_f32_32x32x16_bf16 v[48:63], v[164:167], v[224:227], 0
  v_mfma_f32_32x32x16_bf16 v[48:63], v[162:165], v[232:235], v[48:63]
  s_nop 15
  s_cmp_lg_u32 s28, 0
  s_cbranch_scc1 main_m0_a
  v_cndmask_b32 v48, v48, v68, s[64:65]
  v_cndmask_b32 v49, v49, v68, s[66:67]
  v_cndmask_b32 v50, v50, v68, s[68:69]
  v_cndmask_b32 v51, v51, v68, s[70:71]
  v_cndmask_b32 v52, v52, v68, s[72:73]
  v_cndmask_b32 v53, v53, v68, s[74:75]
  v_cndmask_b32 v54, v54, v68, s[76:77]
  v_cndmask_b32 v55, v55, v68, s[78:79]
  v_cndmask_b32 v56, v56, v68, s[80:81]
  v_cndmask_b32 v57, v57, v68, s[82:83]
  v_cndmask_b32 v58, v58, v68, s[84:85]
  v_cndmask_b32 v59, v59, v68, s[86:87]
  v_cndmask_b32 v60, v60, v68, s[88:89]
  v_cndmask_b32 v61, v61, v68, s[90:91]
  v_cndmask_b32 v62, v62, v68, s[92:93]
  v_cndmask_b32 v63, v63, v68, s[94:95]
main_m0_a:
  s_cmp_lg_u32 s28, 8
  s_cbranch_scc1 main_m0_b
  v_cndmask_b32 v48, v68, v48, s[64:65]
  v_cndmask_b32 v49, v68, v49, s[66:67]
  v_cndmask_b32 v50, v68, v50, s[68:69]
  v_cndmask_b32 v51, v68, v51, s[70:71]
  v_cndmask_b32 v52, v68, v52, s[72:73]
  v_cndmask_b32 v53, v68, v53, s[74:75]
  v_cndmask_b32 v54, v68, v54, s[76:77]
  v_cndmask_b32 v55, v68, v55, s[78:79]
  v_cndmask_b32 v56, v68, v56, s[80:81]
  v_cndmask_b32 v57, v68, v57, s[82:83]
  v_cndmask_b32 v58, v68, v58, s[84:85]
  v_cndmask_b32 v59, v68, v59, s[86:87]
  v_cndmask_b32 v60, v68, v60, s[88:89]
  v_cndmask_b32 v61, v68, v61, s[90:91]
  v_cndmask_b32 v62, v68, v62, s[92:93]
  v_cndmask_b32 v63, v68, v63, s[94:95]
main_m0_b:
  v_max3_f32 v64, v64, v48, v49
  v_max3_f32 v64, v64, v50, v51
  v_max3_f32 v64, v64, v52, v53
  v_max3_f32 v64, v64, v54, v55
  v_max3_f32 v64, v64, v56, v57
  v_max3_f32 v64, v64, v58, v59
  v_max3_f32 v64, v64, v60, v61
  v_max3_f32 v64, v64, v62, v63
  s_add_u32 s28, s28, 1
  s_cmp_le_u32 s28, 8
  s_cbranch_scc1 main_max0
  v_mov_b32 v69, v64
  s_nop 1
  v_permlane32_swap_b32 v64, v69
  v_max_f32 v64, v64, v69
  v_sub_f32 v208, 0, v64
  v_mov_b32 v128, 0
  v_sub_f32 v209, 0, v64
  v_mov_b32 v129, 0
  v_sub_f32 v210, 0, v64
  v_mov_b32 v130, 0
  v_sub_f32 v211, 0, v64
  v_mov_b32 v131, 0
  v_sub_f32 v212, 0, v64
  v_mov_b32 v132, 0
  v_sub_f32 v213, 0, v64
  v_mov_b32 v133, 0
  v_sub_f32 v214, 0, v64
  v_mov_b32 v134, 0
  v_sub_f32 v215, 0, v64
  v_mov_b32 v135, 0
  v_sub_f32 v216, 0, v64
  v_mov_b32 v136, 0
  v_sub_f32 v217, 0, v64
  v_mov_b32 v137, 0
  v_sub_f32 v218, 0, v64
  v_mov_b32 v138, 0
  v_sub_f32 v219, 0, v64
  v_mov_b32 v139, 0
  v_sub_f32 v220, 0, v64
  v_mov_b32 v140, 0
  v_sub_f32 v221, 0, v64
  v_mov_b32 v141, 0
  v_sub_f32 v222, 0, v64
  v_mov_b32 v142, 0
  v_sub_f32 v223, 0, v64
  v_mov_b32 v143, 0
  s_mov_b32 s28, s29
  s_nop 1
main_sum0:
  s_mul_i32 s3, s28, 2560
  v_add_u32 v65, s3, v22
  v_add_u32 v66, s3, v23
  s_mul_i32 s3, s28, 3328
  v_add_u32 v67, s3, v24
  ds_read_b64 v[162:163], v66
  ds_read_b128 v[164:167], v65
  ds_read_b128 v[168:171], v65 offset:1024
  s_waitcnt lgkmcnt(0)
  v_mfma_f32_32x32x16_bf16 v[48:63], v[164:167], v[224:227], v[208:223]
  v_mfma_f32_32x32x16_bf16 v[48:63], v[162:165], v[232:235], v[48:63]
  s_nop 15
  s_cmp_lg_u32 s28, 0
  s_cbranch_scc1 main_s0_a
  v_cndmask_b32 v48, v48, v68, s[64:65]
  v_cndmask_b32 v49, v49, v68, s[66:67]
  v_cndmask_b32 v50, v50, v68, s[68:69]
  v_cndmask_b32 v51, v51, v68, s[70:71]
  v_cndmask_b32 v52, v52, v68, s[72:73]
  v_cndmask_b32 v53, v53, v68, s[74:75]
  v_cndmask_b32 v54, v54, v68, s[76:77]
  v_cndmask_b32 v55, v55, v68, s[78:79]
  v_cndmask_b32 v56, v56, v68, s[80:81]
  v_cndmask_b32 v57, v57, v68, s[82:83]
  v_cndmask_b32 v58, v58, v68, s[84:85]
  v_cndmask_b32 v59, v59, v68, s[86:87]
  v_cndmask_b32 v60, v60, v68, s[88:89]
  v_cndmask_b32 v61, v61, v68, s[90:91]
  v_cndmask_b32 v62, v62, v68, s[92:93]
  v_cndmask_b32 v63, v63, v68, s[94:95]
main_s0_a:
  s_cmp_lg_u32 s28, 8
  s_cbranch_scc1 main_s0_b
  v_cndmask_b32 v48, v68, v48, s[64:65]
  v_cndmask_b32 v49, v68, v49, s[66:67]
  v_cndmask_b32 v50, v68, v50, s[68:69]
  v_cndmask_b32 v51, v68, v51, s[70:71]
  v_cndmask_b32 v52, v68, v52, s[72:73]
  v_cndmask_b32 v53, v68, v53, s[74:75]
  v_cndmask_b32 v54, v68, v54, s[76:77]
  v_cndmask_b32 v55, v68, v55, s[78:79]
  v_cndmask_b32 v56, v68, v56, s[80:81]
  v_cndmask_b32 v57, v68, v57, s[82:83]
  v_cndmask_b32 v58, v68, v58, s[84:85]
  v_cndmask_b32 v59, v68, v59, s[86:87]
  v_cndmask_b32 v60, v68, v60, s[88:89]
  v_cndmask_b32 v61, v68, v61, s[90:91]
  v_cndmask_b32 v62, v68, v62, s[92:93]
  v_cndmask_b32 v63, v68, v63, s[94:95]
main_s0_b:
  ds_read_b64_tr_b16 v[184:185], v67 offset:0
  ds_read_b64_tr_b16 v[186:187], v67 offset:832
  ds_read_b64_tr_b16 v[188:189], v67 offset:1664
  ds_read_b64_tr_b16 v[190:191], v67 offset:2496
  v_exp_f32 v48, v48
  v_exp_f32 v49, v49
  v_exp_f32 v50, v50
  v_exp_f32 v51, v51
  v_exp_f32 v52, v52
  v_exp_f32 v53, v53
  v_exp_f32 v54, v54
  v_exp_f32 v55, v55
  v_exp_f32 v56, v56
  v_exp_f32 v57, v57
  v_exp_f32 v58, v58
  v_exp_f32 v59, v59
  v_exp_f32 v60, v60
  v_exp_f32 v61, v61
  v_exp_f32 v62, v62
  v_exp_f32 v63, v63
  v_cvt_pk_bf16_f32 v96, v48, v49
  v_cvt_pk_bf16_f32 v97, v50, v51
  v_cvt_pk_bf16_f32 v98, v52, v53
  v_cvt_pk_bf16_f32 v99, v54, v55
  v_cvt_pk_bf16_f32 v100, v56, v57
  v_cvt_pk_bf16_f32 v101, v58, v59
  v_cvt_pk_bf16_f32 v102, v60, v61
  v_cvt_pk_bf16_f32 v103, v62, v63
  s_waitcnt lgkmcnt(0)
  v_mfma_f32_32x32x16_bf16 v[128:143], v[184:187], v[96:99], v[128:143]
  v_mfma_f32_32x32x16_bf16 v[128:143], v[188:191], v[100:103], v[128:143]
  s_nop 7
  s_add_u32 s28, s28, 1
  s_cmp_le_u32 s28, 8
  s_cbranch_scc1 main_sum0
  v_mov_b32 v64, v68
  s_mov_b32 s28, s29
main_max1:
  s_mul_i32 s3, s28, 2560
  v_add_u32 v65, s3, v22
  v_add_u32 v66, s3, v23
  s_mul_i32 s3, s28, 3328
  v_add_u32 v67, s3, v24
  ds_read_b64 v[162:163], v66
  ds_read_b128 v[164:167], v65
  ds_read_b128 v[168:171], v65 offset:1024
  s_waitcnt lgkmcnt(0)
  v_mfma_f32_32x32x16_bf16 v[48:63], v[168:171], v[228:231], 0
  v_mfma_f32_32x32x16_bf16 v[48:63], v[162:165], v[236:239], v[48:63]
  s_nop 15
  s_cmp_lg_u32 s28, 0
  s_cbranch_scc1 main_m1_a
  v_cndmask_b32 v48, v48, v68, s[64:65]
  v_cndmask_b32 v49, v49, v68, s[66:67]
  v_cndmask_b32 v50, v50, v68, s[68:69]
  v_cndmask_b32 v51, v51, v68, s[70:71]
  v_cndmask_b32 v52, v52, v68, s[72:73]
  v_cndmask_b32 v53, v53, v68, s[74:75]
  v_cndmask_b32 v54, v54, v68, s[76:77]
  v_cndmask_b32 v55, v55, v68, s[78:79]
  v_cndmask_b32 v56, v56, v68, s[80:81]
  v_cndmask_b32 v57, v57, v68, s[82:83]
  v_cndmask_b32 v58, v58, v68, s[84:85]
  v_cndmask_b32 v59, v59, v68, s[86:87]
  v_cndmask_b32 v60, v60, v68, s[88:89]
  v_cndmask_b32 v61, v61, v68, s[90:91]
  v_cndmask_b32 v62, v62, v68, s[92:93]
  v_cndmask_b32 v63, v63, v68, s[94:95]
main_m1_a:
  s_cmp_lg_u32 s28, 8
  s_cbranch_scc1 main_m1_b
  v_cndmask_b32 v48, v68, v48, s[64:65]
  v_cndmask_b32 v49, v68, v49, s[66:67]
  v_cndmask_b32 v50, v68, v50, s[68:69]
  v_cndmask_b32 v51, v68, v51, s[70:71]
  v_cndmask_b32 v52, v68, v52, s[72:73]
  v_cndmask_b32 v53, v68, v53, s[74:75]
  v_cndmask_b32 v54, v68, v54, s[76:77]
  v_cndmask_b32 v55, v68, v55, s[78:79]
  v_cndmask_b32 v56, v68, v56, s[80:81]
  v_cndmask_b32 v57, v68, v57, s[82:83]
  v_cndmask_b32 v58, v68, v58, s[84:85]
  v_cndmask_b32 v59, v68, v59, s[86:87]
  v_cndmask_b32 v60, v68, v60, s[88:89]
  v_cndmask_b32 v61, v68, v61, s[90:91]
  v_cndmask_b32 v62, v68, v62, s[92:93]
  v_cndmask_b32 v63, v68, v63, s[94:95]
main_m1_b:
  v_max3_f32 v64, v64, v48, v49
  v_max3_f32 v64, v64, v50, v51
  v_max3_f32 v64, v64, v52, v53
  v_max3_f32 v64, v64, v54, v55
  v_max3_f32 v64, v64, v56, v57
  v_max3_f32 v64, v64, v58, v59
  v_max3_f32 v64, v64, v60, v61
  v_max3_f32 v64, v64, v62, v63
  s_add_u32 s28, s28, 1
  s_cmp_le_u32 s28, 8
  s_cbranch_scc1 main_max1
  v_mov_b32 v69, v64
  s_nop 1
  v_permlane32_swap_b32 v64, v69
  v_max_f32 v64, v64, v69
  v_sub_f32 v208, 0, v64
  v_mov_b32 v144, 0
  v_sub_f32 v209, 0, v64
  v_mov_b32 v145, 0
  v_sub_f32 v210, 0, v64
  v_mov_b32 v146, 0
  v_sub_f32 v211, 0, v64
  v_mov_b32 v147, 0
  v_sub_f32 v212, 0, v64
  v_mov_b32 v148, 0
  v_sub_f32 v213, 0, v64
  v_mov_b32 v149, 0
  v_sub_f32 v214, 0, v64
  v_mov_b32 v150, 0
  v_sub_f32 v215, 0, v64
  v_mov_b32 v151, 0
  v_sub_f32 v216, 0, v64
  v_mov_b32 v152, 0
  v_sub_f32 v217, 0, v64
  v_mov_b32 v153, 0
  v_sub_f32 v218, 0, v64
  v_mov_b32 v154, 0
  v_sub_f32 v219, 0, v64
  v_mov_b32 v155, 0
  v_sub_f32 v220, 0, v64
  v_mov_b32 v156, 0
  v_sub_f32 v221, 0, v64
  v_mov_b32 v157, 0
  v_sub_f32 v222, 0, v64
  v_mov_b32 v158, 0
  v_sub_f32 v223, 0, v64
  v_mov_b32 v159, 0
  s_mov_b32 s28, s29
  s_nop 1
main_sum1:
  s_mul_i32 s3, s28, 2560
  v_add_u32 v65, s3, v22
  v_add_u32 v66, s3, v23
  s_mul_i32 s3, s28, 3328
  v_add_u32 v67, s3, v24
  ds_read_b64 v[162:163], v66
  ds_read_b128 v[164:167], v65
  ds_read_b128 v[168:171], v65 offset:1024
  s_waitcnt lgkmcnt(0)
  v_mfma_f32_32x32x16_bf16 v[48:63], v[168:171], v[228:231], v[208:223]
  v_mfma_f32_32x32x16_bf16 v[48:63], v[162:165], v[236:239], v[48:63]
  s_nop 15
  s_cmp_lg_u32 s28, 0
  s_cbranch_scc1 main_s1_a
  v_cndmask_b32 v48, v48, v68, s[64:65]
  v_cndmask_b32 v49, v49, v68, s[66:67]
  v_cndmask_b32 v50, v50, v68, s[68:69]
  v_cndmask_b32 v51, v51, v68, s[70:71]
  v_cndmask_b32 v52, v52, v68, s[72:73]
  v_cndmask_b32 v53, v53, v68, s[74:75]
  v_cndmask_b32 v54, v54, v68, s[76:77]
  v_cndmask_b32 v55, v55, v68, s[78:79]
  v_cndmask_b32 v56, v56, v68, s[80:81]
  v_cndmask_b32 v57, v57, v68, s[82:83]
  v_cndmask_b32 v58, v58, v68, s[84:85]
  v_cndmask_b32 v59, v59, v68, s[86:87]
  v_cndmask_b32 v60, v60, v68, s[88:89]
  v_cndmask_b32 v61, v61, v68, s[90:91]
  v_cndmask_b32 v62, v62, v68, s[92:93]
  v_cndmask_b32 v63, v63, v68, s[94:95]
main_s1_a:
  s_cmp_lg_u32 s28, 8
  s_cbranch_scc1 main_s1_b
  v_cndmask_b32 v48, v68, v48, s[64:65]
  v_cndmask_b32 v49, v68, v49, s[66:67]
  v_cndmask_b32 v50, v68, v50, s[68:69]
  v_cndmask_b32 v51, v68, v51, s[70:71]
  v_cndmask_b32 v52, v68, v52, s[72:73]
  v_cndmask_b32 v53, v68, v53, s[74:75]
  v_cndmask_b32 v54, v68, v54, s[76:77]
  v_cndmask_b32 v55, v68, v55, s[78:79]
  v_cndmask_b32 v56, v68, v56, s[80:81]
  v_cndmask_b32 v57, v68, v57, s[82:83]
  v_cndmask_b32 v58, v68, v58, s[84:85]
  v_cndmask_b32 v59, v68, v59, s[86:87]
  v_cndmask_b32 v60, v68, v60, s[88:89]
  v_cndmask_b32 v61, v68, v61, s[90:91]
  v_cndmask_b32 v62, v68, v62, s[92:93]
  v_cndmask_b32 v63, v68, v63, s[94:95]
main_s1_b:
  ds_read_b64_tr_b16 v[184:185], v67 offset:192
  ds_read_b64_tr_b16 v[186:187], v67 offset:1024
  ds_read_b64_tr_b16 v[188:189], v67 offset:1856
  ds_read_b64_tr_b16 v[190:191], v67 offset:2688
  v_exp_f32 v48, v48
  v_exp_f32 v49, v49
  v_exp_f32 v50, v50
  v_exp_f32 v51, v51
  v_exp_f32 v52, v52
  v_exp_f32 v53, v53
  v_exp_f32 v54, v54
  v_exp_f32 v55, v55
  v_exp_f32 v56, v56
  v_exp_f32 v57, v57
  v_exp_f32 v58, v58
  v_exp_f32 v59, v59
  v_exp_f32 v60, v60
  v_exp_f32 v61, v61
  v_exp_f32 v62, v62
  v_exp_f32 v63, v63
  v_cvt_pk_bf16_f32 v96, v48, v49
  v_cvt_pk_bf16_f32 v97, v50, v51
  v_cvt_pk_bf16_f32 v98, v52, v53
  v_cvt_pk_bf16_f32 v99, v54, v55
  v_cvt_pk_bf16_f32 v100, v56, v57
  v_cvt_pk_bf16_f32 v101, v58, v59
  v_cvt_pk_bf16_f32 v102, v60, v61
  v_cvt_pk_bf16_f32 v103, v62, v63
  s_waitcnt lgkmcnt(0)
  v_mfma_f32_32x32x16_bf16 v[144:159], v[184:187], v[96:99], v[144:159]
  v_mfma_f32_32x32x16_bf16 v[144:159], v[188:191], v[100:103], v[144:159]
  s_nop 7
  s_add_u32 s28, s28, 1
  s_cmp_le_u32 s28, 8
  s_cbranch_scc1 main_sum1
  s_nop 15
  s_branch main_slow_back
main_last:
.section .rodata,"a"
.p2align 6
.amdhsa_kernel interleave_layers__sliding_block__glu_gated_reglu__prompt_kernel
  .amdhsa_next_free_vgpr 512
  .amdhsa_next_free_sgpr 102
  .amdhsa_accum_offset 256
  .amdhsa_group_segment_fixed_size 0
  .amdhsa_kernarg_size 80
  .amdhsa_user_sgpr_count 2
  .amdhsa_user_sgpr_kernarg_segment_ptr 1
  .amdhsa_system_sgpr_workgroup_id_x 1
.end_amdhsa_kernel
```
